```python
import torch

def _softmax(x, axis=-1):
    return torch.softmax(x, dim=axis)
def _gelu(x):
    return torch.nn.functional.gelu(x, approximate="tanh")
def _silu(x):
    return torch.nn.functional.silu(x)
def _sigmoid(x):
    return torch.sigmoid(x)
def _layernorm(x, axis=-1, eps=1e-5):
    m = x.mean(dim=axis, keepdim=True)
    v = x.var(dim=axis, keepdim=True, unbiased=False)
    return (x - m) / torch.sqrt(v + eps)
def _scatter_add(tgt, idx, src, axis=0):
    return tgt.clone().index_add_(axis, idx, src)
def _segment_sum(src, seg, n):
    out = torch.zeros((n,) + src.shape[1:], dtype=src.dtype)
    return out.index_add_(0, seg, src)
def _pad(x, pw):
    flat = tuple(v for pair in reversed(pw) for v in pair)
    return torch.nn.functional.pad(x, flat)

kernel_name = 'interleave_layers__linear_kernel_hedgehog__mixer_s_mlp__prompt'

def setup_inputs():

    _w = (lambda a: (lambda t: t.to(torch.bfloat16) if t.is_floating_point() else t)(torch.as_tensor(a)))
    def _A_setup():
        B, S, D, H = 1, 2048, 512, 32
        Dh = D // H
        return {
            "x": _w((lambda *s: torch.randn(*s, dtype=torch.bfloat16) * 0.05)(B, S, D)),
            "wqkv": _w((lambda *s: torch.randn(*s, dtype=torch.bfloat16) * 0.4)(D, 3 * D)),
            "w_phi": _w((lambda *s: torch.randn(*s, dtype=torch.bfloat16) * 0.4)(H, Dh, Dh) * (Dh ** -0.5)),
            "wo": _w((lambda *s: torch.randn(*s, dtype=torch.bfloat16) * 0.05)(D, D)),
        }
    _A_in = _A_setup()

    def _B_setup():
        B, S, D, F = 1, 2048, 512, 1792
        return {
            "x":  _w((lambda *s: torch.randn(*s, dtype=torch.bfloat16) * 0.05)(B, S, D)),
            "w1": _w((lambda *s: torch.randn(*s, dtype=torch.bfloat16) * 3.2)(D, D) * (D ** -0.5)),
            "w2": _w((lambda *s: torch.randn(*s, dtype=torch.bfloat16) * 3.2)(D, D) * (D ** -0.5)),
            "w3": _w((lambda *s: torch.randn(*s, dtype=torch.bfloat16) * 3.2)(D, F) * (D ** -0.5)),
            "w4": _w((lambda *s: torch.randn(*s, dtype=torch.bfloat16) * 3.2)(F, D) * (F ** -0.5)),
        }
    _B_in = _B_setup()

    return {
        "A_x": _A_in["x"],
        "A_wqkv": _A_in["wqkv"],
        "A_w_phi": _A_in["w_phi"],
        "A_wo": _A_in["wo"],
        "B_x": _B_in["x"],
        "B_w1": _B_in["w1"],
        "B_w2": _B_in["w2"],
        "B_w3": _B_in["w3"],
        "B_w4": _B_in["w4"],
    }

def reference(A_x, A_wqkv, A_w_phi, A_wo, B_x, B_w1, B_w2, B_w3, B_w4):
    def _A_ref(x, wqkv, w_phi, wo):
        B, S, D = x.shape
        H = 32; Dh = D // H
        qkv = (lambda x, *d: x.permute(*d))((x @ wqkv).reshape(B, S, 3, H, Dh), 2, 0, 3, 1, 4)
        q, k, v = qkv[0], qkv[1], qkv[2]
        pq = torch.einsum("bhsd,hdf->bhsf", q, w_phi)
        pk = torch.einsum("bhsd,hdf->bhsf", k, w_phi)
        phi_q = torch.concatenate([_softmax(pq, axis=-1), _softmax(-pq, axis=-1)], axis=-1)
        phi_k = torch.concatenate([_softmax(pk, axis=-1), _softmax(-pk, axis=-1)], axis=-1)
        kv = torch.einsum("bhsf,bhsd->bhfd", phi_k, v)
        z  = torch.einsum("bhsf->bhf", phi_k)
        num = torch.einsum("bhqf,bhfd->bhqd", phi_q, kv)
        den = torch.einsum("bhqf,bhf->bhq", phi_q, z)[..., None] + 1e-6
        o = num / den
        return (lambda x, *d: x.permute(*d))(o, 0, 2, 1, 3).reshape(B, S, D) @ wo

    def _B_ref(x, w1, w2, w3, w4):
        B, S, D = x.shape
        h = _gelu(_layernorm(x, axis=-1) @ w1)
        c = D // 4
        g0 = _pad(h[:, :, 0*c:1*c], ((0, 0), (1, 0), (0, 0)))[:, :S, :]
        g1 = _pad(h[:, :, 1*c:2*c], ((0, 0), (0, 1), (0, 0)))[:, 1:, :]
        g2 = _pad(h[:, :, 2*c:3*c], ((0, 0), (2, 0), (0, 0)))[:, :S, :]
        g3 = _pad(h[:, :, 3*c:   ], ((0, 0), (0, 2), (0, 0)))[:, 2:, :]
        hs = torch.concatenate([g0, g1, g2, g3], axis=-1) @ w2
        x1 = x + hs
        h2 = _gelu(_layernorm(x1, axis=-1) @ w3) @ w4
        return x1 + h2

    x = A_x
    x = x + _A_ref(_layernorm(x, axis=-1), A_wqkv, A_w_phi, A_wo)
    x = x + _B_ref(_layernorm(x, axis=-1), B_w1, B_w2, B_w3, B_w4)
    x = x + _A_ref(_layernorm(x, axis=-1), A_wqkv, A_w_phi, A_wo)
    x = x + _B_ref(_layernorm(x, axis=-1), B_w1, B_w2, B_w3, B_w4)
    return x
```

```asm
; @launch grid=(256,1,1) block=(512,1,1) lds=163840
.amdgcn_target "amdgcn-amd-amdhsa--gfx950"
.text
.p2align 8
.globl interleave_layers__linear_kernel_hedgehog__mixer_s_mlp__prompt_kernel
.type interleave_layers__linear_kernel_hedgehog__mixer_s_mlp__prompt_kernel,@function
interleave_layers__linear_kernel_hedgehog__mixer_s_mlp__prompt_kernel:
    s_cmp_ge_u32 s2, 256
    s_cbranch_scc1 .Lexit_1
    s_load_dwordx16 s[64:79], s[0:1], 0
    s_load_dwordx8 s[80:87], s[0:1], 64
    s_getpc_b64 s[40:41]
.Lpc_2:
    s_lshr_b32 s42, s2, 3
    s_lshl_b32 s42, s42, 11
    v_lshlrev_b32 v3, 2, v0
    v_add_u32 v3, s42, v3
    v_min_u32 v3, code_end-.Lpc_2-4, v3
    s_mov_b32 exec_lo, 1
    s_mov_b32 exec_hi, 1
    global_load_dword v13, v3, s[40:41]
    s_mov_b64 exec, -1
    v_and_b32 v2, 63, v0
    v_lshrrev_b32 v3, 6, v0
    v_lshlrev_b32 v1, 4, v2
    v_readfirstlane_b32 s8, v3
    s_mov_b32 s6, 25247744
    s_mov_b32 s7, 0x00020000
    s_mov_b32 s15, 0x00020000
    s_mov_b32 s90, 256
    s_mov_b32 s91, 0x00020000
    s_and_b32 s16, s2, 7
    s_lshl_b32 s16, s16, 2
    s_lshr_b32 s17, s2, 6
    s_add_u32 s16, s16, s17
    s_bfe_u32 s17, s2, 0x30003
    s_and_b32 s18, s2, 7
    s_lshl_b32 s18, s18, 1
    s_lshr_b32 s19, s2, 7
    s_add_u32 s18, s18, s19
    s_bfe_u32 s19, s2, 0x40003
    s_mov_b32 s21, 0
    s_mov_b32 s23, 0x200000
    v_lshlrev_b32 v7, 2, v2
    s_mov_b32 s50, 0
    v_mov_b32 v15, 161792
    s_and_b32 s26, s8, 3
    s_lshl_b32 s26, s26, 2
    v_add_u32 v14, s26, v15
    v_cmp_gt_u32 vcc, 4, v2
    s_nop 1
    v_cndmask_b32 v3, 0, 2, vcc
    v_add_u32 v10, v7, v15
    ds_write_b32 v10, v3
    v_lshlrev_b32 v10, 2, v0
    v_add_u32 v10, 159744, v10
    v_mov_b32 v11, 0
    ds_write_b32 v10, v11
    s_waitcnt lgkmcnt(0)
    s_mov_b64 s[4:5], s[86:87]
    s_mov_b64 s[88:89], s[84:85]
    s_cmp_lt_u32 s8, 4
    s_barrier
    s_cbranch_scc1 .Lcompute_3
    s_sub_u32 s26, s8, 4
    s_mov_b64 s[12:13], s[66:67]
    s_mov_b32 s14, 1572864
    s_lshr_b32 s28, s2, 3
    s_lshl_b32 s29, s2, 2
    s_add_u32 s28, s28, s29
    s_and_b32 s28, s28, 31
    s_lshl_b32 s28, s28, 2
    s_add_u32 s28, s28, s26
    s_mul_i32 s28, s28, 12288
    v_lshrrev_b32 v40, 1, v2
    v_mul_u32_u24 v40, 3072, v40
    v_and_b32 v41, 1, v2
    v_lshl_add_u32 v40, v41, 10, v40
    s_mov_b64 exec, 0xff
    buffer_load_dword v11, v40, s[12:15], s28 offen offset:1408
    s_mov_b64 exec, -1
    s_mov_b64 s[12:13], s[68:69]
    s_mov_b32 s14, 16384
    s_lshl_b32 s28, s19, 10
    s_mov_b32 m0, 157696
    s_nop 0
    buffer_load_dwordx4 v1, s[12:15], s28 offen lds
    s_mov_b64 s[12:13], s[66:67]
    s_mov_b32 s14, 1572864
    v_lshrrev_b32 v40, 2, v2
    v_mul_u32_u24 v40, 3072, v40
    v_lshrrev_b32 v41, 4, v2
    v_xor_b32 v41, v41, v2
    v_and_b32 v41, 3, v41
    v_lshl_add_u32 v40, v41, 4, v40
    s_lshl_b32 s59, s19, 6
    s_add_u32 s28, s18, 0
    s_and_b32 s28, s28, 3
    s_lshl_b32 s28, s28, 2
    s_add_u32 s28, s28, s26
    s_lshl_b32 s40, s28, 12
    s_lshl_b32 s44, s28, 11
    s_add_u32 s44, s44, 65536
    s_add_u32 s28, s18, 1
    s_and_b32 s28, s28, 3
    s_lshl_b32 s28, s28, 2
    s_add_u32 s28, s28, s26
    s_lshl_b32 s41, s28, 12
    s_lshl_b32 s45, s28, 11
    s_add_u32 s45, s45, 65536
    s_add_u32 s28, s18, 2
    s_and_b32 s28, s28, 3
    s_lshl_b32 s28, s28, 2
    s_add_u32 s28, s28, s26
    s_lshl_b32 s42, s28, 12
    s_lshl_b32 s46, s28, 11
    s_add_u32 s46, s46, 65536
    s_add_u32 s28, s18, 3
    s_and_b32 s28, s28, 3
    s_lshl_b32 s28, s28, 2
    s_add_u32 s28, s28, s26
    s_lshl_b32 s43, s28, 12
    s_lshl_b32 s47, s28, 11
    s_add_u32 s47, s47, 65536
    s_mul_i32 s38, s40, 24
    s_add_u32 s38, s38, s59
    s_add_u32 m0, s40, 0
    s_add_u32 s29, s38, 1024
    buffer_load_dwordx4 v40, s[12:15], s29 offen lds
    s_add_u32 m0, s40, 2048
    s_add_u32 s29, s38, 2048
    buffer_load_dwordx4 v40, s[12:15], s29 offen lds
    s_add_u32 m0, s40, 1024
    s_add_u32 s29, s38, 50176
    buffer_load_dwordx4 v40, s[12:15], s29 offen lds
    s_add_u32 m0, s40, 3072
    s_add_u32 s29, s38, 51200
    buffer_load_dwordx4 v40, s[12:15], s29 offen lds
    s_mul_i32 s38, s41, 24
    s_add_u32 s38, s38, s59
    s_add_u32 m0, s41, 0
    s_add_u32 s29, s38, 1024
    buffer_load_dwordx4 v40, s[12:15], s29 offen lds
    s_add_u32 m0, s41, 2048
    s_add_u32 s29, s38, 2048
    buffer_load_dwordx4 v40, s[12:15], s29 offen lds
    s_add_u32 m0, s41, 1024
    s_add_u32 s29, s38, 50176
    buffer_load_dwordx4 v40, s[12:15], s29 offen lds
    s_add_u32 m0, s41, 3072
    s_add_u32 s29, s38, 51200
    buffer_load_dwordx4 v40, s[12:15], s29 offen lds
    s_mul_i32 s38, s42, 24
    s_add_u32 s38, s38, s59
    s_add_u32 m0, s42, 0
    s_add_u32 s29, s38, 1024
    buffer_load_dwordx4 v40, s[12:15], s29 offen lds
    s_add_u32 m0, s42, 2048
    s_add_u32 s29, s38, 2048
    buffer_load_dwordx4 v40, s[12:15], s29 offen lds
    s_add_u32 m0, s42, 1024
    s_add_u32 s29, s38, 50176
    buffer_load_dwordx4 v40, s[12:15], s29 offen lds
    s_add_u32 m0, s42, 3072
    s_add_u32 s29, s38, 51200
    buffer_load_dwordx4 v40, s[12:15], s29 offen lds
    s_mul_i32 s38, s43, 24
    s_add_u32 s38, s38, s59
    s_add_u32 m0, s43, 0
    s_add_u32 s29, s38, 1024
    buffer_load_dwordx4 v40, s[12:15], s29 offen lds
    s_add_u32 m0, s43, 2048
    s_add_u32 s29, s38, 2048
    buffer_load_dwordx4 v40, s[12:15], s29 offen lds
    s_add_u32 m0, s43, 1024
    s_add_u32 s29, s38, 50176
    buffer_load_dwordx4 v40, s[12:15], s29 offen lds
    s_add_u32 m0, s43, 3072
    s_add_u32 s29, s38, 51200
    buffer_load_dwordx4 v40, s[12:15], s29 offen lds
    v_mov_b32 v16, 0x3f803f80
    v_mov_b32 v17, 0x3f803f80
    v_mov_b32 v18, 0x3f803f80
    v_mov_b32 v19, 0x3f803f80
    v_mov_b32 v8, 1
    v_and_b32 v32, 15, v2
    v_lshrrev_b32 v33, 4, v2
    v_lshrrev_b32 v34, 2, v32
    v_lshrrev_b32 v35, 1, v33
    v_xor_b32 v35, v35, v34
    v_lshlrev_b32 v35, 4, v35
    v_lshl_add_u32 v35, v32, 6, v35
    v_and_b32 v36, 1, v33
    v_lshl_add_u32 v35, v36, 3, v35
    v_xor_b32 v36, 32, v35
    v_bfe_u32 v37, v2, 1, 1
    v_xor_b32 v37, v37, v33
    v_lshlrev_b32 v37, 4, v37
    v_lshrrev_b32 v38, 2, v2
    v_lshl_add_u32 v37, v38, 6, v37
    v_and_b32 v38, 1, v2
    v_lshl_add_u32 v37, v38, 3, v37
    v_xor_b32 v38, 32, v37
    v_and_b32 v39, 1, v34
    v_lshlrev_b32 v39, 10, v39
    v_lshl_add_u32 v39, v33, 8, v39
    v_lshrrev_b32 v34, 3, v32
    v_lshl_add_u32 v39, v34, 7, v39
    v_and_b32 v34, 3, v32
    v_lshl_add_u32 v39, v34, 4, v39
    v_lshlrev_b32 v46, 3, v2
    v_add_u32 v46, 157696, v46
    v_and_b32 v30, 1, v33
    v_lshlrev_b32 v30, 6, v30
    v_lshrrev_b32 v34, 1, v33
    v_lshl_add_u32 v30, v34, 5, v30
    v_add_u32 v30, 159744, v30
    v_lshl_add_u32 v30, v32, 2, v30
    v_lshlrev_b32 v31, 4, v33
    v_add_u32 v31, 159744, v31
    v_lshl_add_u32 v31, v32, 2, v31
    v_add_u32 v64, s40, v35
    v_add_u32 v65, s40, v36
    v_add_u32 v66, s40, v37
    v_add_u32 v67, s40, v38
    s_waitcnt vmcnt(12)
    ds_read_b64_tr_b16 v[20:21], v46
    ds_read_b64_tr_b16 v[22:23], v46 offset:512
    ds_read_b64 v[160:161], v64 offset:0
    ds_read_b64 v[162:163], v64 offset:1024
    ds_read_b64 v[164:165], v65 offset:0
    ds_read_b64 v[166:167], v65 offset:1024
    ds_read_b64_tr_b16 v[168:169], v66 offset:2048
    ds_read_b64_tr_b16 v[170:171], v66 offset:3072
    ds_read_b64_tr_b16 v[172:173], v67 offset:2048
    ds_read_b64_tr_b16 v[174:175], v67 offset:3072
    v_add_u32 v68, s40, v39
    v_add_u32 v69, s40, v1
    s_waitcnt lgkmcnt(0)
    v_mfma_f32_16x16x16_bf16 v[104:107], v[160:161], v[20:21], 0
    v_mfma_f32_16x16x16_bf16 v[108:111], v[162:163], v[20:21], 0
    v_mfma_f32_16x16x16_bf16 v[112:115], v[164:165], v[22:23], 0
    v_mfma_f32_16x16x16_bf16 v[116:119], v[166:167], v[22:23], 0
    ds_write_b128 v69, v[168:171] offset:2048
    ds_write_b128 v69, v[172:175] offset:3072
    v_add_u32 v64, s41, v35
    v_add_u32 v65, s41, v36
    v_add_u32 v66, s41, v37
    v_add_u32 v67, s41, v38
    s_waitcnt vmcnt(8)
    ds_read_b64 v[176:177], v64 offset:0
    ds_read_b64 v[178:179], v64 offset:1024
    ds_read_b64 v[180:181], v65 offset:0
    ds_read_b64 v[182:183], v65 offset:1024
    ds_read_b64_tr_b16 v[184:185], v66 offset:2048
    ds_read_b64_tr_b16 v[186:187], v66 offset:3072
    ds_read_b64_tr_b16 v[188:189], v67 offset:2048
    ds_read_b64_tr_b16 v[190:191], v67 offset:3072
    v_cvt_pk_bf16_f32 v160, v104, v105
    v_cvt_pk_bf16_f32 v161, v106, v107
    v_cvt_pk_bf16_f32 v162, v108, v109
    v_cvt_pk_bf16_f32 v163, v110, v111
    ds_write_b128 v68, v[160:163] offset:0
    v_cvt_pk_bf16_f32 v164, v112, v113
    v_cvt_pk_bf16_f32 v165, v114, v115
    v_cvt_pk_bf16_f32 v166, v116, v117
    v_cvt_pk_bf16_f32 v167, v118, v119
    ds_write_b128 v68, v[164:167] offset:64
    v_mfma_f32_16x16x32_bf16 v[120:123], v[160:163], v[16:19], 0
    v_mfma_f32_16x16x32_bf16 v[124:127], v[164:167], v[16:19], 0
    v_mfma_f32_16x16x32_bf16 v[128:131], v[168:171], v[16:19], 0
    v_mfma_f32_16x16x32_bf16 v[132:135], v[172:175], v[16:19], 0
    v_add_u32 v68, s41, v39
    v_add_u32 v69, s41, v1
    s_waitcnt lgkmcnt(2)
    v_mfma_f32_16x16x16_bf16 v[104:107], v[176:177], v[20:21], 0
    v_mfma_f32_16x16x16_bf16 v[108:111], v[178:179], v[20:21], 0
    v_mfma_f32_16x16x16_bf16 v[112:115], v[180:181], v[22:23], 0
    v_mfma_f32_16x16x16_bf16 v[116:119], v[182:183], v[22:23], 0
    ds_write_b128 v69, v[184:187] offset:2048
    ds_write_b128 v69, v[188:191] offset:3072
    v_add_u32 v64, s42, v35
    v_add_u32 v65, s42, v36
    v_add_u32 v66, s42, v37
    v_add_u32 v67, s42, v38
    s_waitcnt vmcnt(4)
    ds_read_b64 v[192:193], v64 offset:0
    ds_read_b64 v[194:195], v64 offset:1024
    ds_read_b64 v[196:197], v65 offset:0
    ds_read_b64 v[198:199], v65 offset:1024
    ds_read_b64_tr_b16 v[200:201], v66 offset:2048
    ds_read_b64_tr_b16 v[202:203], v66 offset:3072
    ds_read_b64_tr_b16 v[204:205], v67 offset:2048
    ds_read_b64_tr_b16 v[206:207], v67 offset:3072
    v_cvt_pk_bf16_f32 v176, v104, v105
    v_cvt_pk_bf16_f32 v177, v106, v107
    v_cvt_pk_bf16_f32 v178, v108, v109
    v_cvt_pk_bf16_f32 v179, v110, v111
    ds_write_b128 v68, v[176:179] offset:0
    v_cvt_pk_bf16_f32 v180, v112, v113
    v_cvt_pk_bf16_f32 v181, v114, v115
    v_cvt_pk_bf16_f32 v182, v116, v117
    v_cvt_pk_bf16_f32 v183, v118, v119
    ds_write_b128 v68, v[180:183] offset:64
    v_mfma_f32_16x16x32_bf16 v[120:123], v[176:179], v[16:19], v[120:123]
    v_mfma_f32_16x16x32_bf16 v[124:127], v[180:183], v[16:19], v[124:127]
    v_mfma_f32_16x16x32_bf16 v[128:131], v[184:187], v[16:19], v[128:131]
    v_mfma_f32_16x16x32_bf16 v[132:135], v[188:191], v[16:19], v[132:135]
    s_mul_i32 s38, s40, 24
    s_add_u32 s38, s38, s59
    s_add_u32 m0, s44, 0
    s_add_u32 s29, s38, 0
    buffer_load_dwordx4 v40, s[12:15], s29 offen lds
    s_add_u32 m0, s44, 1024
    s_add_u32 s29, s38, 49152
    buffer_load_dwordx4 v40, s[12:15], s29 offen lds
    s_mul_i32 s38, s41, 24
    s_add_u32 s38, s38, s59
    s_add_u32 m0, s45, 0
    s_add_u32 s29, s38, 0
    buffer_load_dwordx4 v40, s[12:15], s29 offen lds
    s_add_u32 m0, s45, 1024
    s_add_u32 s29, s38, 49152
    buffer_load_dwordx4 v40, s[12:15], s29 offen lds
    s_mul_i32 s38, s42, 24
    s_add_u32 s38, s38, s59
    s_add_u32 m0, s46, 0
    s_add_u32 s29, s38, 0
    buffer_load_dwordx4 v40, s[12:15], s29 offen lds
    s_add_u32 m0, s46, 1024
    s_add_u32 s29, s38, 49152
    buffer_load_dwordx4 v40, s[12:15], s29 offen lds
    s_mul_i32 s38, s43, 24
    s_add_u32 s38, s38, s59
    s_add_u32 m0, s47, 0
    s_add_u32 s29, s38, 0
    buffer_load_dwordx4 v40, s[12:15], s29 offen lds
    s_add_u32 m0, s47, 1024
    s_add_u32 s29, s38, 49152
    buffer_load_dwordx4 v40, s[12:15], s29 offen lds
    v_add_u32 v68, s42, v39
    v_add_u32 v69, s42, v1
    s_waitcnt lgkmcnt(2)
    v_mfma_f32_16x16x16_bf16 v[104:107], v[192:193], v[20:21], 0
    v_mfma_f32_16x16x16_bf16 v[108:111], v[194:195], v[20:21], 0
    v_mfma_f32_16x16x16_bf16 v[112:115], v[196:197], v[22:23], 0
    v_mfma_f32_16x16x16_bf16 v[116:119], v[198:199], v[22:23], 0
    ds_write_b128 v69, v[200:203] offset:2048
    ds_write_b128 v69, v[204:207] offset:3072
    v_add_u32 v64, s43, v35
    v_add_u32 v65, s43, v36
    v_add_u32 v66, s43, v37
    v_add_u32 v67, s43, v38
    s_waitcnt vmcnt(8)
    ds_read_b64 v[208:209], v64 offset:0
    ds_read_b64 v[210:211], v64 offset:1024
    ds_read_b64 v[212:213], v65 offset:0
    ds_read_b64 v[214:215], v65 offset:1024
    ds_read_b64_tr_b16 v[216:217], v66 offset:2048
    ds_read_b64_tr_b16 v[218:219], v66 offset:3072
    ds_read_b64_tr_b16 v[220:221], v67 offset:2048
    ds_read_b64_tr_b16 v[222:223], v67 offset:3072
    v_cvt_pk_bf16_f32 v192, v104, v105
    v_cvt_pk_bf16_f32 v193, v106, v107
    v_cvt_pk_bf16_f32 v194, v108, v109
    v_cvt_pk_bf16_f32 v195, v110, v111
    ds_write_b128 v68, v[192:195] offset:0
    v_cvt_pk_bf16_f32 v196, v112, v113
    v_cvt_pk_bf16_f32 v197, v114, v115
    v_cvt_pk_bf16_f32 v198, v116, v117
    v_cvt_pk_bf16_f32 v199, v118, v119
    ds_write_b128 v68, v[196:199] offset:64
    v_mfma_f32_16x16x32_bf16 v[120:123], v[192:195], v[16:19], v[120:123]
    v_mfma_f32_16x16x32_bf16 v[124:127], v[196:199], v[16:19], v[124:127]
    v_mfma_f32_16x16x32_bf16 v[128:131], v[200:203], v[16:19], v[128:131]
    v_mfma_f32_16x16x32_bf16 v[132:135], v[204:207], v[16:19], v[132:135]
    v_add_u32 v68, s43, v39
    v_add_u32 v69, s43, v1
    s_waitcnt lgkmcnt(2)
    v_mfma_f32_16x16x16_bf16 v[104:107], v[208:209], v[20:21], 0
    v_mfma_f32_16x16x16_bf16 v[108:111], v[210:211], v[20:21], 0
    v_mfma_f32_16x16x16_bf16 v[112:115], v[212:213], v[22:23], 0
    v_mfma_f32_16x16x16_bf16 v[116:119], v[214:215], v[22:23], 0
    ds_write_b128 v69, v[216:219] offset:2048
    ds_write_b128 v69, v[220:223] offset:3072
    s_nop 2
    v_cvt_pk_bf16_f32 v208, v104, v105
    v_cvt_pk_bf16_f32 v209, v106, v107
    v_cvt_pk_bf16_f32 v210, v108, v109
    v_cvt_pk_bf16_f32 v211, v110, v111
    ds_write_b128 v68, v[208:211] offset:0
    v_cvt_pk_bf16_f32 v212, v112, v113
    v_cvt_pk_bf16_f32 v213, v114, v115
    v_cvt_pk_bf16_f32 v214, v116, v117
    v_cvt_pk_bf16_f32 v215, v118, v119
    ds_write_b128 v68, v[212:215] offset:64
    s_add_u32 s51, s50, 1
    v_mov_b32 v3, s51
    ds_write_b32 v14, v3 offset:16
    v_mfma_f32_16x16x32_bf16 v[120:123], v[208:211], v[16:19], v[120:123]
    v_mfma_f32_16x16x32_bf16 v[124:127], v[212:215], v[16:19], v[124:127]
    v_mfma_f32_16x16x32_bf16 v[128:131], v[216:219], v[16:19], v[128:131]
    v_mfma_f32_16x16x32_bf16 v[132:135], v[220:223], v[16:19], v[132:135]
    v_and_b32 v3, 15, v2
    v_cmp_eq_u32 s[28:29], 1, v3
    v_cmp_eq_u32 s[30:31], 2, v3
    v_cmp_eq_u32 s[32:33], 3, v3
    s_nop 0
    v_cndmask_b32 v120, v120, v121, s[28:29]
    v_cndmask_b32 v120, v120, v122, s[30:31]
    v_cndmask_b32 v120, v120, v123, s[32:33]
    v_cndmask_b32 v124, v124, v125, s[28:29]
    v_cndmask_b32 v124, v124, v126, s[30:31]
    v_cndmask_b32 v124, v124, v127, s[32:33]
    v_cndmask_b32 v128, v128, v129, s[28:29]
    v_cndmask_b32 v128, v128, v130, s[30:31]
    v_cndmask_b32 v128, v128, v131, s[32:33]
    v_cndmask_b32 v132, v132, v133, s[28:29]
    v_cndmask_b32 v132, v132, v134, s[30:31]
    v_cndmask_b32 v132, v132, v135, s[32:33]
    s_mov_b32 exec_lo, 0x000f000f
    s_mov_b32 exec_hi, 0x000f000f
    ds_add_f32 v30, v120 offset:0
    ds_add_f32 v30, v124 offset:16
    ds_add_f32 v31, v128 offset:128
    ds_add_f32 v31, v132 offset:192
    s_mov_b64 exec, -1
    v_mov_b32 v3, 1
    ds_write_b32 v14, v3 offset:80
    s_lshl_b32 s100, s26, 12
    s_add_u32 s100, s100, 141312
    s_lshl_b32 s49, s2, 2
    s_add_u32 s49, s49, s26
    s_add_u32 s49, s49, 256
    s_mov_b32 s98, 0
    s_cmp_ge_u32 s49, 832
    s_cbranch_scc1 .Lpd4_5
    s_cmp_ge_u32 s49, 384
    s_cbranch_scc1 .Lpd3_4
    s_lshr_b32 s28, s49, 7
    s_and_b32 s29, s49, 7
    s_bfe_u32 s30, s49, 0x40003
    s_cmp_eq_u32 s28, 1
    s_cselect_b64 s[12:13], s[74:75], s[76:77]
    s_cmp_eq_u32 s28, 0
    s_cselect_b64 s[12:13], s[70:71], s[12:13]
    s_mov_b32 s14, 524288
    s_mov_b32 s93, 1024
    s_lshl_b32 s99, s28, 3
    s_add_u32 s99, s99, s29
    s_lshl_b32 s94, s99, 4
    s_add_u32 s94, s94, s30
    s_lshl_b32 s94, s94, 12
    s_add_u32 s94, s94, 1572864
    s_add_u32 s95, s94, 1024
    s_add_u32 s96, s94, 2048
    s_add_u32 s97, s94, 3072
    s_branch .Lpdj_6
.Lpd3_4:
    s_sub_u32 s28, s49, 384
    s_and_b32 s30, s28, 15
    s_lshr_b32 s29, s28, 4
    s_mov_b64 s[12:13], s[78:79]
    s_mov_b32 s14, 1835008
    s_mov_b32 s93, 3584
    s_add_u32 s99, s29, 24
    s_mul_i32 s31, s30, 7168
    s_add_u32 s31, s31, 3145728
    s_lshl_b32 s28, s29, 2
    s_add_u32 s28, s28, 0
    s_mul_i32 s32, s28, 43
    s_lshr_b32 s32, s32, 8
    s_mul_i32 s33, s32, 6
    s_sub_u32 s33, s28, s33
    s_sub_u32 s36, s28, 96
    s_cmp_ge_u32 s28, 96
    s_cselect_b32 s32, s36, s32
    s_cselect_b32 s33, 6, s33
    s_lshl_b32 s36, s32, 3
    s_add_u32 s36, s36, s33
    s_lshl_b32 s36, s36, 4
    s_add_u32 s36, s36, s30
    s_lshl_b32 s36, s36, 6
    s_add_u32 s72, s36, 23015424
    s_mul_i32 s32, s32, 112
    s_add_u32 s32, s32, s33
    s_lshl_b32 s32, s32, 10
    s_add_u32 s94, s32, s31
    s_lshl_b32 s28, s29, 2
    s_add_u32 s28, s28, 1
    s_mul_i32 s32, s28, 43
    s_lshr_b32 s32, s32, 8
    s_mul_i32 s33, s32, 6
    s_sub_u32 s33, s28, s33
    s_sub_u32 s36, s28, 96
    s_cmp_ge_u32 s28, 96
    s_cselect_b32 s32, s36, s32
    s_cselect_b32 s33, 6, s33
    s_lshl_b32 s36, s32, 3
    s_add_u32 s36, s36, s33
    s_lshl_b32 s36, s36, 4
    s_add_u32 s36, s36, s30
    s_lshl_b32 s36, s36, 6
    s_add_u32 s73, s36, 23015424
    s_mul_i32 s32, s32, 112
    s_add_u32 s32, s32, s33
    s_lshl_b32 s32, s32, 10
    s_add_u32 s95, s32, s31
    s_lshl_b32 s28, s29, 2
    s_add_u32 s28, s28, 2
    s_mul_i32 s32, s28, 43
    s_lshr_b32 s32, s32, 8
    s_mul_i32 s33, s32, 6
    s_sub_u32 s33, s28, s33
    s_sub_u32 s36, s28, 96
    s_cmp_ge_u32 s28, 96
    s_cselect_b32 s32, s36, s32
    s_cselect_b32 s33, 6, s33
    s_lshl_b32 s36, s32, 3
    s_add_u32 s36, s36, s33
    s_lshl_b32 s36, s36, 4
    s_add_u32 s36, s36, s30
    s_lshl_b32 s36, s36, 6
    s_add_u32 s74, s36, 23015424
    s_mul_i32 s32, s32, 112
    s_add_u32 s32, s32, s33
    s_lshl_b32 s32, s32, 10
    s_add_u32 s96, s32, s31
    s_lshl_b32 s28, s29, 2
    s_add_u32 s28, s28, 3
    s_mul_i32 s32, s28, 43
    s_lshr_b32 s32, s32, 8
    s_mul_i32 s33, s32, 6
    s_sub_u32 s33, s28, s33
    s_sub_u32 s36, s28, 96
    s_cmp_ge_u32 s28, 96
    s_cselect_b32 s32, s36, s32
    s_cselect_b32 s33, 6, s33
    s_lshl_b32 s36, s32, 3
    s_add_u32 s36, s36, s33
    s_lshl_b32 s36, s36, 4
    s_add_u32 s36, s36, s30
    s_lshl_b32 s36, s36, 6
    s_add_u32 s75, s36, 23015424
    s_mul_i32 s32, s32, 112
    s_add_u32 s32, s32, s33
    s_lshl_b32 s32, s32, 10
    s_add_u32 s97, s32, s31
    s_branch .Lpdj_6
.Lpd4_5:
    s_sub_u32 s28, s49, 832
    s_and_b32 s29, s28, 7
    s_lshr_b32 s30, s28, 3
    s_mov_b64 s[12:13], s[80:81]
    s_mov_b32 s14, 1835008
    s_mov_b32 s93, 1024
    s_add_u32 s99, s29, 52
    s_cmp_ge_u32 s30, 48
    s_cselect_b32 s98, 1, 0
    s_mul_i32 s94, s29, 56
    s_add_u32 s94, s94, s30
    s_lshl_b32 s94, s94, 12
    s_add_u32 s94, s94, 4980736
    s_add_u32 s95, s94, 1024
    s_add_u32 s96, s94, 2048
    s_add_u32 s97, s94, 3072
.Lpdj_6:
    s_mul_i32 s92, s30, s93
    s_lshl_b32 s92, s92, 5
    s_lshl_b32 s29, s29, 7
    s_add_u32 s92, s92, s29
    s_lshl_b32 s99, s99, 7
    s_add_u32 s99, s99, 7000064
    v_lshrrev_b32 v80, 3, v2
    v_mul_u32_u24 v80, s93, v80
    v_lshrrev_b32 v81, 1, v2
    v_lshrrev_b32 v82, 4, v2
    v_xor_b32 v81, v81, v82
    v_and_b32 v81, 3, v81
    v_lshl_add_u32 v80, v81, 5, v80
    v_and_b32 v81, 1, v2
    v_lshl_add_u32 v80, v81, 4, v80
    s_lshl_b32 s93, s93, 3
    s_add_u32 m0, s100, 0
    s_nop 0
    buffer_load_dwordx4 v80, s[12:15], s92 offen lds
    s_add_u32 s92, s92, s93
    s_add_u32 m0, s100, 1024
    s_nop 0
    buffer_load_dwordx4 v80, s[12:15], s92 offen lds
    s_add_u32 s92, s92, s93
    s_add_u32 m0, s100, 2048
    s_nop 0
    buffer_load_dwordx4 v80, s[12:15], s92 offen lds
    s_add_u32 s92, s92, s93
    s_add_u32 m0, s100, 3072
    s_nop 0
    buffer_load_dwordx4 v80, s[12:15], s92 offen lds
    v_add_u32 v64, s44, v35
    v_add_u32 v65, s44, v36
    s_waitcnt vmcnt(10)
    ds_read_b64 v[224:225], v64 offset:0
    ds_read_b64 v[226:227], v64 offset:1024
    ds_read_b64 v[228:229], v65 offset:0
    s_waitcnt lgkmcnt(8)
    ds_read_b64 v[230:231], v65 offset:1024
    v_add_u32 v68, s44, v39
    s_waitcnt lgkmcnt(0)
    v_mfma_f32_16x16x16_bf16 v[104:107], v[224:225], v[20:21], 0
    v_mfma_f32_16x16x16_bf16 v[108:111], v[226:227], v[20:21], 0
    v_mfma_f32_16x16x16_bf16 v[112:115], v[228:229], v[22:23], 0
    v_mfma_f32_16x16x16_bf16 v[116:119], v[230:231], v[22:23], 0
    v_add_u32 v64, s45, v35
    v_add_u32 v65, s45, v36
    s_waitcnt vmcnt(8)
    ds_read_b64 v[232:233], v64 offset:0
    ds_read_b64 v[234:235], v64 offset:1024
    ds_read_b64 v[236:237], v65 offset:0
    ds_read_b64 v[238:239], v65 offset:1024
    v_cvt_pk_bf16_f32 v224, v104, v105
    v_cvt_pk_bf16_f32 v225, v106, v107
    v_cvt_pk_bf16_f32 v226, v108, v109
    v_cvt_pk_bf16_f32 v227, v110, v111
    ds_write_b128 v68, v[224:227] offset:0
    v_cvt_pk_bf16_f32 v228, v112, v113
    v_cvt_pk_bf16_f32 v229, v114, v115
    v_cvt_pk_bf16_f32 v230, v116, v117
    v_cvt_pk_bf16_f32 v231, v118, v119
    ds_write_b128 v68, v[228:231] offset:64
    v_mfma_f32_16x16x32_bf16 v[136:139], v[224:227], v[16:19], 0
    v_mfma_f32_16x16x32_bf16 v[140:143], v[228:231], v[16:19], 0
    v_add_u32 v68, s45, v39
    s_waitcnt lgkmcnt(2)
    v_mfma_f32_16x16x16_bf16 v[104:107], v[232:233], v[20:21], 0
    v_mfma_f32_16x16x16_bf16 v[108:111], v[234:235], v[20:21], 0
    v_mfma_f32_16x16x16_bf16 v[112:115], v[236:237], v[22:23], 0
    v_mfma_f32_16x16x16_bf16 v[116:119], v[238:239], v[22:23], 0
    v_add_u32 v64, s46, v35
    v_add_u32 v65, s46, v36
    s_waitcnt vmcnt(6)
    ds_read_b64 v[240:241], v64 offset:0
    ds_read_b64 v[242:243], v64 offset:1024
    ds_read_b64 v[244:245], v65 offset:0
    ds_read_b64 v[246:247], v65 offset:1024
    v_cvt_pk_bf16_f32 v232, v104, v105
    v_cvt_pk_bf16_f32 v233, v106, v107
    v_cvt_pk_bf16_f32 v234, v108, v109
    v_cvt_pk_bf16_f32 v235, v110, v111
    ds_write_b128 v68, v[232:235] offset:0
    v_cvt_pk_bf16_f32 v236, v112, v113
    v_cvt_pk_bf16_f32 v237, v114, v115
    v_cvt_pk_bf16_f32 v238, v116, v117
    v_cvt_pk_bf16_f32 v239, v118, v119
    ds_write_b128 v68, v[236:239] offset:64
    v_mfma_f32_16x16x32_bf16 v[136:139], v[232:235], v[16:19], v[136:139]
    v_mfma_f32_16x16x32_bf16 v[140:143], v[236:239], v[16:19], v[140:143]
    v_add_u32 v68, s46, v39
    s_waitcnt lgkmcnt(2)
    v_mfma_f32_16x16x16_bf16 v[104:107], v[240:241], v[20:21], 0
    v_mfma_f32_16x16x16_bf16 v[108:111], v[242:243], v[20:21], 0
    v_mfma_f32_16x16x16_bf16 v[112:115], v[244:245], v[22:23], 0
    v_mfma_f32_16x16x16_bf16 v[116:119], v[246:247], v[22:23], 0
    v_add_u32 v64, s47, v35
    v_add_u32 v65, s47, v36
    s_waitcnt vmcnt(4)
    ds_read_b64 v[248:249], v64 offset:0
    ds_read_b64 v[250:251], v64 offset:1024
    ds_read_b64 v[252:253], v65 offset:0
    ds_read_b64 v[254:255], v65 offset:1024
    v_cvt_pk_bf16_f32 v240, v104, v105
    v_cvt_pk_bf16_f32 v241, v106, v107
    v_cvt_pk_bf16_f32 v242, v108, v109
    v_cvt_pk_bf16_f32 v243, v110, v111
    ds_write_b128 v68, v[240:243] offset:0
    v_cvt_pk_bf16_f32 v244, v112, v113
    v_cvt_pk_bf16_f32 v245, v114, v115
    v_cvt_pk_bf16_f32 v246, v116, v117
    v_cvt_pk_bf16_f32 v247, v118, v119
    ds_write_b128 v68, v[244:247] offset:64
    v_mfma_f32_16x16x32_bf16 v[136:139], v[240:243], v[16:19], v[136:139]
    v_mfma_f32_16x16x32_bf16 v[140:143], v[244:247], v[16:19], v[140:143]
    v_add_u32 v68, s47, v39
    s_waitcnt lgkmcnt(2)
    v_mfma_f32_16x16x16_bf16 v[104:107], v[248:249], v[20:21], 0
    v_mfma_f32_16x16x16_bf16 v[108:111], v[250:251], v[20:21], 0
    v_mfma_f32_16x16x16_bf16 v[112:115], v[252:253], v[22:23], 0
    v_mfma_f32_16x16x16_bf16 v[116:119], v[254:255], v[22:23], 0
    s_nop 4
    v_cvt_pk_bf16_f32 v248, v104, v105
    v_cvt_pk_bf16_f32 v249, v106, v107
    v_cvt_pk_bf16_f32 v250, v108, v109
    v_cvt_pk_bf16_f32 v251, v110, v111
    ds_write_b128 v68, v[248:251] offset:0
    v_cvt_pk_bf16_f32 v252, v112, v113
    v_cvt_pk_bf16_f32 v253, v114, v115
    v_cvt_pk_bf16_f32 v254, v116, v117
    v_cvt_pk_bf16_f32 v255, v118, v119
    ds_write_b128 v68, v[252:255] offset:64
    s_add_u32 s51, s50, 2
    v_mov_b32 v3, s51
    ds_write_b32 v14, v3 offset:16
    v_mfma_f32_16x16x32_bf16 v[136:139], v[248:251], v[16:19], v[136:139]
    v_mfma_f32_16x16x32_bf16 v[140:143], v[252:255], v[16:19], v[140:143]
    v_and_b32 v3, 15, v2
    v_cmp_eq_u32 s[28:29], 1, v3
    v_cmp_eq_u32 s[30:31], 2, v3
    v_cmp_eq_u32 s[32:33], 3, v3
    s_nop 2
    v_cndmask_b32 v136, v136, v137, s[28:29]
    v_cndmask_b32 v136, v136, v138, s[30:31]
    v_cndmask_b32 v136, v136, v139, s[32:33]
    v_cndmask_b32 v140, v140, v141, s[28:29]
    v_cndmask_b32 v140, v140, v142, s[30:31]
    v_cndmask_b32 v140, v140, v143, s[32:33]
    s_mov_b32 exec_lo, 0x000f000f
    s_mov_b32 exec_hi, 0x000f000f
    ds_add_f32 v30, v136 offset:256
    ds_add_f32 v30, v140 offset:272
    s_mov_b64 exec, -1
    v_mov_b32 v3, 2
    ds_write_b32 v14, v3 offset:80
    s_waitcnt lgkmcnt(0)
    s_mul_i32 s52, s19, 98304
    s_add_u32 s52, s52, 0
    s_mul_i32 s53, s17, 65536
    s_add_u32 s53, s53, 1572864
    s_mul_i32 s54, s17, 65536
    s_add_u32 s54, s54, 2097152
    s_mul_i32 s55, s17, 65536
    s_add_u32 s55, s55, 2621440
    s_mul_i32 s56, s19, 114688
    s_add_u32 s56, s56, 3145728
    s_mul_i32 s57, s17, 229376
    s_add_u32 s57, s57, 4980736
    s_add_u32 s51, s50, 1
.Llw_7:
    ds_read_b32 v24, v15 offset:56
    s_waitcnt lgkmcnt(0)
    v_cmp_le_u32 vcc, s51, v24
    s_cbranch_vccnz .Llwd_8
    s_sub_u32 s23, s23, 1
    s_cbranch_scc1 .Lexit_1
    s_sleep 1
    s_branch .Llw_7
.Llwd_8:
    s_lshr_b32 s34, s2, 3
    s_lshl_b32 s34, s34, 2
    s_add_u32 s34, s34, s26
    v_lshlrev_b32 v21, 7, v2
    s_lshl_b32 s37, s26, 10
    s_mov_b32 s64, s40
    s_mov_b32 s65, s41
    s_mov_b32 s66, s42
    s_mov_b32 s67, s43
    s_mov_b32 s68, s44
    s_mov_b32 s69, s45
    s_mov_b32 s70, s46
    s_mov_b32 s71, s47
    v_mov_b32 v28, v39
    v_bfe_u32 v3, v2, 2, 2
    v_lshl_add_u32 v3, v33, 3, v3
    v_mul_u32_u24 v47, 336, v3
    v_and_b32 v3, 3, v2
    s_lshr_b32 s30, s26, 1
    s_and_b32 s31, s26, 1
    s_lshl_b32 s32, s30, 6
    s_lshl_b32 s33, s31, 3
    s_add_u32 s32, s32, s33
    s_add_u32 s32, s32, 98432
    v_lshl_add_u32 v4, v3, 4, v47
    v_add_u32 v4, s32, v4
    s_lshl_b32 s32, s30, 5
    s_add_u32 s32, s32, 98560
    v_lshl_add_u32 v5, v3, 3, v47
    v_add_u32 v5, s32, v5
    s_lshl_b32 s40, s19, 12
    s_add_u32 s40, s40, s37
    s_add_u32 s40, s40, 6860800
    s_lshl_b32 s41, s19, 8
    s_lshl_b32 s33, s30, 7
    s_add_u32 s41, s41, s33
    s_lshl_b32 s31, s31, 4
    s_add_u32 s41, s41, s31
    s_add_u32 s41, s41, 6926336
    s_lshl_b32 s48, s19, 12
    s_add_u32 s48, s48, s37
    s_add_u32 s48, s48, 7025408
    v_lshlrev_b32 v50, 5, v33
    v_lshl_add_u32 v6, v32, 2, v50
    v_mov_b32 v3, 2147483632
    v_cmp_gt_u32 vcc, 4, v32
    s_nop 1
    v_cndmask_b32 v6, v3, v6, vcc
    v_cmp_eq_u32 s[42:43], 1, v32
    v_cmp_eq_u32 s[44:45], 2, v32
    v_cmp_eq_u32 s[46:47], 3, v32
    s_add_u32 s51, s50, 3
.Llw_11:
    ds_read_b128 v[24:27], v15 offset:0
    s_waitcnt lgkmcnt(0)
    v_min_u32 v24, v24, v25
    v_min3_u32 v24, v24, v26, v27
    v_cmp_le_u32 vcc, s51, v24
    s_cbranch_vccnz .Llwd_12
    s_sub_u32 s23, s23, 1
    s_cbranch_scc1 .Lexit_1
    s_sleep 2
    s_branch .Llw_11
.Llwd_12:
    s_add_u32 s51, s50, 1
.Llw_13:
    ds_read_b128 v[24:27], v15 offset:32
    s_waitcnt lgkmcnt(0)
    v_min_u32 v24, v24, v25
    v_min3_u32 v24, v24, v26, v27
    v_cmp_le_u32 vcc, s51, v24
    s_cbranch_vccnz .Llwd_14
    s_sub_u32 s23, s23, 1
    s_cbranch_scc1 .Lexit_1
    s_branch .Llw_13
.Llwd_14:
    s_setprio 3
    ds_read_b64_tr_b16 v[104:105], v4 offset:0
    ds_read_b64_tr_b16 v[120:121], v5 offset:0
    ds_read_b64_tr_b16 v[106:107], v4 offset:1344
    ds_read_b64_tr_b16 v[122:123], v5 offset:1344
    ds_read_b64_tr_b16 v[108:109], v4 offset:10752
    ds_read_b64_tr_b16 v[124:125], v5 offset:10752
    ds_read_b64_tr_b16 v[110:111], v4 offset:12096
    ds_read_b64_tr_b16 v[126:127], v5 offset:12096
    ds_read_b64_tr_b16 v[112:113], v4 offset:21504
    ds_read_b64_tr_b16 v[128:129], v5 offset:21504
    ds_read_b64_tr_b16 v[114:115], v4 offset:22848
    ds_read_b64_tr_b16 v[130:131], v5 offset:22848
    s_waitcnt lgkmcnt(8)
    ds_read_b64_tr_b16 v[116:117], v4 offset:32256
    ds_read_b64_tr_b16 v[132:133], v5 offset:32256
    ds_read_b64_tr_b16 v[118:119], v4 offset:33600
    ds_read_b64_tr_b16 v[134:135], v5 offset:33600
    v_mfma_f32_16x16x32_bf16 v[136:139], v[104:107], v[120:123], 0
    v_mfma_f32_16x16x32_bf16 v[140:143], v[104:107], v[16:19], 0
    s_waitcnt lgkmcnt(8)
    v_mfma_f32_16x16x32_bf16 v[136:139], v[108:111], v[124:127], v[136:139]
    v_mfma_f32_16x16x32_bf16 v[140:143], v[108:111], v[16:19], v[140:143]
    s_waitcnt lgkmcnt(4)
    v_mfma_f32_16x16x32_bf16 v[136:139], v[112:115], v[128:131], v[136:139]
    v_mfma_f32_16x16x32_bf16 v[140:143], v[112:115], v[16:19], v[140:143]
    s_waitcnt lgkmcnt(0)
    v_mfma_f32_16x16x32_bf16 v[136:139], v[116:119], v[132:135], v[136:139]
    v_mfma_f32_16x16x32_bf16 v[140:143], v[116:119], v[16:19], v[140:143]
    s_nop 6
    buffer_atomic_add_f32 v136, v7, s[4:7], s40 offen
    buffer_atomic_add_f32 v137, v7, s[4:7], s40 offen offset:256
    buffer_atomic_add_f32 v138, v7, s[4:7], s40 offen offset:512
    buffer_atomic_add_f32 v139, v7, s[4:7], s40 offen offset:768
    v_cndmask_b32 v140, v140, v141, s[42:43]
    v_cndmask_b32 v140, v140, v142, s[44:45]
    v_cndmask_b32 v140, v140, v143, s[46:47]
    buffer_atomic_add_f32 v140, v6, s[4:7], s41 offen
    s_waitcnt vmcnt(0)
    s_mov_b64 exec, 1
    buffer_atomic_add v8, v7, s[4:7], s48 offen
    s_mov_b64 exec, -1
    s_add_u32 s51, s50, 1
    v_mov_b32 v3, s51
    ds_write_b32 v14, v3 offset:128
    s_setprio 0
    s_cmp_eq_u32 s98, 1
    s_cselect_b32 s28, 8, 4
    s_cselect_b32 s29, 4, 16
    v_lshrrev_b32 v81, 4, v2
    v_mul_u32_u24 v81, s28, v81
    v_bfe_u32 v82, v2, 2, 2
    v_add_u32 v81, v81, v82
    v_and_b32 v82, 3, v2
    v_lshlrev_b32 v82, 3, v82
    v_add_u32 v82, s100, v82
    v_bfe_u32 v83, v81, 1, 2
    v_lshl_add_u32 v83, v83, 5, v82
    v_lshl_add_u32 v83, v81, 7, v83
    v_xor_b32 v84, 0, v83
    ds_read_b64_tr_b16 v[88:89], v84
    v_xor_b32 v84, 32, v83
    ds_read_b64_tr_b16 v[92:93], v84
    v_xor_b32 v84, 64, v83
    ds_read_b64_tr_b16 v[96:97], v84
    v_xor_b32 v84, 96, v83
    ds_read_b64_tr_b16 v[100:101], v84
    v_add_u32 v81, s29, v81
    v_bfe_u32 v83, v81, 1, 2
    v_lshl_add_u32 v83, v83, 5, v82
    v_lshl_add_u32 v83, v81, 7, v83
    v_xor_b32 v84, 0, v83
    ds_read_b64_tr_b16 v[90:91], v84
    v_xor_b32 v84, 32, v83
    ds_read_b64_tr_b16 v[94:95], v84
    v_xor_b32 v84, 64, v83
    ds_read_b64_tr_b16 v[98:99], v84
    v_xor_b32 v84, 96, v83
    ds_read_b64_tr_b16 v[102:103], v84
    s_waitcnt lgkmcnt(0)
    buffer_store_dwordx4 v[88:91], v1, s[4:7], s94 offen sc1
    buffer_store_dwordx4 v[92:95], v1, s[4:7], s95 offen sc1
    buffer_store_dwordx4 v[96:99], v1, s[4:7], s96 offen sc1
    buffer_store_dwordx4 v[100:103], v1, s[4:7], s97 offen sc1
    v_mfma_f32_16x16x32_bf16 v[144:147], v[88:91], v[16:19], 0
    v_mfma_f32_16x16x32_bf16 v[148:151], v[92:95], v[16:19], 0
    v_mfma_f32_16x16x32_bf16 v[152:155], v[96:99], v[16:19], 0
    v_mfma_f32_16x16x32_bf16 v[156:159], v[100:103], v[16:19], 0
    s_sub_u32 s28, s49, 384
    s_cmp_lt_u32 s28, 448
    s_cselect_b32 s72, s72, 25247744
    s_cselect_b32 s73, s73, 25247744
    s_cselect_b32 s74, s74, 25247744
    s_cselect_b32 s75, s75, 25247744
    s_mov_b32 exec_lo, 0x00010001
    s_mov_b32 exec_hi, 0x00010001
    buffer_store_dwordx4 v[144:147], v2, s[4:7], s72 offen sc1
    buffer_store_dwordx4 v[148:151], v2, s[4:7], s73 offen sc1
    buffer_store_dwordx4 v[152:155], v2, s[4:7], s74 offen sc1
    buffer_store_dwordx4 v[156:159], v2, s[4:7], s75 offen sc1
    s_mov_b64 exec, -1
    v_mov_b32 v3, 3
    ds_write_b32 v14, v3 offset:80
    s_waitcnt vmcnt(0)
    s_mov_b64 exec, 1
    buffer_atomic_add v8, v7, s[4:7], s99 offen
    s_mov_b64 exec, -1
    s_cmp_lg_u32 s26, 0
    s_cbranch_scc1 .Lnomode_15
    s_getreg_b32 s30, hwreg(HW_REG_XCC_ID)
    s_and_b32 s30, s30, 15
    s_mul_i32 s31, s30, s30
    s_lshl_b32 s31, s31, 16
    s_lshl_b32 s30, s30, 7
    s_add_u32 s30, s30, s31
    s_add_u32 s58, s30, 1
    s_and_b32 s59, s2, 7
    s_lshl_b32 s59, s59, 7
    s_add_u32 s59, s59, 7010304
    s_mov_b64 exec, 0x1
.Lpoll_16:
    buffer_load_dword v3, v7, s[4:7], s59 offen sc1
.Lpollc_18:
    s_waitcnt vmcnt(0)
    v_and_b32 v22, 127, v3
    v_cmp_le_u32 vcc, 32, v22
    s_nop 0
    s_cmp_eq_u64 vcc, exec
    s_cbranch_scc1 .Lpolld_19
    s_sub_u32 s23, s23, 1
    s_cbranch_scc1 .Lexit_1
    s_sleep 8
    s_branch .Lpoll_16
.Lpolld_19:
    s_mov_b64 exec, -1
    v_readfirstlane_b32 s30, v3
    s_lshl_b32 s31, s58, 5
    s_cmp_eq_u32 s30, s31
    s_cselect_b32 s33, 2, 1
    v_mov_b32 v3, s33
    ds_write_b32 v15, v3 offset:48
    s_waitcnt lgkmcnt(0)
.Lnomode_15:
    s_branch .Llb3_10
.Llloop_9:
    s_add_u32 s51, s50, 1
.Llw_20:
    ds_read_b128 v[24:27], v15 offset:0
    s_waitcnt lgkmcnt(0)
    v_min_u32 v24, v24, v25
    v_min3_u32 v24, v24, v26, v27
    v_cmp_le_u32 vcc, s51, v24
    s_cbranch_vccnz .Llwd_21
    s_sub_u32 s23, s23, 1
    s_cbranch_scc1 .Lexit_1
    s_sleep 2
    s_branch .Llw_20
.Llwd_21:
    v_add_u32 v9, s64, v28
    ds_write_b128 v9, v[160:163] offset:0
    ds_write_b128 v9, v[164:167] offset:64
    v_add_u32 v10, s64, v1
    ds_write_b128 v10, v[168:171] offset:2048
    ds_write_b128 v10, v[172:175] offset:3072
    v_add_u32 v9, s65, v28
    ds_write_b128 v9, v[176:179] offset:0
    ds_write_b128 v9, v[180:183] offset:64
    v_add_u32 v10, s65, v1
    ds_write_b128 v10, v[184:187] offset:2048
    ds_write_b128 v10, v[188:191] offset:3072
    v_add_u32 v9, s66, v28
    ds_write_b128 v9, v[192:195] offset:0
    ds_write_b128 v9, v[196:199] offset:64
    v_add_u32 v10, s66, v1
    ds_write_b128 v10, v[200:203] offset:2048
    ds_write_b128 v10, v[204:207] offset:3072
    v_add_u32 v9, s67, v28
    ds_write_b128 v9, v[208:211] offset:0
    ds_write_b128 v9, v[212:215] offset:64
    v_add_u32 v10, s67, v1
    ds_write_b128 v10, v[216:219] offset:2048
    s_waitcnt lgkmcnt(8)
    ds_write_b128 v10, v[220:223] offset:3072
    s_add_u32 s51, s50, 1
    v_mov_b32 v3, s51
    ds_write_b32 v14, v3 offset:16
    s_add_u32 s51, s50, 2
.Llw_22:
    ds_read_b128 v[24:27], v15 offset:0
    s_waitcnt lgkmcnt(0)
    v_min_u32 v24, v24, v25
    v_min3_u32 v24, v24, v26, v27
    v_cmp_le_u32 vcc, s51, v24
    s_cbranch_vccnz .Llwd_23
    s_sub_u32 s23, s23, 1
    s_cbranch_scc1 .Lexit_1
    s_sleep 2
    s_branch .Llw_22
.Llwd_23:
    v_add_u32 v9, s68, v28
    ds_write_b128 v9, v[224:227] offset:0
    ds_write_b128 v9, v[228:231] offset:64
    v_add_u32 v9, s69, v28
    ds_write_b128 v9, v[232:235] offset:0
    ds_write_b128 v9, v[236:239] offset:64
    v_add_u32 v9, s70, v28
    ds_write_b128 v9, v[240:243] offset:0
    ds_write_b128 v9, v[244:247] offset:64
    v_add_u32 v9, s71, v28
    ds_write_b128 v9, v[248:251] offset:0
    ds_write_b128 v9, v[252:255] offset:64
    s_add_u32 s51, s50, 2
    v_mov_b32 v3, s51
    ds_write_b32 v14, v3 offset:16
    s_add_u32 s51, s50, 3
.Llw_24:
    ds_read_b128 v[24:27], v15 offset:0
    s_waitcnt lgkmcnt(0)
    v_min_u32 v24, v24, v25
    v_min3_u32 v24, v24, v26, v27
    v_cmp_le_u32 vcc, s51, v24
    s_cbranch_vccnz .Llwd_25
    s_sub_u32 s23, s23, 1
    s_cbranch_scc1 .Lexit_1
    s_sleep 2
    s_branch .Llw_24
.Llwd_25:
    s_add_u32 s51, s50, 1
.Llw_26:
    ds_read_b128 v[24:27], v15 offset:32
    s_waitcnt lgkmcnt(0)
    v_min_u32 v24, v24, v25
    v_min3_u32 v24, v24, v26, v27
    v_cmp_le_u32 vcc, s51, v24
    s_cbranch_vccnz .Llwd_27
    s_sub_u32 s23, s23, 1
    s_cbranch_scc1 .Lexit_1
    s_branch .Llw_26
.Llwd_27:
    s_setprio 3
    ds_read_b64_tr_b16 v[160:161], v4 offset:0
    ds_read_b64_tr_b16 v[176:177], v5 offset:0
    ds_read_b64_tr_b16 v[162:163], v4 offset:1344
    ds_read_b64_tr_b16 v[178:179], v5 offset:1344
    ds_read_b64_tr_b16 v[164:165], v4 offset:10752
    ds_read_b64_tr_b16 v[180:181], v5 offset:10752
    ds_read_b64_tr_b16 v[166:167], v4 offset:12096
    ds_read_b64_tr_b16 v[182:183], v5 offset:12096
    ds_read_b64_tr_b16 v[168:169], v4 offset:21504
    ds_read_b64_tr_b16 v[184:185], v5 offset:21504
    ds_read_b64_tr_b16 v[170:171], v4 offset:22848
    ds_read_b64_tr_b16 v[186:187], v5 offset:22848
    s_waitcnt lgkmcnt(8)
    ds_read_b64_tr_b16 v[172:173], v4 offset:32256
    ds_read_b64_tr_b16 v[188:189], v5 offset:32256
    ds_read_b64_tr_b16 v[174:175], v4 offset:33600
    ds_read_b64_tr_b16 v[190:191], v5 offset:33600
    v_mfma_f32_16x16x32_bf16 v[192:195], v[160:163], v[176:179], 0
    v_mfma_f32_16x16x32_bf16 v[196:199], v[160:163], v[16:19], 0
    s_waitcnt lgkmcnt(8)
    v_mfma_f32_16x16x32_bf16 v[192:195], v[164:167], v[180:183], v[192:195]
    v_mfma_f32_16x16x32_bf16 v[196:199], v[164:167], v[16:19], v[196:199]
    s_waitcnt lgkmcnt(4)
    v_mfma_f32_16x16x32_bf16 v[192:195], v[168:171], v[184:187], v[192:195]
    v_mfma_f32_16x16x32_bf16 v[196:199], v[168:171], v[16:19], v[196:199]
    s_waitcnt lgkmcnt(0)
    v_mfma_f32_16x16x32_bf16 v[192:195], v[172:175], v[188:191], v[192:195]
    v_mfma_f32_16x16x32_bf16 v[196:199], v[172:175], v[16:19], v[196:199]
    s_nop 6
    buffer_atomic_add_f32 v192, v7, s[4:7], s40 offen
    buffer_atomic_add_f32 v193, v7, s[4:7], s40 offen offset:256
    buffer_atomic_add_f32 v194, v7, s[4:7], s40 offen offset:512
    buffer_atomic_add_f32 v195, v7, s[4:7], s40 offen offset:768
    v_cndmask_b32 v196, v196, v197, s[42:43]
    v_cndmask_b32 v196, v196, v198, s[44:45]
    v_cndmask_b32 v196, v196, v199, s[46:47]
    buffer_atomic_add_f32 v196, v6, s[4:7], s41 offen
    s_waitcnt vmcnt(0)
    s_mov_b64 exec, 1
    buffer_atomic_add v8, v7, s[4:7], s48 offen
    s_mov_b64 exec, -1
    s_add_u32 s51, s50, 1
    v_mov_b32 v3, s51
    ds_write_b32 v14, v3 offset:128
    s_setprio 0
    s_waitcnt lgkmcnt(0)
.Llb3_10:
    s_cmp_lg_u32 s21, 0
    s_cbranch_scc1 .Lonly_28
    s_lshl_b32 s33, s17, 7
    s_add_u32 s33, s33, 7000064
    v_mul_u32_u24 v23, 8, v21
    s_mov_b64 exec, 0x3
.Lpoll_29:
    buffer_load_dword v3, v23, s[4:7], s33 offen sc1
.Lpollc_31:
    s_waitcnt vmcnt(0)
    v_cmp_le_u32 vcc, 16, v3
    s_nop 0
    s_cmp_eq_u64 vcc, exec
    s_cbranch_scc1 .Lpolld_32
    s_sub_u32 s23, s23, 1
    s_cbranch_scc1 .Lexit_1
    s_sleep 8
    s_branch .Lpoll_29
.Lpolld_32:
    s_mov_b64 exec, -1
    s_mov_b32 s51, 3
.Llw_33:
    ds_read_b128 v[24:27], v15 offset:80
    s_waitcnt lgkmcnt(0)
    v_min_u32 v24, v24, v25
    v_min3_u32 v24, v24, v26, v27
    v_cmp_le_u32 vcc, s51, v24
    s_cbranch_vccnz .Llwd_34
    s_sub_u32 s23, s23, 1
    s_cbranch_scc1 .Lexit_1
    s_sleep 1
    s_branch .Llw_33
.Llwd_34:
.Lonly_28:
    s_add_u32 s51, s50, 3
.Llw_35:
    ds_read_b128 v[24:27], v15 offset:0
    s_waitcnt lgkmcnt(0)
    v_min_u32 v24, v24, v25
    v_min3_u32 v24, v24, v26, v27
    v_cmp_le_u32 vcc, s51, v24
    s_cbranch_vccnz .Llwd_36
    s_sub_u32 s23, s23, 1
    s_cbranch_scc1 .Lexit_1
    s_sleep 2
    s_branch .Llw_35
.Llwd_36:
    s_add_u32 m0, s37, 143360
    s_add_u32 s28, s37, 0
    s_add_u32 s28, s28, s53
    buffer_load_dwordx4 v1, s[4:7], s28 offen sc1 lds
    s_add_u32 m0, s37, 147456
    s_add_u32 s28, s37, 4096
    s_add_u32 s28, s28, s53
    buffer_load_dwordx4 v1, s[4:7], s28 offen sc1 lds
    s_add_u32 m0, s37, 151552
    s_add_u32 s28, s37, 8192
    s_add_u32 s28, s28, s53
    buffer_load_dwordx4 v1, s[4:7], s28 offen sc1 lds
    s_add_u32 m0, s37, 155648
    s_add_u32 s28, s37, 12288
    s_add_u32 s28, s28, s53
    buffer_load_dwordx4 v1, s[4:7], s28 offen sc1 lds
    s_add_u32 m0, s37, 0
    s_add_u32 s28, s37, 16384
    s_add_u32 s28, s28, s53
    buffer_load_dwordx4 v1, s[4:7], s28 offen sc1 lds
    s_add_u32 m0, s37, 4096
    s_add_u32 s28, s37, 20480
    s_add_u32 s28, s28, s53
    buffer_load_dwordx4 v1, s[4:7], s28 offen sc1 lds
    s_add_u32 m0, s37, 8192
    s_add_u32 s28, s37, 24576
    s_add_u32 s28, s28, s53
    buffer_load_dwordx4 v1, s[4:7], s28 offen sc1 lds
    s_add_u32 m0, s37, 12288
    s_add_u32 s28, s37, 28672
    s_add_u32 s28, s28, s53
    buffer_load_dwordx4 v1, s[4:7], s28 offen sc1 lds
    s_add_u32 m0, s37, 16384
    s_add_u32 s28, s37, 32768
    s_add_u32 s28, s28, s53
    buffer_load_dwordx4 v1, s[4:7], s28 offen sc1 lds
    s_add_u32 m0, s37, 20480
    s_add_u32 s28, s37, 36864
    s_add_u32 s28, s28, s53
    buffer_load_dwordx4 v1, s[4:7], s28 offen sc1 lds
    s_add_u32 m0, s37, 24576
    s_add_u32 s28, s37, 40960
    s_add_u32 s28, s28, s53
    buffer_load_dwordx4 v1, s[4:7], s28 offen sc1 lds
    s_add_u32 m0, s37, 28672
    s_add_u32 s28, s37, 45056
    s_add_u32 s28, s28, s53
    buffer_load_dwordx4 v1, s[4:7], s28 offen sc1 lds
    s_add_u32 m0, s37, 32768
    s_add_u32 s28, s37, 49152
    s_add_u32 s28, s28, s53
    buffer_load_dwordx4 v1, s[4:7], s28 offen sc1 lds
    s_add_u32 m0, s37, 36864
    s_add_u32 s28, s37, 53248
    s_add_u32 s28, s28, s53
    buffer_load_dwordx4 v1, s[4:7], s28 offen sc1 lds
    s_add_u32 m0, s37, 40960
    s_add_u32 s28, s37, 57344
    s_add_u32 s28, s28, s53
    buffer_load_dwordx4 v1, s[4:7], s28 offen sc1 lds
    s_add_u32 m0, s37, 45056
    s_add_u32 s28, s37, 61440
    s_add_u32 s28, s28, s53
    buffer_load_dwordx4 v1, s[4:7], s28 offen sc1 lds
    s_add_u32 m0, s37, 49152
    s_add_u32 s28, s37, 0
    s_add_u32 s28, s28, s54
    buffer_load_dwordx4 v1, s[4:7], s28 offen sc1 lds
    s_add_u32 m0, s37, 53248
    s_add_u32 s28, s37, 4096
    s_add_u32 s28, s28, s54
    buffer_load_dwordx4 v1, s[4:7], s28 offen sc1 lds
    s_add_u32 m0, s37, 57344
    s_add_u32 s28, s37, 8192
    s_add_u32 s28, s28, s54
    buffer_load_dwordx4 v1, s[4:7], s28 offen sc1 lds
    s_add_u32 m0, s37, 61440
    s_add_u32 s28, s37, 12288
    s_add_u32 s28, s28, s54
    buffer_load_dwordx4 v1, s[4:7], s28 offen sc1 lds
    s_waitcnt vmcnt(0)
    s_add_u32 s51, s50, 3
    v_mov_b32 v3, s51
    ds_write_b32 v14, v3 offset:16
    s_waitcnt lgkmcnt(0)
    s_cmp_lg_u32 s21, 0
    s_cbranch_scc1 .Lonly_37
    s_lshl_b32 s33, s17, 7
    s_add_u32 s33, s33, 7002112
    v_mul_u32_u24 v23, 0, v21
    s_mov_b64 exec, 0x1
.Lpoll_38:
    buffer_load_dword v3, v23, s[4:7], s33 offen sc1
.Lpollc_40:
    s_waitcnt vmcnt(0)
    v_cmp_le_u32 vcc, 16, v3
    s_nop 0
    s_cmp_eq_u64 vcc, exec
    s_cbranch_scc1 .Lpolld_41
    s_sub_u32 s23, s23, 1
    s_cbranch_scc1 .Lexit_1
    s_sleep 8
    s_branch .Lpoll_38
.Lpolld_41:
    s_mov_b64 exec, -1
.Lonly_37:
    s_add_u32 s51, s50, 1
.Llw_42:
    ds_read_b128 v[24:27], v15 offset:128
    s_waitcnt lgkmcnt(0)
    v_min_u32 v24, v24, v25
    v_min3_u32 v24, v24, v26, v27
    v_cmp_le_u32 vcc, s51, v24
    s_cbranch_vccnz .Llwd_43
    s_sub_u32 s23, s23, 1
    s_cbranch_scc1 .Lexit_1
    s_sleep 1
    s_branch .Llw_42
.Llwd_43:
    s_add_u32 s51, s50, 4
.Llw_44:
    ds_read_b128 v[24:27], v15 offset:0
    s_waitcnt lgkmcnt(0)
    v_min_u32 v24, v24, v25
    v_min3_u32 v24, v24, v26, v27
    v_cmp_le_u32 vcc, s51, v24
    s_cbranch_vccnz .Llwd_45
    s_sub_u32 s23, s23, 1
    s_cbranch_scc1 .Lexit_1
    s_sleep 2
    s_branch .Llw_44
.Llwd_45:
    s_add_u32 m0, s37, 65536
    s_add_u32 s28, s37, 16384
    s_add_u32 s28, s28, s54
    buffer_load_dwordx4 v1, s[4:7], s28 offen sc1 lds
    s_add_u32 m0, s37, 69632
    s_add_u32 s28, s37, 20480
    s_add_u32 s28, s28, s54
    buffer_load_dwordx4 v1, s[4:7], s28 offen sc1 lds
    s_add_u32 m0, s37, 73728
    s_add_u32 s28, s37, 24576
    s_add_u32 s28, s28, s54
    buffer_load_dwordx4 v1, s[4:7], s28 offen sc1 lds
    s_add_u32 m0, s37, 77824
    s_add_u32 s28, s37, 28672
    s_add_u32 s28, s28, s54
    buffer_load_dwordx4 v1, s[4:7], s28 offen sc1 lds
    s_add_u32 m0, s37, 81920
    s_add_u32 s28, s37, 32768
    s_add_u32 s28, s28, s54
    buffer_load_dwordx4 v1, s[4:7], s28 offen sc1 lds
    s_add_u32 m0, s37, 86016
    s_add_u32 s28, s37, 36864
    s_add_u32 s28, s28, s54
    buffer_load_dwordx4 v1, s[4:7], s28 offen sc1 lds
    s_add_u32 m0, s37, 90112
    s_add_u32 s28, s37, 40960
    s_add_u32 s28, s28, s54
    buffer_load_dwordx4 v1, s[4:7], s28 offen sc1 lds
    s_add_u32 m0, s37, 94208
    s_add_u32 s28, s37, 45056
    s_add_u32 s28, s28, s54
    buffer_load_dwordx4 v1, s[4:7], s28 offen sc1 lds
    s_add_u32 m0, s37, 98304
    s_add_u32 s28, s37, 49152
    s_add_u32 s28, s28, s54
    buffer_load_dwordx4 v1, s[4:7], s28 offen sc1 lds
    s_add_u32 m0, s37, 102400
    s_add_u32 s28, s37, 53248
    s_add_u32 s28, s28, s54
    buffer_load_dwordx4 v1, s[4:7], s28 offen sc1 lds
    s_add_u32 m0, s37, 106496
    s_add_u32 s28, s37, 57344
    s_add_u32 s28, s28, s54
    buffer_load_dwordx4 v1, s[4:7], s28 offen sc1 lds
    s_add_u32 m0, s37, 110592
    s_add_u32 s28, s37, 61440
    s_add_u32 s28, s28, s54
    buffer_load_dwordx4 v1, s[4:7], s28 offen sc1 lds
    s_add_u32 m0, s37, 114688
    s_add_u32 s28, s37, 0
    s_add_u32 s28, s28, s55
    buffer_load_dwordx4 v1, s[4:7], s28 offen sc1 lds
    s_add_u32 m0, s37, 118784
    s_add_u32 s28, s37, 4096
    s_add_u32 s28, s28, s55
    buffer_load_dwordx4 v1, s[4:7], s28 offen sc1 lds
    s_add_u32 m0, s37, 122880
    s_add_u32 s28, s37, 8192
    s_add_u32 s28, s28, s55
    buffer_load_dwordx4 v1, s[4:7], s28 offen sc1 lds
    s_add_u32 m0, s37, 126976
    s_add_u32 s28, s37, 12288
    s_add_u32 s28, s28, s55
    buffer_load_dwordx4 v1, s[4:7], s28 offen sc1 lds
    s_add_u32 m0, s37, 131072
    s_add_u32 s28, s37, 16384
    s_add_u32 s28, s28, s55
    buffer_load_dwordx4 v1, s[4:7], s28 offen sc1 lds
    s_add_u32 m0, s37, 135168
    s_add_u32 s28, s37, 20480
    s_add_u32 s28, s28, s55
    buffer_load_dwordx4 v1, s[4:7], s28 offen sc1 lds
    s_add_u32 m0, s37, 139264
    s_add_u32 s28, s37, 24576
    s_add_u32 s28, s28, s55
    buffer_load_dwordx4 v1, s[4:7], s28 offen sc1 lds
    s_waitcnt vmcnt(0)
    s_add_u32 s51, s50, 4
    v_mov_b32 v3, s51
    ds_write_b32 v14, v3 offset:16
    s_waitcnt lgkmcnt(0)
    s_cmp_lg_u32 s21, 0
    s_cbranch_scc1 .Lonly_46
    s_add_u32 s51, s50, 4
.Llw_47:
    ds_read_b128 v[24:27], v15 offset:16
    s_waitcnt lgkmcnt(0)
    v_min_u32 v24, v24, v25
    v_min3_u32 v24, v24, v26, v27
    v_cmp_le_u32 vcc, s51, v24
    s_cbranch_vccnz .Llwd_48
    s_sub_u32 s23, s23, 1
    s_cbranch_scc1 .Lexit_1
    s_sleep 1
    s_branch .Llw_47
.Llwd_48:
    s_mul_i32 s28, s26, 4096
    s_add_u32 s28, s28, 49152
    v_add_u32 v9, s28, v1
    ds_read_b128 v[92:95], v9 offset:0
    ds_read_b128 v[96:99], v9 offset:1024
    ds_read_b128 v[100:103], v9 offset:2048
    ds_read_b128 v[104:107], v9 offset:3072
    s_waitcnt lgkmcnt(0)
    v_mfma_f32_16x16x32_bf16 v[120:123], v[92:95], v[16:19], 0
    v_mfma_f32_16x16x32_bf16 v[124:127], v[96:99], v[16:19], 0
    v_mfma_f32_16x16x32_bf16 v[128:131], v[100:103], v[16:19], 0
    v_mfma_f32_16x16x32_bf16 v[132:135], v[104:107], v[16:19], 0
    s_mul_i32 s28, s26, 4096
    s_add_u32 s28, s28, 65536
    v_add_u32 v9, s28, v1
    ds_read_b128 v[92:95], v9 offset:0
    ds_read_b128 v[96:99], v9 offset:1024
    ds_read_b128 v[100:103], v9 offset:2048
    ds_read_b128 v[104:107], v9 offset:3072
    s_waitcnt lgkmcnt(0)
    v_mfma_f32_16x16x32_bf16 v[120:123], v[92:95], v[16:19], v[120:123]
    v_mfma_f32_16x16x32_bf16 v[124:127], v[96:99], v[16:19], v[124:127]
    v_mfma_f32_16x16x32_bf16 v[128:131], v[100:103], v[16:19], v[128:131]
    v_mfma_f32_16x16x32_bf16 v[132:135], v[104:107], v[16:19], v[132:135]
    s_mul_i32 s28, s26, 4096
    s_add_u32 s28, s28, 81920
    v_add_u32 v9, s28, v1
    ds_read_b128 v[92:95], v9 offset:0
    ds_read_b128 v[96:99], v9 offset:1024
    ds_read_b128 v[100:103], v9 offset:2048
    ds_read_b128 v[104:107], v9 offset:3072
    s_waitcnt lgkmcnt(0)
    v_mfma_f32_16x16x32_bf16 v[120:123], v[92:95], v[16:19], v[120:123]
    v_mfma_f32_16x16x32_bf16 v[124:127], v[96:99], v[16:19], v[124:127]
    v_mfma_f32_16x16x32_bf16 v[128:131], v[100:103], v[16:19], v[128:131]
    v_mfma_f32_16x16x32_bf16 v[132:135], v[104:107], v[16:19], v[132:135]
    s_mul_i32 s28, s26, 4096
    s_add_u32 s28, s28, 98304
    v_add_u32 v9, s28, v1
    ds_read_b128 v[92:95], v9 offset:0
    ds_read_b128 v[96:99], v9 offset:1024
    ds_read_b128 v[100:103], v9 offset:2048
    ds_read_b128 v[104:107], v9 offset:3072
    s_waitcnt lgkmcnt(0)
    v_mfma_f32_16x16x32_bf16 v[120:123], v[92:95], v[16:19], v[120:123]
    v_mfma_f32_16x16x32_bf16 v[124:127], v[96:99], v[16:19], v[124:127]
    v_mfma_f32_16x16x32_bf16 v[128:131], v[100:103], v[16:19], v[128:131]
    v_mfma_f32_16x16x32_bf16 v[132:135], v[104:107], v[16:19], v[132:135]
    v_and_b32 v3, 15, v2
    v_cmp_eq_u32 s[28:29], 1, v3
    v_cmp_eq_u32 s[30:31], 2, v3
    v_cmp_eq_u32 s[32:33], 3, v3
    s_nop 0
    v_cndmask_b32 v120, v120, v121, s[28:29]
    v_cndmask_b32 v120, v120, v122, s[30:31]
    v_cndmask_b32 v120, v120, v123, s[32:33]
    v_cndmask_b32 v124, v124, v125, s[28:29]
    v_cndmask_b32 v124, v124, v126, s[30:31]
    v_cndmask_b32 v124, v124, v127, s[32:33]
    v_cndmask_b32 v128, v128, v129, s[28:29]
    v_cndmask_b32 v128, v128, v130, s[30:31]
    v_cndmask_b32 v128, v128, v131, s[32:33]
    v_cndmask_b32 v132, v132, v133, s[28:29]
    v_cndmask_b32 v132, v132, v134, s[30:31]
    v_cndmask_b32 v132, v132, v135, s[32:33]
    s_mov_b32 exec_lo, 0x000f000f
    s_mov_b32 exec_hi, 0x000f000f
    ds_add_f32 v31, v120 offset:384
    ds_add_f32 v31, v124 offset:448
    ds_add_f32 v31, v128 offset:512
    ds_add_f32 v31, v132 offset:576
    s_mov_b64 exec, -1
    v_mov_b32 v3, 4
    ds_write_b32 v14, v3 offset:80
    s_waitcnt lgkmcnt(0)
    s_mul_i32 s33, s19, 6
    s_lshr_b32 s33, s33, 2
    v_add_u32 v23, s33, v2
    s_lshr_b32 s33, s19, 2
    s_add_u32 s33, s33, 24
    v_writelane_b32 v23, s33, 2
    v_lshlrev_b32 v23, 7, v23
    s_mov_b32 s33, 7003136
    s_mov_b64 exec, 0x7
.Lpoll_49:
    buffer_load_dword v3, v23, s[4:7], s33 offen sc1
.Lpollc_51:
    s_waitcnt vmcnt(0)
    v_cmp_le_u32 vcc, 16, v3
    s_nop 0
    s_cmp_eq_u64 vcc, exec
    s_cbranch_scc1 .Lpolld_52
    s_sub_u32 s23, s23, 1
    s_cbranch_scc1 .Lexit_1
    s_sleep 8
    s_branch .Lpoll_49
.Lpolld_52:
    s_mov_b64 exec, -1
    s_lshl_b32 s33, s19, 13
    s_add_u32 s33, s33, s37
    s_add_u32 s33, s33, 23015424
    s_add_u32 s36, s33, 4096
    s_cmp_eq_u32 s26, 3
    s_cselect_b32 s36, 25247744, s36
    buffer_load_dwordx4 v[144:147], v1, s[4:7], s33 offen sc1
    buffer_load_dwordx4 v[148:151], v1, s[4:7], s36 offen sc1
    s_lshl_b32 s33, s26, 6
    s_add_u32 s33, s33, 160384
    v_and_b32 v9, 0x30, v1
    v_add_u32 v9, s33, v9
    s_waitcnt vmcnt(0)
    v_add_f32_dpp v144, v144, v144 row_ror:4 row_mask:0xf bank_mask:0xf
    v_add_f32_dpp v145, v145, v145 row_ror:4 row_mask:0xf bank_mask:0xf
    v_add_f32_dpp v146, v146, v146 row_ror:4 row_mask:0xf bank_mask:0xf
    v_add_f32_dpp v147, v147, v147 row_ror:4 row_mask:0xf bank_mask:0xf
    v_add_f32_dpp v148, v148, v148 row_ror:4 row_mask:0xf bank_mask:0xf
    v_add_f32_dpp v149, v149, v149 row_ror:4 row_mask:0xf bank_mask:0xf
    v_add_f32_dpp v150, v150, v150 row_ror:4 row_mask:0xf bank_mask:0xf
    v_add_f32_dpp v151, v151, v151 row_ror:4 row_mask:0xf bank_mask:0xf
    v_add_f32_dpp v144, v144, v144 row_ror:8 row_mask:0xf bank_mask:0xf
    v_add_f32_dpp v145, v145, v145 row_ror:8 row_mask:0xf bank_mask:0xf
    v_add_f32_dpp v146, v146, v146 row_ror:8 row_mask:0xf bank_mask:0xf
    v_add_f32_dpp v147, v147, v147 row_ror:8 row_mask:0xf bank_mask:0xf
    v_add_f32_dpp v148, v148, v148 row_ror:8 row_mask:0xf bank_mask:0xf
    v_add_f32_dpp v149, v149, v149 row_ror:8 row_mask:0xf bank_mask:0xf
    v_add_f32_dpp v150, v150, v150 row_ror:8 row_mask:0xf bank_mask:0xf
    v_add_f32_dpp v151, v151, v151 row_ror:8 row_mask:0xf bank_mask:0xf
    v_mov_b32 v152, v144
    v_mov_b32 v153, v145
    v_mov_b32 v154, v146
    v_mov_b32 v155, v147
    v_mov_b32 v156, v148
    v_mov_b32 v157, v149
    v_mov_b32 v158, v150
    v_mov_b32 v159, v151
    v_permlane16_swap_b32 v144, v152
    v_permlane16_swap_b32 v145, v153
    v_permlane16_swap_b32 v146, v154
    v_permlane16_swap_b32 v147, v155
    v_permlane16_swap_b32 v148, v156
    v_permlane16_swap_b32 v149, v157
    v_permlane16_swap_b32 v150, v158
    v_permlane16_swap_b32 v151, v159
    v_add_f32 v144, v144, v152
    v_add_f32 v145, v145, v153
    v_add_f32 v146, v146, v154
    v_add_f32 v147, v147, v155
    v_add_f32 v148, v148, v156
    v_add_f32 v149, v149, v157
    v_add_f32 v150, v150, v158
    v_add_f32 v151, v151, v159
    v_mov_b32 v152, v144
    v_mov_b32 v153, v145
    v_mov_b32 v154, v146
    v_mov_b32 v155, v147
    v_mov_b32 v156, v148
    v_mov_b32 v157, v149
    v_mov_b32 v158, v150
    v_mov_b32 v159, v151
    v_permlane32_swap_b32 v144, v152
    v_permlane32_swap_b32 v145, v153
    v_permlane32_swap_b32 v146, v154
    v_permlane32_swap_b32 v147, v155
    v_permlane32_swap_b32 v148, v156
    v_permlane32_swap_b32 v149, v157
    v_permlane32_swap_b32 v150, v158
    v_permlane32_swap_b32 v151, v159
    v_add_f32 v144, v144, v152
    v_add_f32 v145, v145, v153
    v_add_f32 v146, v146, v154
    v_add_f32 v147, v147, v155
    v_add_f32 v148, v148, v156
    v_add_f32 v149, v149, v157
    v_add_f32 v150, v150, v158
    v_add_f32 v151, v151, v159
    s_mov_b64 exec, 15
    ds_write_b128 v9, v[144:147]
    ds_write_b128 v9, v[148:151] offset:256
    s_mov_b64 exec, -1
    s_waitcnt lgkmcnt(0)
.Lonly_46:
    s_cmp_lg_u32 s21, 0
    s_cbranch_scc1 .Lonly_53
    s_lshl_b32 s33, s17, 7
    s_add_u32 s33, s33, 7006720
    v_mul_u32_u24 v23, 0, v21
    s_mov_b64 exec, 0x1
.Lpoll_54:
    buffer_load_dword v3, v23, s[4:7], s33 offen sc1
.Lpollc_56:
    s_waitcnt vmcnt(0)
    v_cmp_le_u32 vcc, 56, v3
    s_nop 0
    s_cmp_eq_u64 vcc, exec
    s_cbranch_scc1 .Lpolld_57
    s_sub_u32 s23, s23, 1
    s_cbranch_scc1 .Lexit_1
    s_sleep 8
    s_branch .Lpoll_54
.Lpolld_57:
    s_mov_b64 exec, -1
    s_add_u32 s28, s37, s57
    s_add_u32 s28, s28, 159744
    buffer_load_dwordx4 v[92:95], v1, s[4:7], s28 offen sc1
    s_add_u32 s28, s28, 4096
    buffer_load_dwordx4 v[96:99], v1, s[4:7], s28 offen sc1
    s_add_u32 s28, s28, 4096
    buffer_load_dwordx4 v[100:103], v1, s[4:7], s28 offen sc1
    s_add_u32 s28, s28, 4096
    buffer_load_dwordx4 v[104:107], v1, s[4:7], s28 offen sc1
    s_add_u32 s28, s28, 4096
    buffer_load_dwordx4 v[108:111], v1, s[4:7], s28 offen sc1
    s_add_u32 s28, s28, 4096
    buffer_load_dwordx4 v[112:115], v1, s[4:7], s28 offen sc1
    s_add_u32 s28, s28, 4096
    buffer_load_dwordx4 v[116:119], v1, s[4:7], s28 offen sc1
    s_add_u32 s28, s28, 4096
    buffer_load_dwordx4 v[120:123], v1, s[4:7], s28 offen sc1
    s_add_u32 s28, s28, 4096
    buffer_load_dwordx4 v[124:127], v1, s[4:7], s28 offen sc1
    s_add_u32 s28, s28, 4096
    buffer_load_dwordx4 v[128:131], v1, s[4:7], s28 offen sc1
    s_add_u32 s28, s28, 4096
    buffer_load_dwordx4 v[132:135], v1, s[4:7], s28 offen sc1
    s_add_u32 s28, s28, 4096
    buffer_load_dwordx4 v[136:139], v1, s[4:7], s28 offen sc1
    s_add_u32 s28, s28, 4096
    buffer_load_dwordx4 v[140:143], v1, s[4:7], s28 offen sc1
    s_add_u32 s28, s28, 4096
    buffer_load_dwordx4 v[144:147], v1, s[4:7], s28 offen sc1
    s_add_u32 s28, s28, 4096
    buffer_load_dwordx4 v[148:151], v1, s[4:7], s28 offen sc1
    s_add_u32 s28, s28, 4096
    buffer_load_dwordx4 v[152:155], v1, s[4:7], s28 offen sc1
    s_add_u32 s28, s28, 4096
    buffer_load_dwordx4 v[156:159], v1, s[4:7], s28 offen sc1
    s_add_u32 s28, s28, 4096
.Lonly_53:
    s_add_u32 s51, s50, 5
.Llw_58:
    ds_read_b128 v[24:27], v15 offset:0
    s_waitcnt lgkmcnt(0)
    v_min_u32 v24, v24, v25
    v_min3_u32 v24, v24, v26, v27
    v_cmp_le_u32 vcc, s51, v24
    s_cbranch_vccnz .Llwd_59
    s_sub_u32 s23, s23, 1
    s_cbranch_scc1 .Lexit_1
    s_sleep 2
    s_branch .Llw_58
.Llwd_59:
    s_add_u32 m0, s37, 143360
    s_add_u32 s28, s37, 28672
    s_add_u32 s28, s28, s55
    buffer_load_dwordx4 v1, s[4:7], s28 offen sc1 lds
    s_add_u32 m0, s37, 147456
    s_add_u32 s28, s37, 32768
    s_add_u32 s28, s28, s55
    buffer_load_dwordx4 v1, s[4:7], s28 offen sc1 lds
    s_add_u32 m0, s37, 151552
    s_add_u32 s28, s37, 36864
    s_add_u32 s28, s28, s55
    buffer_load_dwordx4 v1, s[4:7], s28 offen sc1 lds
    s_add_u32 m0, s37, 155648
    s_add_u32 s28, s37, 40960
    s_add_u32 s28, s28, s55
    buffer_load_dwordx4 v1, s[4:7], s28 offen sc1 lds
    s_add_u32 m0, s37, 0
    s_add_u32 s28, s37, 45056
    s_add_u32 s28, s28, s55
    buffer_load_dwordx4 v1, s[4:7], s28 offen sc1 lds
    s_add_u32 m0, s37, 4096
    s_add_u32 s28, s37, 49152
    s_add_u32 s28, s28, s55
    buffer_load_dwordx4 v1, s[4:7], s28 offen sc1 lds
    s_add_u32 m0, s37, 8192
    s_add_u32 s28, s37, 53248
    s_add_u32 s28, s28, s55
    buffer_load_dwordx4 v1, s[4:7], s28 offen sc1 lds
    s_add_u32 m0, s37, 12288
    s_add_u32 s28, s37, 57344
    s_add_u32 s28, s28, s55
    buffer_load_dwordx4 v1, s[4:7], s28 offen sc1 lds
    s_add_u32 m0, s37, 16384
    s_add_u32 s28, s37, 61440
    s_add_u32 s28, s28, s55
    buffer_load_dwordx4 v1, s[4:7], s28 offen sc1 lds
    s_add_u32 m0, s37, 21504
    s_add_u32 s28, s37, 0
    s_add_u32 s28, s28, s56
    buffer_load_dwordx4 v1, s[4:7], s28 offen sc1 lds
    s_add_u32 m0, s37, 25600
    s_add_u32 s28, s37, 4096
    s_add_u32 s28, s28, s56
    buffer_load_dwordx4 v1, s[4:7], s28 offen sc1 lds
    s_add_u32 m0, s37, 29696
    s_add_u32 s28, s37, 8192
    s_add_u32 s28, s28, s56
    buffer_load_dwordx4 v1, s[4:7], s28 offen sc1 lds
    s_add_u32 m0, s37, 33792
    s_add_u32 s28, s37, 12288
    s_add_u32 s28, s28, s56
    buffer_load_dwordx4 v1, s[4:7], s28 offen sc1 lds
    s_add_u32 m0, s37, 37888
    s_add_u32 s28, s37, 16384
    s_add_u32 s28, s28, s56
    buffer_load_dwordx4 v1, s[4:7], s28 offen sc1 lds
    s_min_u32 s28, s37, 0
    s_add_u32 m0, s28, 41984
    s_add_u32 s28, s28, 20480
    s_add_u32 s28, s28, s56
    buffer_load_dwordx4 v1, s[4:7], s28 offen sc1 lds
    s_cmp_lg_u32 s21, 0
    s_cbranch_scc1 .Lonly_60
.Lonly_60:
    s_waitcnt vmcnt(0)
    s_add_u32 s51, s50, 5
    v_mov_b32 v3, s51
    ds_write_b32 v14, v3 offset:16
    v_add_u32 v9, s37, v1
    v_add_u32 v9, 43008, v9
    s_waitcnt lgkmcnt(0)
    s_cmp_lg_u32 s21, 1
    s_cbranch_scc1 .Lonly_61
    s_add_u32 s51, s50, 1
.Llw_62:
    ds_read_b128 v[24:27], v15 offset:64
    s_waitcnt lgkmcnt(0)
    v_min_u32 v24, v24, v25
    v_min3_u32 v24, v24, v26, v27
    v_cmp_le_u32 vcc, s51, v24
    s_cbranch_vccnz .Llwd_63
    s_sub_u32 s23, s23, 1
    s_cbranch_scc1 .Lexit_1
    s_sleep 2
    s_branch .Llw_62
.Llwd_63:
    ds_write_b128 v9, v[32:35] offset:0
    ds_write_b128 v9, v[36:39] offset:4096
    ds_write_b128 v9, v[40:43] offset:8192
    ds_write_b128 v9, v[44:47] offset:12288
    ds_write_b128 v9, v[48:51] offset:16384
    ds_write_b128 v9, v[52:55] offset:20480
    ds_write_b128 v9, v[56:59] offset:24576
    ds_write_b128 v9, v[60:63] offset:28672
    ds_write_b128 v9, v[64:67] offset:32768
    ds_write_b128 v9, v[68:71] offset:36864
    ds_write_b128 v9, v[72:75] offset:40960
    ds_write_b128 v9, v[76:79] offset:45056
    ds_write_b128 v9, v[80:83] offset:49152
    ds_write_b128 v9, v[84:87] offset:53248
    ds_write_b128 v9, v[88:91] offset:57344
    s_waitcnt lgkmcnt(0)
.Lonly_61:
    s_add_u32 s51, s50, 6
.Llw_64:
    ds_read_b128 v[24:27], v15 offset:0
    s_waitcnt lgkmcnt(0)
    v_min_u32 v24, v24, v25
    v_min3_u32 v24, v24, v26, v27
    v_cmp_le_u32 vcc, s51, v24
    s_cbranch_vccnz .Llwd_65
    s_sub_u32 s23, s23, 1
    s_cbranch_scc1 .Lexit_1
    s_sleep 2
    s_branch .Llw_64
.Llwd_65:
    s_add_u32 m0, s37, 104448
    s_add_u32 s28, s37, 82944
    s_add_u32 s28, s28, s56
    buffer_load_dwordx4 v1, s[4:7], s28 offen sc1 lds
    s_add_u32 m0, s37, 108544
    s_add_u32 s28, s37, 87040
    s_add_u32 s28, s28, s56
    buffer_load_dwordx4 v1, s[4:7], s28 offen sc1 lds
    s_min_u32 s28, s37, 1024
    s_add_u32 m0, s28, 112640
    s_add_u32 s28, s28, 91136
    s_add_u32 s28, s28, s56
    buffer_load_dwordx4 v1, s[4:7], s28 offen sc1 lds
    s_cmp_lg_u32 s21, 0
    s_cbranch_scc1 .Lonly_66
    s_add_u32 m0, s37, 43008
    s_add_u32 s28, s37, 21504
    s_add_u32 s28, s28, s56
    buffer_load_dwordx4 v1, s[4:7], s28 offen sc1 lds
    s_add_u32 m0, s37, 47104
    s_add_u32 s28, s37, 25600
    s_add_u32 s28, s28, s56
    buffer_load_dwordx4 v1, s[4:7], s28 offen sc1 lds
    s_add_u32 m0, s37, 51200
    s_add_u32 s28, s37, 29696
    s_add_u32 s28, s28, s56
    buffer_load_dwordx4 v1, s[4:7], s28 offen sc1 lds
    s_add_u32 m0, s37, 55296
    s_add_u32 s28, s37, 33792
    s_add_u32 s28, s28, s56
    buffer_load_dwordx4 v1, s[4:7], s28 offen sc1 lds
    s_add_u32 m0, s37, 59392
    s_add_u32 s28, s37, 37888
    s_add_u32 s28, s28, s56
    buffer_load_dwordx4 v1, s[4:7], s28 offen sc1 lds
    s_add_u32 m0, s37, 63488
    s_add_u32 s28, s37, 41984
    s_add_u32 s28, s28, s56
    buffer_load_dwordx4 v1, s[4:7], s28 offen sc1 lds
    s_add_u32 m0, s37, 67584
    s_add_u32 s28, s37, 46080
    s_add_u32 s28, s28, s56
    buffer_load_dwordx4 v1, s[4:7], s28 offen sc1 lds
    s_add_u32 m0, s37, 71680
    s_add_u32 s28, s37, 50176
    s_add_u32 s28, s28, s56
    buffer_load_dwordx4 v1, s[4:7], s28 offen sc1 lds
    s_add_u32 m0, s37, 75776
    s_add_u32 s28, s37, 54272
    s_add_u32 s28, s28, s56
    buffer_load_dwordx4 v1, s[4:7], s28 offen sc1 lds
    s_add_u32 m0, s37, 79872
    s_add_u32 s28, s37, 58368
    s_add_u32 s28, s28, s56
    buffer_load_dwordx4 v1, s[4:7], s28 offen sc1 lds
    s_add_u32 m0, s37, 83968
    s_add_u32 s28, s37, 62464
    s_add_u32 s28, s28, s56
    buffer_load_dwordx4 v1, s[4:7], s28 offen sc1 lds
    s_add_u32 m0, s37, 88064
    s_add_u32 s28, s37, 66560
    s_add_u32 s28, s28, s56
    buffer_load_dwordx4 v1, s[4:7], s28 offen sc1 lds
    s_add_u32 m0, s37, 92160
    s_add_u32 s28, s37, 70656
    s_add_u32 s28, s28, s56
    buffer_load_dwordx4 v1, s[4:7], s28 offen sc1 lds
    s_add_u32 m0, s37, 96256
    s_add_u32 s28, s37, 74752
    s_add_u32 s28, s28, s56
    buffer_load_dwordx4 v1, s[4:7], s28 offen sc1 lds
    s_add_u32 m0, s37, 100352
    s_add_u32 s28, s37, 78848
    s_add_u32 s28, s28, s56
    buffer_load_dwordx4 v1, s[4:7], s28 offen sc1 lds
.Lonly_66:
    s_waitcnt vmcnt(0)
    s_add_u32 s51, s50, 6
    v_mov_b32 v3, s51
    ds_write_b32 v14, v3 offset:16
    s_waitcnt lgkmcnt(0)
    s_cmp_lg_u32 s21, 0
    s_cbranch_scc1 .Lonly_67
    ds_read_b128 v[32:35], v9 offset:0
    ds_read_b128 v[36:39], v9 offset:4096
    ds_read_b128 v[40:43], v9 offset:8192
    ds_read_b128 v[44:47], v9 offset:12288
    ds_read_b128 v[48:51], v9 offset:16384
    ds_read_b128 v[52:55], v9 offset:20480
    ds_read_b128 v[56:59], v9 offset:24576
    ds_read_b128 v[60:63], v9 offset:28672
    ds_read_b128 v[64:67], v9 offset:32768
    ds_read_b128 v[68:71], v9 offset:36864
    ds_read_b128 v[72:75], v9 offset:40960
    ds_read_b128 v[76:79], v9 offset:45056
    ds_read_b128 v[80:83], v9 offset:49152
    ds_read_b128 v[84:87], v9 offset:53248
    ds_read_b128 v[88:91], v9 offset:57344
    v_mov_b32 v3, 5
    s_waitcnt lgkmcnt(8)
    ds_write_b32 v14, v3 offset:80
    s_waitcnt lgkmcnt(0)
.Lonly_67:
    s_add_u32 s51, s50, 7
.Llw_68:
    ds_read_b128 v[24:27], v15 offset:0
    s_waitcnt lgkmcnt(0)
    v_min_u32 v24, v24, v25
    v_min3_u32 v24, v24, v26, v27
    v_cmp_le_u32 vcc, s51, v24
    s_cbranch_vccnz .Llwd_69
    s_sub_u32 s23, s23, 1
    s_cbranch_scc1 .Lexit_1
    s_sleep 2
    s_branch .Llw_68
.Llwd_69:
    s_add_u32 m0, s37, 0
    s_add_u32 s28, s37, 93184
    s_add_u32 s28, s28, s56
    buffer_load_dwordx4 v1, s[4:7], s28 offen sc1 lds
    s_add_u32 m0, s37, 4096
    s_add_u32 s28, s37, 97280
    s_add_u32 s28, s28, s56
    buffer_load_dwordx4 v1, s[4:7], s28 offen sc1 lds
    s_add_u32 m0, s37, 8192
    s_add_u32 s28, s37, 101376
    s_add_u32 s28, s28, s56
    buffer_load_dwordx4 v1, s[4:7], s28 offen sc1 lds
    s_add_u32 m0, s37, 12288
    s_add_u32 s28, s37, 105472
    s_add_u32 s28, s28, s56
    buffer_load_dwordx4 v1, s[4:7], s28 offen sc1 lds
    s_add_u32 m0, s37, 16384
    s_add_u32 s28, s37, 109568
    s_add_u32 s28, s28, s56
    buffer_load_dwordx4 v1, s[4:7], s28 offen sc1 lds
    s_min_u32 s28, s37, 0
    s_add_u32 m0, s28, 20480
    s_add_u32 s28, s28, 113664
    s_add_u32 s28, s28, s56
    buffer_load_dwordx4 v1, s[4:7], s28 offen sc1 lds
    s_waitcnt vmcnt(0)
    s_add_u32 s51, s50, 7
    v_mov_b32 v3, s51
    ds_write_b32 v14, v3 offset:16
    s_add_u32 s51, s50, 2
.Llw_70:
    ds_read_b128 v[24:27], v15 offset:64
    s_waitcnt lgkmcnt(0)
    v_min_u32 v24, v24, v25
    v_min3_u32 v24, v24, v26, v27
    v_cmp_le_u32 vcc, s51, v24
    s_cbranch_vccnz .Llwd_71
    s_sub_u32 s23, s23, 1
    s_cbranch_scc1 .Lexit_1
    s_sleep 2
    s_branch .Llw_70
.Llwd_71:
    s_add_u32 m0, s37, 114688
    s_add_u32 s28, s37, 0
    s_add_u32 s28, s28, s57
    buffer_load_dwordx4 v1, s[4:7], s28 offen sc1 lds
    s_add_u32 m0, s37, 118784
    s_add_u32 s28, s37, 4096
    s_add_u32 s28, s28, s57
    buffer_load_dwordx4 v1, s[4:7], s28 offen sc1 lds
    s_add_u32 m0, s37, 122880
    s_add_u32 s28, s37, 8192
    s_add_u32 s28, s28, s57
    buffer_load_dwordx4 v1, s[4:7], s28 offen sc1 lds
    s_add_u32 m0, s37, 126976
    s_add_u32 s28, s37, 12288
    s_add_u32 s28, s28, s57
    buffer_load_dwordx4 v1, s[4:7], s28 offen sc1 lds
    s_add_u32 m0, s37, 131072
    s_add_u32 s28, s37, 16384
    s_add_u32 s28, s28, s57
    buffer_load_dwordx4 v1, s[4:7], s28 offen sc1 lds
    s_add_u32 m0, s37, 135168
    s_add_u32 s28, s37, 20480
    s_add_u32 s28, s28, s57
    buffer_load_dwordx4 v1, s[4:7], s28 offen sc1 lds
    s_add_u32 m0, s37, 139264
    s_add_u32 s28, s37, 24576
    s_add_u32 s28, s28, s57
    buffer_load_dwordx4 v1, s[4:7], s28 offen sc1 lds
    s_add_u32 m0, s37, 143360
    s_add_u32 s28, s37, 28672
    s_add_u32 s28, s28, s57
    buffer_load_dwordx4 v1, s[4:7], s28 offen sc1 lds
    s_add_u32 m0, s37, 147456
    s_add_u32 s28, s37, 32768
    s_add_u32 s28, s28, s57
    buffer_load_dwordx4 v1, s[4:7], s28 offen sc1 lds
    s_add_u32 m0, s37, 151552
    s_add_u32 s28, s37, 36864
    s_add_u32 s28, s28, s57
    buffer_load_dwordx4 v1, s[4:7], s28 offen sc1 lds
    s_add_u32 m0, s37, 155648
    s_add_u32 s28, s37, 40960
    s_add_u32 s28, s28, s57
    buffer_load_dwordx4 v1, s[4:7], s28 offen sc1 lds
    s_waitcnt vmcnt(0)
    s_add_u32 s51, s50, 8
    v_mov_b32 v3, s51
    ds_write_b32 v14, v3 offset:16
    s_add_u32 s51, s50, 8
.Llw_72:
    ds_read_b128 v[24:27], v15 offset:0
    s_waitcnt lgkmcnt(0)
    v_min_u32 v24, v24, v25
    v_min3_u32 v24, v24, v26, v27
    v_cmp_le_u32 vcc, s51, v24
    s_cbranch_vccnz .Llwd_73
    s_sub_u32 s23, s23, 1
    s_cbranch_scc1 .Lexit_1
    s_sleep 2
    s_branch .Llw_72
.Llwd_73:
    s_mov_b32 s51, 5
.Llw_74:
    ds_read_b128 v[24:27], v15 offset:80
    s_waitcnt lgkmcnt(0)
    v_min_u32 v24, v24, v25
    v_min3_u32 v24, v24, v26, v27
    v_cmp_le_u32 vcc, s51, v24
    s_cbranch_vccnz .Llwd_75
    s_sub_u32 s23, s23, 1
    s_cbranch_scc1 .Lexit_1
    s_sleep 1
    s_branch .Llw_74
.Llwd_75:
    s_add_u32 m0, s37, 24576
    s_add_u32 s28, s37, 94208
    s_add_u32 s28, s28, s57
    buffer_load_dwordx4 v1, s[4:7], s28 offen sc1 lds
    s_add_u32 m0, s37, 28672
    s_add_u32 s28, s37, 98304
    s_add_u32 s28, s28, s57
    buffer_load_dwordx4 v1, s[4:7], s28 offen sc1 lds
    s_add_u32 m0, s37, 32768
    s_add_u32 s28, s37, 102400
    s_add_u32 s28, s28, s57
    buffer_load_dwordx4 v1, s[4:7], s28 offen sc1 lds
    s_add_u32 m0, s37, 36864
    s_add_u32 s28, s37, 106496
    s_add_u32 s28, s28, s57
    buffer_load_dwordx4 v1, s[4:7], s28 offen sc1 lds
    s_add_u32 m0, s37, 40960
    s_add_u32 s28, s37, 110592
    s_add_u32 s28, s28, s57
    buffer_load_dwordx4 v1, s[4:7], s28 offen sc1 lds
    s_add_u32 m0, s37, 45056
    s_add_u32 s28, s37, 114688
    s_add_u32 s28, s28, s57
    buffer_load_dwordx4 v1, s[4:7], s28 offen sc1 lds
    s_add_u32 m0, s37, 49152
    s_add_u32 s28, s37, 118784
    s_add_u32 s28, s28, s57
    buffer_load_dwordx4 v1, s[4:7], s28 offen sc1 lds
    s_add_u32 m0, s37, 53248
    s_add_u32 s28, s37, 122880
    s_add_u32 s28, s28, s57
    buffer_load_dwordx4 v1, s[4:7], s28 offen sc1 lds
    s_add_u32 m0, s37, 57344
    s_add_u32 s28, s37, 126976
    s_add_u32 s28, s28, s57
    buffer_load_dwordx4 v1, s[4:7], s28 offen sc1 lds
    s_add_u32 m0, s37, 61440
    s_add_u32 s28, s37, 131072
    s_add_u32 s28, s28, s57
    buffer_load_dwordx4 v1, s[4:7], s28 offen sc1 lds
    s_add_u32 m0, s37, 65536
    s_add_u32 s28, s37, 135168
    s_add_u32 s28, s28, s57
    buffer_load_dwordx4 v1, s[4:7], s28 offen sc1 lds
    s_add_u32 m0, s37, 69632
    s_add_u32 s28, s37, 139264
    s_add_u32 s28, s28, s57
    buffer_load_dwordx4 v1, s[4:7], s28 offen sc1 lds
    s_add_u32 m0, s37, 73728
    s_add_u32 s28, s37, 143360
    s_add_u32 s28, s28, s57
    buffer_load_dwordx4 v1, s[4:7], s28 offen sc1 lds
    s_add_u32 m0, s37, 77824
    s_add_u32 s28, s37, 147456
    s_add_u32 s28, s28, s57
    buffer_load_dwordx4 v1, s[4:7], s28 offen sc1 lds
    s_add_u32 m0, s37, 81920
    s_add_u32 s28, s37, 151552
    s_add_u32 s28, s28, s57
    buffer_load_dwordx4 v1, s[4:7], s28 offen sc1 lds
    s_cmp_lg_u32 s21, 0
    s_cbranch_scc1 .Lonly_76
.Lonly_76:
    s_add_u32 s51, s50, 9
.Llw_77:
    ds_read_b128 v[24:27], v15 offset:0
    s_waitcnt lgkmcnt(0)
    v_min_u32 v24, v24, v25
    v_min3_u32 v24, v24, v26, v27
    v_cmp_le_u32 vcc, s51, v24
    s_cbranch_vccnz .Llwd_78
    s_sub_u32 s23, s23, 1
    s_cbranch_scc1 .Lexit_1
    s_sleep 2
    s_branch .Llw_77
.Llwd_78:
    s_add_u32 m0, s37, 90112
    s_add_u32 s28, s37, 45056
    s_add_u32 s28, s28, s57
    buffer_load_dwordx4 v1, s[4:7], s28 offen sc1 lds
    s_add_u32 m0, s37, 94208
    s_add_u32 s28, s37, 49152
    s_add_u32 s28, s28, s57
    buffer_load_dwordx4 v1, s[4:7], s28 offen sc1 lds
    s_add_u32 m0, s37, 98304
    s_add_u32 s28, s37, 53248
    s_add_u32 s28, s28, s57
    buffer_load_dwordx4 v1, s[4:7], s28 offen sc1 lds
    s_add_u32 m0, s37, 102400
    s_add_u32 s28, s37, 57344
    s_add_u32 s28, s28, s57
    buffer_load_dwordx4 v1, s[4:7], s28 offen sc1 lds
    s_add_u32 m0, s37, 106496
    s_add_u32 s28, s37, 61440
    s_add_u32 s28, s28, s57
    buffer_load_dwordx4 v1, s[4:7], s28 offen sc1 lds
    s_add_u32 m0, s37, 110592
    s_add_u32 s28, s37, 65536
    s_add_u32 s28, s28, s57
    buffer_load_dwordx4 v1, s[4:7], s28 offen sc1 lds
    s_add_u32 m0, s37, 0
    s_add_u32 s28, s37, 69632
    s_add_u32 s28, s28, s57
    buffer_load_dwordx4 v1, s[4:7], s28 offen sc1 lds
    s_add_u32 m0, s37, 4096
    s_add_u32 s28, s37, 73728
    s_add_u32 s28, s28, s57
    buffer_load_dwordx4 v1, s[4:7], s28 offen sc1 lds
    s_add_u32 m0, s37, 8192
    s_add_u32 s28, s37, 77824
    s_add_u32 s28, s28, s57
    buffer_load_dwordx4 v1, s[4:7], s28 offen sc1 lds
    s_add_u32 m0, s37, 12288
    s_add_u32 s28, s37, 81920
    s_add_u32 s28, s28, s57
    buffer_load_dwordx4 v1, s[4:7], s28 offen sc1 lds
    s_add_u32 m0, s37, 16384
    s_add_u32 s28, s37, 86016
    s_add_u32 s28, s28, s57
    buffer_load_dwordx4 v1, s[4:7], s28 offen sc1 lds
    s_add_u32 m0, s37, 20480
    s_add_u32 s28, s37, 90112
    s_add_u32 s28, s28, s57
    buffer_load_dwordx4 v1, s[4:7], s28 offen sc1 lds
    s_add_u32 m0, s37, 86016
    s_add_u32 s28, s37, 155648
    s_add_u32 s28, s28, s57
    buffer_load_dwordx4 v1, s[4:7], s28 offen sc1 lds
    s_waitcnt vmcnt(0)
    s_add_u32 s51, s50, 9
    v_mov_b32 v3, s51
    ds_write_b32 v14, v3 offset:16
    v_add_u32 v9, s37, v1
    v_add_u32 v9, 90112, v9
    v_add_u32 v10, 32768, v9
    s_add_u32 s51, s50, 3
.Llw_79:
    ds_read_b128 v[24:27], v15 offset:64
    s_waitcnt lgkmcnt(0)
    v_min_u32 v24, v24, v25
    v_min3_u32 v24, v24, v26, v27
    v_cmp_le_u32 vcc, s51, v24
    s_cbranch_vccnz .Llwd_80
    s_sub_u32 s23, s23, 1
    s_cbranch_scc1 .Lexit_1
    s_sleep 1
    s_branch .Llw_79
.Llwd_80:
    s_setprio 3
    ds_write_b128 v9, v[92:95] offset:24576
    ds_write_b128 v9, v[96:99] offset:28672
    ds_write_b128 v10, v[100:103] offset:0
    ds_write_b128 v10, v[104:107] offset:4096
    ds_write_b128 v10, v[108:111] offset:8192
    ds_write_b128 v10, v[112:115] offset:12288
    ds_write_b128 v10, v[116:119] offset:16384
    ds_write_b128 v10, v[120:123] offset:20480
    ds_write_b128 v10, v[124:127] offset:24576
    s_setprio 0
    s_add_u32 s51, s50, 10
.Llw_81:
    ds_read_b128 v[24:27], v15 offset:0
    s_waitcnt lgkmcnt(0)
    v_min_u32 v24, v24, v25
    v_min3_u32 v24, v24, v26, v27
    v_cmp_le_u32 vcc, s51, v24
    s_cbranch_vccnz .Llwd_82
    s_sub_u32 s23, s23, 1
    s_cbranch_scc1 .Lexit_1
    s_sleep 1
    s_branch .Llw_81
.Llwd_82:
    s_setprio 3
    ds_write_b128 v10, v[128:131] offset:28672
    ds_write_b128 v10, v[132:135] offset:32768
    ds_write_b128 v9, v[136:139] offset:0
    ds_write_b128 v9, v[140:143] offset:4096
    ds_write_b128 v9, v[144:147] offset:8192
    ds_write_b128 v9, v[148:151] offset:12288
    ds_write_b128 v9, v[152:155] offset:16384
    ds_write_b128 v9, v[156:159] offset:20480
    s_add_u32 s51, s50, 10
    v_mov_b32 v3, s51
    ds_write_b32 v14, v3 offset:16
    s_setprio 0
    s_waitcnt lgkmcnt(0)
    s_add_u32 s50, s50, 10
    s_add_u32 s40, s40, 69632
    s_add_u32 s41, s41, 69632
    s_add_u32 s48, s48, 64
    s_add_u32 s21, s21, 1
    s_cmp_lt_u32 s21, 2
    s_cbranch_scc1 .Llloop_9
    s_endpgm
.Lcompute_3:
    s_setprio 2
    s_lshl_b32 s18, s18, 3
    s_lshl_b32 s26, s8, 1
    s_add_u32 s18, s18, s26
    s_cmp_lt_u32 s2, 32
    s_cselect_b32 s58, s8, 0
    s_cmp_lg_u32 s58, 3
    s_cbranch_scc1 .Lnz_83
    v_mov_b32 v28, 0
    v_mov_b32 v29, 0
    v_mov_b32 v30, 0
    v_mov_b32 v31, 0
    s_mul_i32 s28, s2, 5120
    s_add_u32 s28, s28, 6860800
    s_add_u32 s29, s28, 4096
    s_and_b32 s30, s2, 7
    s_lshl_b32 s30, s30, 14
    s_lshr_b32 s31, s2, 3
    s_lshl_b32 s31, s31, 12
    s_add_u32 s30, s30, s31
    s_add_u32 s30, s30, 7024640
    buffer_store_dwordx4 v[28:31], v1, s[4:7], s28 offen offset:0 sc1
    buffer_store_dwordx4 v[28:31], v1, s[4:7], s28 offen offset:1024 sc1
    buffer_store_dwordx4 v[28:31], v1, s[4:7], s28 offen offset:2048 sc1
    buffer_store_dwordx4 v[28:31], v1, s[4:7], s28 offen offset:3072 sc1
    buffer_store_dwordx4 v[28:31], v1, s[4:7], s29 offen offset:0 sc1
    buffer_store_dwordx4 v[28:31], v1, s[4:7], s30 offen offset:0 sc1
    buffer_store_dwordx4 v[28:31], v1, s[4:7], s30 offen offset:1024 sc1
    buffer_store_dwordx4 v[28:31], v1, s[4:7], s30 offen offset:2048 sc1
    buffer_store_dwordx4 v[28:31], v1, s[4:7], s30 offen offset:3072 sc1
    v_mov_b32 v3, 1
    s_waitcnt vmcnt(0)
    s_mov_b64 exec, 1
    buffer_atomic_add v3, v7, s[88:91], 0 offen
    s_mov_b64 exec, -1
.Lnz_83:
    s_nop 0
    s_mov_b64 s[12:13], s[64:65]
    s_mov_b32 s14, 2097152
    v_lshrrev_b32 v3, 4, v2
    v_and_b32 v10, 0xf0, v1
    v_lshl_add_u32 v10, v3, 10, v10
    s_lshl_b32 s92, s18, 14
    s_add_u32 s93, s92, 4096
    s_add_u32 s94, s92, 8192
    s_add_u32 s95, s92, 12288
    s_add_u32 s96, s92, 16384
    s_add_u32 s97, s92, 20480
    s_add_u32 s98, s92, 24576
    s_add_u32 s99, s92, 28672
    buffer_load_dwordx4 v[128:131], v10, s[12:15], s92 offen
    buffer_load_dwordx4 v[132:135], v10, s[12:15], s93 offen
    buffer_load_dwordx4 v[136:139], v10, s[12:15], s94 offen
    buffer_load_dwordx4 v[140:143], v10, s[12:15], s95 offen
    buffer_load_dwordx4 v[144:147], v10, s[12:15], s96 offen
    buffer_load_dwordx4 v[148:151], v10, s[12:15], s97 offen
    buffer_load_dwordx4 v[152:155], v10, s[12:15], s98 offen
    buffer_load_dwordx4 v[156:159], v10, s[12:15], s99 offen
    buffer_load_dwordx4 v[160:163], v10, s[12:15], s92 offen offset:256
    buffer_load_dwordx4 v[164:167], v10, s[12:15], s93 offen offset:256
    buffer_load_dwordx4 v[168:171], v10, s[12:15], s94 offen offset:256
    buffer_load_dwordx4 v[172:175], v10, s[12:15], s95 offen offset:256
    buffer_load_dwordx4 v[176:179], v10, s[12:15], s96 offen offset:256
    buffer_load_dwordx4 v[180:183], v10, s[12:15], s97 offen offset:256
    buffer_load_dwordx4 v[184:187], v10, s[12:15], s98 offen offset:256
    buffer_load_dwordx4 v[188:191], v10, s[12:15], s99 offen offset:256
    buffer_load_dwordx4 v[192:195], v10, s[12:15], s92 offen offset:512
    buffer_load_dwordx4 v[196:199], v10, s[12:15], s93 offen offset:512
    buffer_load_dwordx4 v[200:203], v10, s[12:15], s94 offen offset:512
    buffer_load_dwordx4 v[204:207], v10, s[12:15], s95 offen offset:512
    buffer_load_dwordx4 v[208:211], v10, s[12:15], s96 offen offset:512
    buffer_load_dwordx4 v[212:215], v10, s[12:15], s97 offen offset:512
    buffer_load_dwordx4 v[216:219], v10, s[12:15], s98 offen offset:512
    buffer_load_dwordx4 v[220:223], v10, s[12:15], s99 offen offset:512
    buffer_load_dwordx4 v[224:227], v10, s[12:15], s92 offen offset:768
    buffer_load_dwordx4 v[228:231], v10, s[12:15], s93 offen offset:768
    buffer_load_dwordx4 v[232:235], v10, s[12:15], s94 offen offset:768
    buffer_load_dwordx4 v[236:239], v10, s[12:15], s95 offen offset:768
    buffer_load_dwordx4 v[240:243], v10, s[12:15], s96 offen offset:768
    buffer_load_dwordx4 v[244:247], v10, s[12:15], s97 offen offset:768
    buffer_load_dwordx4 v[248:251], v10, s[12:15], s98 offen offset:768
    buffer_load_dwordx4 v[252:255], v10, s[12:15], s99 offen offset:768
    s_mov_b32 s20, 0
    s_mov_b32 s22, 0
    s_mov_b32 s44, 0
    s_mov_b32 s45, 0
    s_mov_b32 s49, 0
    s_lshl_b32 s16, s16, 2
    s_add_u32 s16, s16, s8
    s_lshl_b32 s24, s16, 14
    s_lshl_b32 s26, s17, 11
    s_add_u32 s24, s24, s26
    s_lshl_b32 s25, s16, 10
    s_lshl_b32 s26, s17, 7
    s_add_u32 s25, s25, s26
    s_mov_b32 s52, 9437184
    s_and_b32 s26, s16, 15
    s_bitcmp1_b32 s17, 1
    s_cselect_b32 s27, 0, 15
    s_cmp_eq_u32 s26, s27
    s_cselect_b32 s46, 1, 0
    s_lshl_b32 s27, s16, 10
    s_add_u32 s28, s27, 7024512
    s_add_u32 s27, s27, 7026568
    s_cmp_eq_u32 s26, 15
    s_cselect_b32 s53, s27, 0
    s_cmp_eq_u32 s26, 0
    s_cselect_b32 s53, s28, s53
    s_cmp_eq_u32 s16, 0
    s_cselect_b32 s53, 0, s53
    s_cmp_eq_u32 s16, 127
    s_cselect_b32 s53, 0, s53
    s_lshl_b32 s47, s16, 10
    s_lshl_b32 s26, s17, 2
    s_add_u32 s47, s47, s26
    s_add_u32 s47, s47, 7024640
    s_lshl_b32 s48, s18, 10
    s_lshl_b32 s26, s19, 2
    s_add_u32 s48, s48, s26
    s_add_u32 s48, s48, 7024640
    v_add_u32 v4, 0x10000, v1
    v_add_u32 v5, 0x20000, v1
    v_and_b32 v6, 0x300, v1
    v_and_b32 v3, 15, v2
    v_lshl_add_u32 v6, v3, 3, v6
    v_mov_b32 v8, 1
    v_lshrrev_b32 v9, 3, v2
    v_and_b32 v3, 0x1c, v7
    v_lshl_add_u32 v9, v9, 10, v3
    v_mov_b32 v12, 0
    s_waitcnt vmcnt(28)
    s_mul_i32 s34, s8, 10752
    s_add_u32 s34, s34, 98304
    v_lshrrev_b32 v3, 4, v2
    v_and_b32 v76, 15, v2
    v_xor_b32 v77, v76, v3
    v_lshlrev_b32 v77, 4, v77
    v_lshl_add_u32 v77, v3, 8, v77
    v_add_u32 v77, s34, v77
    v_xor_b32 v64, 0, v77
    v_xor_b32 v65, 64, v77
    v_xor_b32 v66, 128, v77
    v_xor_b32 v67, 192, v77
    v_lshrrev_b32 v77, 1, v3
    v_xor_b32 v77, v77, v76
    v_lshlrev_b32 v77, 4, v77
    v_lshl_add_u32 v77, v76, 8, v77
    v_and_b32 v3, 1, v3
    v_lshl_add_u32 v77, v3, 3, v77
    v_add_u32 v77, s34, v77
    v_xor_b32 v68, 0, v77
    v_xor_b32 v69, 32, v77
    v_xor_b32 v70, 64, v77
    v_xor_b32 v71, 96, v77
    v_xor_b32 v72, 128, v77
    v_xor_b32 v73, 160, v77
    v_xor_b32 v74, 192, v77
    v_xor_b32 v75, 224, v77
    v_mov_b32 v104, 0x3f803f80
    v_mov_b32 v105, 0x3f803f80
    v_mov_b32 v106, 0x3f803f80
    v_mov_b32 v107, 0x3f803f80
    s_cmp_lg_u32 s8, 2
    s_cbranch_scc1 .Lnp1_87
    s_mov_b32 s100, 123904
    s_mov_b32 s101, s2
    s_mov_b32 s98, 0
    s_cmp_ge_u32 s101, 832
    s_cbranch_scc1 .Lpd4_89
    s_cmp_ge_u32 s101, 384
    s_cbranch_scc1 .Lpd3_88
    s_lshr_b32 s28, s101, 7
    s_and_b32 s29, s101, 7
    s_bfe_u32 s30, s101, 0x40003
    s_cmp_eq_u32 s28, 1
    s_cselect_b64 s[12:13], s[74:75], s[76:77]
    s_cmp_eq_u32 s28, 0
    s_cselect_b64 s[12:13], s[70:71], s[12:13]
    s_mov_b32 s14, 524288
    s_mov_b32 s93, 1024
    s_lshl_b32 s99, s28, 3
    s_add_u32 s99, s99, s29
    s_lshl_b32 s94, s99, 4
    s_add_u32 s94, s94, s30
    s_lshl_b32 s94, s94, 12
    s_add_u32 s94, s94, 1572864
    s_add_u32 s95, s94, 1024
    s_add_u32 s96, s94, 2048
    s_add_u32 s97, s94, 3072
    s_branch .Lpdj_90
.Lpd3_88:
    s_sub_u32 s28, s101, 384
    s_and_b32 s30, s28, 15
    s_lshr_b32 s29, s28, 4
    s_mov_b64 s[12:13], s[78:79]
    s_mov_b32 s14, 1835008
    s_mov_b32 s93, 3584
    s_add_u32 s99, s29, 24
    s_mul_i32 s31, s30, 7168
    s_add_u32 s31, s31, 3145728
    s_lshl_b32 s28, s29, 2
    s_add_u32 s28, s28, 0
    s_mul_i32 s32, s28, 43
    s_lshr_b32 s32, s32, 8
    s_mul_i32 s33, s32, 6
    s_sub_u32 s33, s28, s33
    s_sub_u32 s36, s28, 96
    s_cmp_ge_u32 s28, 96
    s_cselect_b32 s32, s36, s32
    s_cselect_b32 s33, 6, s33
    s_lshl_b32 s36, s32, 3
    s_add_u32 s36, s36, s33
    s_lshl_b32 s36, s36, 4
    s_add_u32 s36, s36, s30
    s_lshl_b32 s36, s36, 6
    s_add_u32 s72, s36, 23015424
    s_mul_i32 s32, s32, 112
    s_add_u32 s32, s32, s33
    s_lshl_b32 s32, s32, 10
    s_add_u32 s94, s32, s31
    s_lshl_b32 s28, s29, 2
    s_add_u32 s28, s28, 1
    s_mul_i32 s32, s28, 43
    s_lshr_b32 s32, s32, 8
    s_mul_i32 s33, s32, 6
    s_sub_u32 s33, s28, s33
    s_sub_u32 s36, s28, 96
    s_cmp_ge_u32 s28, 96
    s_cselect_b32 s32, s36, s32
    s_cselect_b32 s33, 6, s33
    s_lshl_b32 s36, s32, 3
    s_add_u32 s36, s36, s33
    s_lshl_b32 s36, s36, 4
    s_add_u32 s36, s36, s30
    s_lshl_b32 s36, s36, 6
    s_add_u32 s73, s36, 23015424
    s_mul_i32 s32, s32, 112
    s_add_u32 s32, s32, s33
    s_lshl_b32 s32, s32, 10
    s_add_u32 s95, s32, s31
    s_lshl_b32 s28, s29, 2
    s_add_u32 s28, s28, 2
    s_mul_i32 s32, s28, 43
    s_lshr_b32 s32, s32, 8
    s_mul_i32 s33, s32, 6
    s_sub_u32 s33, s28, s33
    s_sub_u32 s36, s28, 96
    s_cmp_ge_u32 s28, 96
    s_cselect_b32 s32, s36, s32
    s_cselect_b32 s33, 6, s33
    s_lshl_b32 s36, s32, 3
    s_add_u32 s36, s36, s33
    s_lshl_b32 s36, s36, 4
    s_add_u32 s36, s36, s30
    s_lshl_b32 s36, s36, 6
    s_add_u32 s74, s36, 23015424
    s_mul_i32 s32, s32, 112
    s_add_u32 s32, s32, s33
    s_lshl_b32 s32, s32, 10
    s_add_u32 s96, s32, s31
    s_lshl_b32 s28, s29, 2
    s_add_u32 s28, s28, 3
    s_mul_i32 s32, s28, 43
    s_lshr_b32 s32, s32, 8
    s_mul_i32 s33, s32, 6
    s_sub_u32 s33, s28, s33
    s_sub_u32 s36, s28, 96
    s_cmp_ge_u32 s28, 96
    s_cselect_b32 s32, s36, s32
    s_cselect_b32 s33, 6, s33
    s_lshl_b32 s36, s32, 3
    s_add_u32 s36, s36, s33
    s_lshl_b32 s36, s36, 4
    s_add_u32 s36, s36, s30
    s_lshl_b32 s36, s36, 6
    s_add_u32 s75, s36, 23015424
    s_mul_i32 s32, s32, 112
    s_add_u32 s32, s32, s33
    s_lshl_b32 s32, s32, 10
    s_add_u32 s97, s32, s31
    s_branch .Lpdj_90
.Lpd4_89:
    s_sub_u32 s28, s101, 832
    s_and_b32 s29, s28, 7
    s_lshr_b32 s30, s28, 3
    s_mov_b64 s[12:13], s[80:81]
    s_mov_b32 s14, 1835008
    s_mov_b32 s93, 1024
    s_add_u32 s99, s29, 52
    s_cmp_ge_u32 s30, 48
    s_cselect_b32 s98, 1, 0
    s_mul_i32 s94, s29, 56
    s_add_u32 s94, s94, s30
    s_lshl_b32 s94, s94, 12
    s_add_u32 s94, s94, 4980736
    s_add_u32 s95, s94, 1024
    s_add_u32 s96, s94, 2048
    s_add_u32 s97, s94, 3072
.Lpdj_90:
    s_mul_i32 s92, s30, s93
    s_lshl_b32 s92, s92, 5
    s_lshl_b32 s29, s29, 7
    s_add_u32 s92, s92, s29
    s_lshl_b32 s99, s99, 7
    s_add_u32 s99, s99, 7000064
    v_lshrrev_b32 v80, 3, v2
    v_mul_u32_u24 v80, s93, v80
    v_lshrrev_b32 v81, 1, v2
    v_lshrrev_b32 v82, 4, v2
    v_xor_b32 v81, v81, v82
    v_and_b32 v81, 3, v81
    v_lshl_add_u32 v80, v81, 5, v80
    v_and_b32 v81, 1, v2
    v_lshl_add_u32 v80, v81, 4, v80
    s_lshl_b32 s93, s93, 3
    s_add_u32 m0, s100, 0
    s_nop 0
    buffer_load_dwordx4 v80, s[12:15], s92 offen lds
    s_add_u32 s92, s92, s93
    s_add_u32 m0, s100, 1024
    s_nop 0
    buffer_load_dwordx4 v80, s[12:15], s92 offen lds
    s_add_u32 s92, s92, s93
    s_add_u32 m0, s100, 2048
    s_nop 0
    buffer_load_dwordx4 v80, s[12:15], s92 offen lds
    s_add_u32 s92, s92, s93
    s_add_u32 m0, s100, 3072
    s_nop 0
    buffer_load_dwordx4 v80, s[12:15], s92 offen lds
.Lnp1_87:
    ds_write_b128 v64, v[128:131] offset:0
    ds_write_b128 v65, v[132:135] offset:1024
    ds_write_b128 v66, v[136:139] offset:2048
    ds_write_b128 v67, v[140:143] offset:3072
    ds_read_b64 v[128:129], v68
    ds_read_b64 v[130:131], v69
    ds_read_b64 v[132:133], v70
    ds_read_b64 v[134:135], v71
    ds_read_b64 v[136:137], v72
    ds_read_b64 v[138:139], v73
    ds_read_b64 v[140:141], v74
    ds_read_b64 v[142:143], v75
    s_waitcnt vmcnt(24) lgkmcnt(0)
    ds_write_b128 v64, v[144:147] offset:0
    ds_write_b128 v65, v[148:151] offset:1024
    ds_write_b128 v66, v[152:155] offset:2048
    ds_write_b128 v67, v[156:159] offset:3072
    ds_read_b64 v[144:145], v68
    ds_read_b64 v[146:147], v69
    ds_read_b64 v[148:149], v70
    ds_read_b64 v[150:151], v71
    ds_read_b64 v[152:153], v72
    ds_read_b64 v[154:155], v73
    ds_read_b64 v[156:157], v74
    ds_read_b64 v[158:159], v75
    v_mfma_f32_16x16x32_bf16 v[108:111], v[104:107], v[128:131], 0
    v_mfma_f32_16x16x32_bf16 v[112:115], v[128:131], v[128:131], 0
    v_mfma_f32_16x16x32_bf16 v[108:111], v[104:107], v[132:135], v[108:111]
    v_mfma_f32_16x16x32_bf16 v[112:115], v[132:135], v[132:135], v[112:115]
    v_mfma_f32_16x16x32_bf16 v[108:111], v[104:107], v[136:139], v[108:111]
    v_mfma_f32_16x16x32_bf16 v[112:115], v[136:139], v[136:139], v[112:115]
    v_mfma_f32_16x16x32_bf16 v[108:111], v[104:107], v[140:143], v[108:111]
    v_mfma_f32_16x16x32_bf16 v[112:115], v[140:143], v[140:143], v[112:115]
    s_waitcnt vmcnt(20) lgkmcnt(0)
    ds_write_b128 v64, v[160:163] offset:0
    ds_write_b128 v65, v[164:167] offset:1024
    ds_write_b128 v66, v[168:171] offset:2048
    ds_write_b128 v67, v[172:175] offset:3072
    ds_read_b64 v[160:161], v68
    ds_read_b64 v[162:163], v69
    ds_read_b64 v[164:165], v70
    ds_read_b64 v[166:167], v71
    ds_read_b64 v[168:169], v72
    ds_read_b64 v[170:171], v73
    ds_read_b64 v[172:173], v74
    ds_read_b64 v[174:175], v75
    v_mfma_f32_16x16x32_bf16 v[116:119], v[104:107], v[144:147], 0
    v_mfma_f32_16x16x32_bf16 v[120:123], v[144:147], v[144:147], 0
    v_mfma_f32_16x16x32_bf16 v[116:119], v[104:107], v[148:151], v[116:119]
    v_mfma_f32_16x16x32_bf16 v[120:123], v[148:151], v[148:151], v[120:123]
    v_mfma_f32_16x16x32_bf16 v[116:119], v[104:107], v[152:155], v[116:119]
    v_mfma_f32_16x16x32_bf16 v[120:123], v[152:155], v[152:155], v[120:123]
    v_mfma_f32_16x16x32_bf16 v[116:119], v[104:107], v[156:159], v[116:119]
    v_mfma_f32_16x16x32_bf16 v[120:123], v[156:159], v[156:159], v[120:123]
    s_waitcnt vmcnt(16) lgkmcnt(0)
    ds_write_b128 v64, v[176:179] offset:0
    ds_write_b128 v65, v[180:183] offset:1024
    ds_write_b128 v66, v[184:187] offset:2048
    ds_write_b128 v67, v[188:191] offset:3072
    ds_read_b64 v[176:177], v68
    ds_read_b64 v[178:179], v69
    ds_read_b64 v[180:181], v70
    ds_read_b64 v[182:183], v71
    ds_read_b64 v[184:185], v72
    ds_read_b64 v[186:187], v73
    ds_read_b64 v[188:189], v74
    ds_read_b64 v[190:191], v75
    v_mfma_f32_16x16x32_bf16 v[108:111], v[104:107], v[160:163], v[108:111]
    v_mfma_f32_16x16x32_bf16 v[112:115], v[160:163], v[160:163], v[112:115]
    v_mfma_f32_16x16x32_bf16 v[108:111], v[104:107], v[164:167], v[108:111]
    v_mfma_f32_16x16x32_bf16 v[112:115], v[164:167], v[164:167], v[112:115]
    v_mfma_f32_16x16x32_bf16 v[108:111], v[104:107], v[168:171], v[108:111]
    v_mfma_f32_16x16x32_bf16 v[112:115], v[168:171], v[168:171], v[112:115]
    v_mfma_f32_16x16x32_bf16 v[108:111], v[104:107], v[172:175], v[108:111]
    v_mfma_f32_16x16x32_bf16 v[112:115], v[172:175], v[172:175], v[112:115]
    s_waitcnt vmcnt(12) lgkmcnt(0)
    ds_write_b128 v64, v[192:195] offset:0
    ds_write_b128 v65, v[196:199] offset:1024
    ds_write_b128 v66, v[200:203] offset:2048
    ds_write_b128 v67, v[204:207] offset:3072
    ds_read_b64 v[192:193], v68
    ds_read_b64 v[194:195], v69
    ds_read_b64 v[196:197], v70
    ds_read_b64 v[198:199], v71
    ds_read_b64 v[200:201], v72
    ds_read_b64 v[202:203], v73
    ds_read_b64 v[204:205], v74
    ds_read_b64 v[206:207], v75
    v_mfma_f32_16x16x32_bf16 v[116:119], v[104:107], v[176:179], v[116:119]
    v_mfma_f32_16x16x32_bf16 v[120:123], v[176:179], v[176:179], v[120:123]
    v_mfma_f32_16x16x32_bf16 v[116:119], v[104:107], v[180:183], v[116:119]
    v_mfma_f32_16x16x32_bf16 v[120:123], v[180:183], v[180:183], v[120:123]
    v_mfma_f32_16x16x32_bf16 v[116:119], v[104:107], v[184:187], v[116:119]
    v_mfma_f32_16x16x32_bf16 v[120:123], v[184:187], v[184:187], v[120:123]
    v_mfma_f32_16x16x32_bf16 v[116:119], v[104:107], v[188:191], v[116:119]
    v_mfma_f32_16x16x32_bf16 v[120:123], v[188:191], v[188:191], v[120:123]
    s_waitcnt vmcnt(8) lgkmcnt(0)
    ds_write_b128 v64, v[208:211] offset:0
    ds_write_b128 v65, v[212:215] offset:1024
    ds_write_b128 v66, v[216:219] offset:2048
    ds_write_b128 v67, v[220:223] offset:3072
    ds_read_b64 v[208:209], v68
    ds_read_b64 v[210:211], v69
    ds_read_b64 v[212:213], v70
    ds_read_b64 v[214:215], v71
    ds_read_b64 v[216:217], v72
    ds_read_b64 v[218:219], v73
    ds_read_b64 v[220:221], v74
    ds_read_b64 v[222:223], v75
    v_mfma_f32_16x16x32_bf16 v[108:111], v[104:107], v[192:195], v[108:111]
    v_mfma_f32_16x16x32_bf16 v[112:115], v[192:195], v[192:195], v[112:115]
    v_mfma_f32_16x16x32_bf16 v[108:111], v[104:107], v[196:199], v[108:111]
    v_mfma_f32_16x16x32_bf16 v[112:115], v[196:199], v[196:199], v[112:115]
    v_mfma_f32_16x16x32_bf16 v[108:111], v[104:107], v[200:203], v[108:111]
    v_mfma_f32_16x16x32_bf16 v[112:115], v[200:203], v[200:203], v[112:115]
    v_mfma_f32_16x16x32_bf16 v[108:111], v[104:107], v[204:207], v[108:111]
    v_mfma_f32_16x16x32_bf16 v[112:115], v[204:207], v[204:207], v[112:115]
    s_waitcnt vmcnt(4) lgkmcnt(0)
    ds_write_b128 v64, v[224:227] offset:0
    ds_write_b128 v65, v[228:231] offset:1024
    ds_write_b128 v66, v[232:235] offset:2048
    ds_write_b128 v67, v[236:239] offset:3072
    ds_read_b64 v[224:225], v68
    ds_read_b64 v[226:227], v69
    ds_read_b64 v[228:229], v70
    ds_read_b64 v[230:231], v71
    ds_read_b64 v[232:233], v72
    ds_read_b64 v[234:235], v73
    ds_read_b64 v[236:237], v74
    ds_read_b64 v[238:239], v75
    v_mfma_f32_16x16x32_bf16 v[116:119], v[104:107], v[208:211], v[116:119]
    v_mfma_f32_16x16x32_bf16 v[120:123], v[208:211], v[208:211], v[120:123]
    v_mfma_f32_16x16x32_bf16 v[116:119], v[104:107], v[212:215], v[116:119]
    v_mfma_f32_16x16x32_bf16 v[120:123], v[212:215], v[212:215], v[120:123]
    v_mfma_f32_16x16x32_bf16 v[116:119], v[104:107], v[216:219], v[116:119]
    v_mfma_f32_16x16x32_bf16 v[120:123], v[216:219], v[216:219], v[120:123]
    v_mfma_f32_16x16x32_bf16 v[116:119], v[104:107], v[220:223], v[116:119]
    v_mfma_f32_16x16x32_bf16 v[120:123], v[220:223], v[220:223], v[120:123]
    s_waitcnt vmcnt(0) lgkmcnt(0)
    ds_write_b128 v64, v[240:243] offset:0
    ds_write_b128 v65, v[244:247] offset:1024
    ds_write_b128 v66, v[248:251] offset:2048
    ds_write_b128 v67, v[252:255] offset:3072
    ds_read_b64 v[240:241], v68
    ds_read_b64 v[242:243], v69
    ds_read_b64 v[244:245], v70
    ds_read_b64 v[246:247], v71
    ds_read_b64 v[248:249], v72
    ds_read_b64 v[250:251], v73
    ds_read_b64 v[252:253], v74
    ds_read_b64 v[254:255], v75
    v_mfma_f32_16x16x32_bf16 v[108:111], v[104:107], v[224:227], v[108:111]
    v_mfma_f32_16x16x32_bf16 v[112:115], v[224:227], v[224:227], v[112:115]
    v_mfma_f32_16x16x32_bf16 v[108:111], v[104:107], v[228:231], v[108:111]
    v_mfma_f32_16x16x32_bf16 v[112:115], v[228:231], v[228:231], v[112:115]
    v_mfma_f32_16x16x32_bf16 v[108:111], v[104:107], v[232:235], v[108:111]
    v_mfma_f32_16x16x32_bf16 v[112:115], v[232:235], v[232:235], v[112:115]
    v_mfma_f32_16x16x32_bf16 v[108:111], v[104:107], v[236:239], v[108:111]
    v_mfma_f32_16x16x32_bf16 v[112:115], v[236:239], v[236:239], v[112:115]
    s_waitcnt lgkmcnt(0)
    v_mfma_f32_16x16x32_bf16 v[116:119], v[104:107], v[240:243], v[116:119]
    v_mfma_f32_16x16x32_bf16 v[120:123], v[240:243], v[240:243], v[120:123]
    v_mfma_f32_16x16x32_bf16 v[116:119], v[104:107], v[244:247], v[116:119]
    v_mfma_f32_16x16x32_bf16 v[120:123], v[244:247], v[244:247], v[120:123]
    v_mfma_f32_16x16x32_bf16 v[116:119], v[104:107], v[248:251], v[116:119]
    v_mfma_f32_16x16x32_bf16 v[120:123], v[248:251], v[248:251], v[120:123]
    v_mfma_f32_16x16x32_bf16 v[116:119], v[104:107], v[252:255], v[116:119]
    v_mfma_f32_16x16x32_bf16 v[120:123], v[252:255], v[252:255], v[120:123]
    v_and_b32 v3, 3, v2
    v_cmp_eq_u32 s[28:29], 1, v3
    v_cmp_eq_u32 s[30:31], 2, v3
    v_cmp_eq_u32 s[32:33], 3, v3
    v_bfe_u32 v3, v2, 2, 2
    v_lshrrev_b32 v20, 4, v2
    v_cmp_eq_u32 vcc, v3, v20
    v_cndmask_b32 v112, v112, v113, s[28:29]
    v_cndmask_b32 v112, v112, v114, s[30:31]
    v_cndmask_b32 v112, v112, v115, s[32:33]
    v_cndmask_b32 v32, 0, v108, vcc
    v_cndmask_b32 v33, 0, v112, vcc
    v_mov_b32 v34, 0
    v_mov_b32 v35, 0
    v_cndmask_b32 v120, v120, v121, s[28:29]
    v_cndmask_b32 v120, v120, v122, s[30:31]
    v_cndmask_b32 v120, v120, v123, s[32:33]
    v_cndmask_b32 v36, 0, v116, vcc
    v_cndmask_b32 v37, 0, v120, vcc
    v_mov_b32 v38, 0
    v_mov_b32 v39, 0
    v_pk_add_f32 v[32:33], v[32:33], v[34:35]
    s_nop 1
    v_permlane32_swap_b32 v32, v33
    v_add_f32 v32, v32, v33
    v_mov_b32 v33, v32
    s_nop 1
    v_permlane16_swap_b32 v32, v33
    v_add_f32 v32, v32, v33
    v_mov_b32 v33, v32
    s_nop 1
    v_permlane32_swap_b32 v32, v33
    v_mul_f32 v32, 0x3b000000, v32
    v_mul_f32 v33, 0x3b000000, v33
    v_fma_f32 v33, -v32, v32, v33
    v_max_f32 v33, 0, v33
    v_add_f32 v34, 0x3727c5ac, v33
    v_rsq_f32 v34, v34
    v_mov_b32 v33, v32
    v_mul_f32 v40, 0x3fb8aa3b, v34
    v_mov_b32 v35, v34
    v_pk_add_f32 v[36:37], v[36:37], v[38:39]
    s_nop 1
    v_permlane32_swap_b32 v36, v37
    v_add_f32 v36, v36, v37
    v_mov_b32 v37, v36
    s_nop 1
    v_permlane16_swap_b32 v36, v37
    v_add_f32 v36, v36, v37
    v_mov_b32 v37, v36
    s_nop 1
    v_permlane32_swap_b32 v36, v37
    v_mul_f32 v36, 0x3b000000, v36
    v_mul_f32 v37, 0x3b000000, v37
    v_fma_f32 v37, -v36, v36, v37
    v_max_f32 v37, 0, v37
    v_add_f32 v38, 0x3727c5ac, v37
    v_rsq_f32 v38, v38
    v_mov_b32 v37, v36
    v_mul_f32 v42, 0x3fb8aa3b, v38
    v_mov_b32 v39, v38
    s_nop 0
    v_permlane32_swap_b32 v40, v42
    v_mov_b32 v41, v40
    s_cmp_lg_u32 s8, 2
    s_cbranch_scc1 .Lnp2_91
    s_waitcnt vmcnt(0)
    s_cmp_eq_u32 s98, 1
    s_cselect_b32 s28, 8, 4
    s_cselect_b32 s29, 4, 16
    v_lshrrev_b32 v81, 4, v2
    v_mul_u32_u24 v81, s28, v81
    v_bfe_u32 v82, v2, 2, 2
    v_add_u32 v81, v81, v82
    v_and_b32 v82, 3, v2
    v_lshlrev_b32 v82, 3, v82
    v_add_u32 v82, s100, v82
    v_bfe_u32 v83, v81, 1, 2
    v_lshl_add_u32 v83, v83, 5, v82
    v_lshl_add_u32 v83, v81, 7, v83
    v_xor_b32 v84, 0, v83
    ds_read_b64_tr_b16 v[88:89], v84
    v_xor_b32 v84, 32, v83
    ds_read_b64_tr_b16 v[92:93], v84
    v_xor_b32 v84, 64, v83
    ds_read_b64_tr_b16 v[96:97], v84
    v_xor_b32 v84, 96, v83
    ds_read_b64_tr_b16 v[100:101], v84
    v_add_u32 v81, s29, v81
    v_bfe_u32 v83, v81, 1, 2
    v_lshl_add_u32 v83, v83, 5, v82
    v_lshl_add_u32 v83, v81, 7, v83
    v_xor_b32 v84, 0, v83
    ds_read_b64_tr_b16 v[90:91], v84
    v_xor_b32 v84, 32, v83
    ds_read_b64_tr_b16 v[94:95], v84
    v_xor_b32 v84, 64, v83
    ds_read_b64_tr_b16 v[98:99], v84
    v_xor_b32 v84, 96, v83
    ds_read_b64_tr_b16 v[102:103], v84
    s_waitcnt lgkmcnt(0)
    buffer_store_dwordx4 v[88:91], v1, s[4:7], s94 offen sc1
    buffer_store_dwordx4 v[92:95], v1, s[4:7], s95 offen sc1
    buffer_store_dwordx4 v[96:99], v1, s[4:7], s96 offen sc1
    buffer_store_dwordx4 v[100:103], v1, s[4:7], s97 offen sc1
.Lnp2_91:
    s_cmp_lg_u32 s8, 0
    s_cbranch_scc1 .Lnochk_92
    s_mov_b32 s31, 0
    s_mov_b64 exec, 0x1
.Lpoll_93:
    buffer_load_dword v3, v7, s[88:91], s31 offen sc1
.Lpollc_95:
    s_waitcnt vmcnt(0)
    v_cmp_le_u32 vcc, 32, v3
    s_nop 0
    s_cmp_eq_u64 vcc, exec
    s_cbranch_scc1 .Lpolld_96
    s_sub_u32 s23, s23, 1
    s_cbranch_scc1 .Lexit_1
    s_sleep 8
    s_branch .Lpoll_93
.Lpolld_96:
    s_mov_b64 exec, -1
    ds_write_b32 v15, v8 offset:56
    s_getreg_b32 s30, hwreg(HW_REG_XCC_ID)
    s_and_b32 s30, s30, 15
    s_mul_i32 s31, s30, s30
    s_lshl_b32 s31, s31, 16
    s_lshl_b32 s30, s30, 7
    s_add_u32 s30, s30, s31
    s_add_u32 s58, s30, 1
    s_and_b32 s59, s2, 7
    s_lshl_b32 s59, s59, 7
    s_add_u32 s59, s59, 7010304
    v_mov_b32 v3, s58
    s_mov_b64 exec, 1
    buffer_atomic_add v3, v7, s[4:7], s59 offen
    s_mov_b64 exec, -1
.Lnochk_92:
    s_mov_b64 s[12:13], s[64:65]
    s_mov_b32 s14, 2097152
    v_and_b32 v3, 15, v2
    v_lshlrev_b32 v62, 10, v3
    v_lshrrev_b32 v3, 4, v2
    v_lshl_add_u32 v62, v3, 3, v62
    s_lshl_b32 s28, s16, 14
    s_lshl_b32 s29, s17, 7
    s_add_u32 s28, s28, s29
    v_and_b32 v13, 0x30, v2
    v_add_u32 v13, 159744, v13
    v_lshrrev_b32 v60, 4, v2
    v_and_b32 v61, 15, v2
    s_mul_i32 s30, s8, 10752
    s_add_u32 s30, s30, 98304
    v_mul_u32_u24 v45, 336, v61
    v_add_u32 v45, s30, v45
    v_lshl_add_u32 v46, v60, 3, v45
    v_lshl_add_u32 v44, v60, 4, v45
    v_and_b32 v3, 1, v60
    v_lshl_add_u32 v45, v3, 6, v45
    v_lshrrev_b32 v3, 1, v60
    v_mul_u32_u24 v3, 5376, v3
    v_add_u32 v45, v45, v3
    s_lshl_b32 s42, s19, 12
    s_add_u32 s42, s42, s22
    s_add_u32 s42, s42, 6860800
    s_lshl_b32 s43, s19, 8
    s_add_u32 s43, s43, s22
    s_add_u32 s43, s43, 6926336
    v_lshlrev_b32 v50, 5, v60
    v_mov_b32 v56, 0x358637bd
    v_mov_b32 v57, 0x358637bd
    v_mov_b32 v58, 0x358637bd
    v_mov_b32 v59, 0x358637bd
    s_add_u32 s51, s50, 1
.Llw_97:
    ds_read_b128 v[20:23], v15 offset:16
    s_waitcnt lgkmcnt(0)
    v_min_u32 v20, v20, v21
    v_min3_u32 v20, v20, v22, v23
    v_cmp_le_u32 vcc, s51, v20
    s_cbranch_vccnz .Llwd_98
    s_sub_u32 s23, s23, 1
    s_cbranch_scc1 .Lexit_1
    s_sleep 1
    s_branch .Llw_97
.Llwd_98:
    buffer_load_dwordx2 v[24:25], v62, s[12:15], s28 offen offset:0
    buffer_load_dwordx2 v[26:27], v62, s[12:15], s28 offen offset:32
    buffer_load_dwordx2 v[28:29], v62, s[12:15], s28 offen offset:64
    buffer_load_dwordx2 v[30:31], v62, s[12:15], s28 offen offset:96
    ds_read_b128 v[96:99], v1 offset:0
    ds_read_b128 v[100:103], v1 offset:1024
    ds_read_b128 v[104:107], v1 offset:2048
    ds_read_b128 v[108:111], v1 offset:3072
    ds_read_b128 v[112:115], v1 offset:4096
    ds_read_b128 v[116:119], v1 offset:5120
    ds_read_b128 v[120:123], v1 offset:6144
    ds_read_b128 v[124:127], v1 offset:7168
    s_waitcnt lgkmcnt(7)
    v_mfma_f32_16x16x32_bf16 v[64:67], v[96:99], v[128:131], 0
    v_mfma_f32_16x16x32_bf16 v[80:83], v[96:99], v[144:147], 0
    ds_read_b128 v[96:99], v1 offset:8192
    s_waitcnt lgkmcnt(7)
    v_mfma_f32_16x16x32_bf16 v[68:71], v[100:103], v[128:131], 0
    v_mfma_f32_16x16x32_bf16 v[84:87], v[100:103], v[144:147], 0
    ds_read_b128 v[100:103], v1 offset:9216
    s_waitcnt lgkmcnt(7)
    v_mfma_f32_16x16x32_bf16 v[72:75], v[104:107], v[128:131], 0
    v_mfma_f32_16x16x32_bf16 v[88:91], v[104:107], v[144:147], 0
    ds_read_b128 v[104:107], v1 offset:10240
    s_waitcnt lgkmcnt(7)
    v_mfma_f32_16x16x32_bf16 v[76:79], v[108:111], v[128:131], 0
    v_mfma_f32_16x16x32_bf16 v[92:95], v[108:111], v[144:147], 0
    ds_read_b128 v[108:111], v1 offset:11264
    s_waitcnt lgkmcnt(7)
    v_mfma_f32_16x16x32_bf16 v[64:67], v[112:115], v[132:135], v[64:67]
    v_mfma_f32_16x16x32_bf16 v[80:83], v[112:115], v[148:151], v[80:83]
    ds_read_b128 v[112:115], v1 offset:12288
    s_waitcnt lgkmcnt(7)
    v_mfma_f32_16x16x32_bf16 v[68:71], v[116:119], v[132:135], v[68:71]
    v_mfma_f32_16x16x32_bf16 v[84:87], v[116:119], v[148:151], v[84:87]
    ds_read_b128 v[116:119], v1 offset:13312
    s_waitcnt lgkmcnt(7)
    v_mfma_f32_16x16x32_bf16 v[72:75], v[120:123], v[132:135], v[72:75]
    v_mfma_f32_16x16x32_bf16 v[88:91], v[120:123], v[148:151], v[88:91]
    ds_read_b128 v[120:123], v1 offset:14336
    s_waitcnt lgkmcnt(7)
    v_mfma_f32_16x16x32_bf16 v[76:79], v[124:127], v[132:135], v[76:79]
    v_mfma_f32_16x16x32_bf16 v[92:95], v[124:127], v[148:151], v[92:95]
    ds_read_b128 v[124:127], v1 offset:15360
    s_waitcnt lgkmcnt(7)
    v_mfma_f32_16x16x32_bf16 v[64:67], v[96:99], v[136:139], v[64:67]
    v_mfma_f32_16x16x32_bf16 v[80:83], v[96:99], v[152:155], v[80:83]
    ds_read_b128 v[96:99], v1 offset:16384
    s_waitcnt lgkmcnt(7)
    v_mfma_f32_16x16x32_bf16 v[68:71], v[100:103], v[136:139], v[68:71]
    v_mfma_f32_16x16x32_bf16 v[84:87], v[100:103], v[152:155], v[84:87]
    ds_read_b128 v[100:103], v1 offset:17408
    s_waitcnt lgkmcnt(7)
    v_mfma_f32_16x16x32_bf16 v[72:75], v[104:107], v[136:139], v[72:75]
    v_mfma_f32_16x16x32_bf16 v[88:91], v[104:107], v[152:155], v[88:91]
    ds_read_b128 v[104:107], v1 offset:18432
    s_waitcnt lgkmcnt(7)
    v_mfma_f32_16x16x32_bf16 v[76:79], v[108:111], v[136:139], v[76:79]
    v_mfma_f32_16x16x32_bf16 v[92:95], v[108:111], v[152:155], v[92:95]
    ds_read_b128 v[108:111], v1 offset:19456
    s_waitcnt lgkmcnt(7)
    v_mfma_f32_16x16x32_bf16 v[64:67], v[112:115], v[140:143], v[64:67]
    v_mfma_f32_16x16x32_bf16 v[80:83], v[112:115], v[156:159], v[80:83]
    ds_read_b128 v[112:115], v1 offset:20480
    s_waitcnt lgkmcnt(7)
    v_mfma_f32_16x16x32_bf16 v[68:71], v[116:119], v[140:143], v[68:71]
    v_mfma_f32_16x16x32_bf16 v[84:87], v[116:119], v[156:159], v[84:87]
    ds_read_b128 v[116:119], v1 offset:21504
    s_waitcnt lgkmcnt(7)
    v_mfma_f32_16x16x32_bf16 v[72:75], v[120:123], v[140:143], v[72:75]
    v_mfma_f32_16x16x32_bf16 v[88:91], v[120:123], v[156:159], v[88:91]
    ds_read_b128 v[120:123], v1 offset:22528
    s_waitcnt lgkmcnt(7)
    v_mfma_f32_16x16x32_bf16 v[76:79], v[124:127], v[140:143], v[76:79]
    v_mfma_f32_16x16x32_bf16 v[92:95], v[124:127], v[156:159], v[92:95]
    ds_read_b128 v[124:127], v1 offset:23552
    s_waitcnt lgkmcnt(7)
    v_mfma_f32_16x16x32_bf16 v[64:67], v[96:99], v[160:163], v[64:67]
    v_mfma_f32_16x16x32_bf16 v[80:83], v[96:99], v[176:179], v[80:83]
    ds_read_b128 v[96:99], v1 offset:24576
    s_waitcnt lgkmcnt(7)
    v_mfma_f32_16x16x32_bf16 v[68:71], v[100:103], v[160:163], v[68:71]
    v_mfma_f32_16x16x32_bf16 v[84:87], v[100:103], v[176:179], v[84:87]
    ds_read_b128 v[100:103], v1 offset:25600
    s_waitcnt lgkmcnt(7)
    v_mfma_f32_16x16x32_bf16 v[72:75], v[104:107], v[160:163], v[72:75]
    v_mfma_f32_16x16x32_bf16 v[88:91], v[104:107], v[176:179], v[88:91]
    ds_read_b128 v[104:107], v1 offset:26624
    s_waitcnt lgkmcnt(7)
    v_mfma_f32_16x16x32_bf16 v[76:79], v[108:111], v[160:163], v[76:79]
    v_mfma_f32_16x16x32_bf16 v[92:95], v[108:111], v[176:179], v[92:95]
    ds_read_b128 v[108:111], v1 offset:27648
    s_waitcnt lgkmcnt(7)
    v_mfma_f32_16x16x32_bf16 v[64:67], v[112:115], v[164:167], v[64:67]
    v_mfma_f32_16x16x32_bf16 v[80:83], v[112:115], v[180:183], v[80:83]
    ds_read_b128 v[112:115], v1 offset:28672
    s_waitcnt lgkmcnt(7)
    v_mfma_f32_16x16x32_bf16 v[68:71], v[116:119], v[164:167], v[68:71]
    v_mfma_f32_16x16x32_bf16 v[84:87], v[116:119], v[180:183], v[84:87]
    ds_read_b128 v[116:119], v1 offset:29696
    s_waitcnt lgkmcnt(7)
    v_mfma_f32_16x16x32_bf16 v[72:75], v[120:123], v[164:167], v[72:75]
    v_mfma_f32_16x16x32_bf16 v[88:91], v[120:123], v[180:183], v[88:91]
    ds_read_b128 v[120:123], v1 offset:30720
    s_waitcnt lgkmcnt(7)
    v_mfma_f32_16x16x32_bf16 v[76:79], v[124:127], v[164:167], v[76:79]
    v_mfma_f32_16x16x32_bf16 v[92:95], v[124:127], v[180:183], v[92:95]
    ds_read_b128 v[124:127], v1 offset:31744
    s_waitcnt lgkmcnt(7)
    v_mfma_f32_16x16x32_bf16 v[64:67], v[96:99], v[168:171], v[64:67]
    v_mfma_f32_16x16x32_bf16 v[80:83], v[96:99], v[184:187], v[80:83]
    ds_read_b128 v[96:99], v1 offset:32768
    s_waitcnt lgkmcnt(7)
    v_mfma_f32_16x16x32_bf16 v[68:71], v[100:103], v[168:171], v[68:71]
    v_mfma_f32_16x16x32_bf16 v[84:87], v[100:103], v[184:187], v[84:87]
    ds_read_b128 v[100:103], v1 offset:33792
    s_waitcnt lgkmcnt(7)
    v_mfma_f32_16x16x32_bf16 v[72:75], v[104:107], v[168:171], v[72:75]
    v_mfma_f32_16x16x32_bf16 v[88:91], v[104:107], v[184:187], v[88:91]
    ds_read_b128 v[104:107], v1 offset:34816
    s_waitcnt lgkmcnt(7)
    v_mfma_f32_16x16x32_bf16 v[76:79], v[108:111], v[168:171], v[76:79]
    v_mfma_f32_16x16x32_bf16 v[92:95], v[108:111], v[184:187], v[92:95]
    ds_read_b128 v[108:111], v1 offset:35840
    s_waitcnt lgkmcnt(7)
    v_mfma_f32_16x16x32_bf16 v[64:67], v[112:115], v[172:175], v[64:67]
    v_mfma_f32_16x16x32_bf16 v[80:83], v[112:115], v[188:191], v[80:83]
    ds_read_b128 v[112:115], v1 offset:36864
    s_waitcnt lgkmcnt(7)
    v_mfma_f32_16x16x32_bf16 v[68:71], v[116:119], v[172:175], v[68:71]
    v_mfma_f32_16x16x32_bf16 v[84:87], v[116:119], v[188:191], v[84:87]
    ds_read_b128 v[116:119], v1 offset:37888
    s_waitcnt lgkmcnt(7)
    v_mfma_f32_16x16x32_bf16 v[72:75], v[120:123], v[172:175], v[72:75]
    v_mfma_f32_16x16x32_bf16 v[88:91], v[120:123], v[188:191], v[88:91]
    ds_read_b128 v[120:123], v1 offset:38912
    s_waitcnt lgkmcnt(7)
    v_mfma_f32_16x16x32_bf16 v[76:79], v[124:127], v[172:175], v[76:79]
    v_mfma_f32_16x16x32_bf16 v[92:95], v[124:127], v[188:191], v[92:95]
    ds_read_b128 v[124:127], v1 offset:39936
    s_waitcnt lgkmcnt(7)
    v_mfma_f32_16x16x32_bf16 v[64:67], v[96:99], v[192:195], v[64:67]
    v_mfma_f32_16x16x32_bf16 v[80:83], v[96:99], v[208:211], v[80:83]
    ds_read_b128 v[96:99], v1 offset:40960
    s_waitcnt lgkmcnt(7)
    v_mfma_f32_16x16x32_bf16 v[68:71], v[100:103], v[192:195], v[68:71]
    v_mfma_f32_16x16x32_bf16 v[84:87], v[100:103], v[208:211], v[84:87]
    ds_read_b128 v[100:103], v1 offset:41984
    s_waitcnt lgkmcnt(7)
    v_mfma_f32_16x16x32_bf16 v[72:75], v[104:107], v[192:195], v[72:75]
    v_mfma_f32_16x16x32_bf16 v[88:91], v[104:107], v[208:211], v[88:91]
    ds_read_b128 v[104:107], v1 offset:43008
    s_waitcnt lgkmcnt(7)
    v_mfma_f32_16x16x32_bf16 v[76:79], v[108:111], v[192:195], v[76:79]
    v_mfma_f32_16x16x32_bf16 v[92:95], v[108:111], v[208:211], v[92:95]
    ds_read_b128 v[108:111], v1 offset:44032
    s_waitcnt lgkmcnt(7)
    v_mfma_f32_16x16x32_bf16 v[64:67], v[112:115], v[196:199], v[64:67]
    v_mfma_f32_16x16x32_bf16 v[80:83], v[112:115], v[212:215], v[80:83]
    ds_read_b128 v[112:115], v1 offset:45056
    s_waitcnt lgkmcnt(7)
    v_mfma_f32_16x16x32_bf16 v[68:71], v[116:119], v[196:199], v[68:71]
    v_mfma_f32_16x16x32_bf16 v[84:87], v[116:119], v[212:215], v[84:87]
    ds_read_b128 v[116:119], v1 offset:46080
    s_waitcnt lgkmcnt(7)
    v_mfma_f32_16x16x32_bf16 v[72:75], v[120:123], v[196:199], v[72:75]
    v_mfma_f32_16x16x32_bf16 v[88:91], v[120:123], v[212:215], v[88:91]
    ds_read_b128 v[120:123], v1 offset:47104
    s_waitcnt lgkmcnt(7)
    v_mfma_f32_16x16x32_bf16 v[76:79], v[124:127], v[196:199], v[76:79]
    v_mfma_f32_16x16x32_bf16 v[92:95], v[124:127], v[212:215], v[92:95]
    ds_read_b128 v[124:127], v1 offset:48128
    s_waitcnt lgkmcnt(7)
    v_mfma_f32_16x16x32_bf16 v[64:67], v[96:99], v[200:203], v[64:67]
    v_mfma_f32_16x16x32_bf16 v[80:83], v[96:99], v[216:219], v[80:83]
    ds_read_b128 v[96:99], v1 offset:49152
    s_waitcnt lgkmcnt(7)
    v_mfma_f32_16x16x32_bf16 v[68:71], v[100:103], v[200:203], v[68:71]
    v_mfma_f32_16x16x32_bf16 v[84:87], v[100:103], v[216:219], v[84:87]
    ds_read_b128 v[100:103], v1 offset:50176
    s_waitcnt lgkmcnt(7)
    v_mfma_f32_16x16x32_bf16 v[72:75], v[104:107], v[200:203], v[72:75]
    v_mfma_f32_16x16x32_bf16 v[88:91], v[104:107], v[216:219], v[88:91]
    ds_read_b128 v[104:107], v1 offset:51200
    s_waitcnt lgkmcnt(7)
    v_mfma_f32_16x16x32_bf16 v[76:79], v[108:111], v[200:203], v[76:79]
    v_mfma_f32_16x16x32_bf16 v[92:95], v[108:111], v[216:219], v[92:95]
    ds_read_b128 v[108:111], v1 offset:52224
    s_waitcnt lgkmcnt(7)
    v_mfma_f32_16x16x32_bf16 v[64:67], v[112:115], v[204:207], v[64:67]
    v_mfma_f32_16x16x32_bf16 v[80:83], v[112:115], v[220:223], v[80:83]
    ds_read_b128 v[112:115], v1 offset:53248
    s_waitcnt lgkmcnt(7)
    v_mfma_f32_16x16x32_bf16 v[68:71], v[116:119], v[204:207], v[68:71]
    v_mfma_f32_16x16x32_bf16 v[84:87], v[116:119], v[220:223], v[84:87]
    ds_read_b128 v[116:119], v1 offset:54272
    s_waitcnt lgkmcnt(7)
    v_mfma_f32_16x16x32_bf16 v[72:75], v[120:123], v[204:207], v[72:75]
    v_mfma_f32_16x16x32_bf16 v[88:91], v[120:123], v[220:223], v[88:91]
    ds_read_b128 v[120:123], v1 offset:55296
    s_waitcnt lgkmcnt(7)
    v_mfma_f32_16x16x32_bf16 v[76:79], v[124:127], v[204:207], v[76:79]
    v_mfma_f32_16x16x32_bf16 v[92:95], v[124:127], v[220:223], v[92:95]
    ds_read_b128 v[124:127], v1 offset:56320
    s_waitcnt lgkmcnt(7)
    v_mfma_f32_16x16x32_bf16 v[64:67], v[96:99], v[224:227], v[64:67]
    v_mfma_f32_16x16x32_bf16 v[80:83], v[96:99], v[240:243], v[80:83]
    ds_read_b128 v[20:23], v15 offset:80
    ds_read_b128 v[96:99], v1 offset:57344
    s_waitcnt lgkmcnt(8)
    v_mfma_f32_16x16x32_bf16 v[68:71], v[100:103], v[224:227], v[68:71]
    v_mfma_f32_16x16x32_bf16 v[84:87], v[100:103], v[240:243], v[84:87]
    ds_read_b128 v[100:103], v1 offset:58368
    s_waitcnt lgkmcnt(8)
    v_mfma_f32_16x16x32_bf16 v[72:75], v[104:107], v[224:227], v[72:75]
    v_mfma_f32_16x16x32_bf16 v[88:91], v[104:107], v[240:243], v[88:91]
    ds_read_b128 v[104:107], v1 offset:59392
    s_waitcnt lgkmcnt(8)
    v_mfma_f32_16x16x32_bf16 v[76:79], v[108:111], v[224:227], v[76:79]
    v_mfma_f32_16x16x32_bf16 v[92:95], v[108:111], v[240:243], v[92:95]
    ds_read_b128 v[108:111], v1 offset:60416
    s_waitcnt lgkmcnt(8)
    v_mfma_f32_16x16x32_bf16 v[64:67], v[112:115], v[228:231], v[64:67]
    v_mfma_f32_16x16x32_bf16 v[80:83], v[112:115], v[244:247], v[80:83]
    s_mov_b32 s51, 1
    s_waitcnt lgkmcnt(4)
    v_min_u32 v20, v20, v21
    v_min3_u32 v20, v20, v22, v23
    v_cmp_le_u32 vcc, s51, v20
    s_cbranch_vccnz .Llt_99
    s_mov_b32 s51, 1
.Llw_100:
    ds_read_b128 v[20:23], v15 offset:80
    s_waitcnt lgkmcnt(0)
    v_min_u32 v20, v20, v21
    v_min3_u32 v20, v20, v22, v23
    v_cmp_le_u32 vcc, s51, v20
    s_cbranch_vccnz .Llwd_101
    s_sub_u32 s23, s23, 1
    s_cbranch_scc1 .Lexit_1
    s_branch .Llw_100
.Llwd_101:
.Llt_99:
    ds_read_b128 v[112:115], v1 offset:61440
    v_mfma_f32_16x16x32_bf16 v[68:71], v[116:119], v[228:231], v[68:71]
    v_mfma_f32_16x16x32_bf16 v[84:87], v[116:119], v[244:247], v[84:87]
    ds_read_b128 v[116:119], v1 offset:62464
    v_mfma_f32_16x16x32_bf16 v[72:75], v[120:123], v[228:231], v[72:75]
    v_mfma_f32_16x16x32_bf16 v[88:91], v[120:123], v[244:247], v[88:91]
    ds_read_b128 v[120:123], v1 offset:63488
    v_mfma_f32_16x16x32_bf16 v[76:79], v[124:127], v[228:231], v[76:79]
    v_mfma_f32_16x16x32_bf16 v[92:95], v[124:127], v[244:247], v[92:95]
    ds_read_b128 v[124:127], v1 offset:64512
    s_waitcnt lgkmcnt(7)
    v_mfma_f32_16x16x32_bf16 v[64:67], v[96:99], v[232:235], v[64:67]
    v_mfma_f32_16x16x32_bf16 v[80:83], v[96:99], v[248:251], v[80:83]
    s_waitcnt lgkmcnt(6)
    v_mfma_f32_16x16x32_bf16 v[68:71], v[100:103], v[232:235], v[68:71]
    v_mfma_f32_16x16x32_bf16 v[84:87], v[100:103], v[248:251], v[84:87]
    s_waitcnt lgkmcnt(5)
    v_mfma_f32_16x16x32_bf16 v[72:75], v[104:107], v[232:235], v[72:75]
    v_mfma_f32_16x16x32_bf16 v[88:91], v[104:107], v[248:251], v[88:91]
    s_waitcnt lgkmcnt(4)
    v_mfma_f32_16x16x32_bf16 v[76:79], v[108:111], v[232:235], v[76:79]
    v_mfma_f32_16x16x32_bf16 v[92:95], v[108:111], v[248:251], v[92:95]
    s_waitcnt lgkmcnt(3)
    v_mfma_f32_16x16x32_bf16 v[64:67], v[112:115], v[236:239], v[64:67]
    ds_read_b128 v[96:99], v13 offset:0
    v_mfma_f32_16x16x32_bf16 v[80:83], v[112:115], v[252:255], v[80:83]
    s_waitcnt lgkmcnt(3)
    v_mfma_f32_16x16x32_bf16 v[68:71], v[116:119], v[236:239], v[68:71]
    ds_read_b128 v[100:103], v13 offset:64
    v_mfma_f32_16x16x32_bf16 v[84:87], v[116:119], v[252:255], v[84:87]
    s_waitcnt lgkmcnt(3)
    v_mfma_f32_16x16x32_bf16 v[72:75], v[120:123], v[236:239], v[72:75]
    ds_read_b128 v[104:107], v13 offset:128
    v_mfma_f32_16x16x32_bf16 v[88:91], v[120:123], v[252:255], v[88:91]
    s_waitcnt lgkmcnt(3)
    v_mfma_f32_16x16x32_bf16 v[76:79], v[124:127], v[236:239], v[76:79]
    ds_read_b128 v[108:111], v13 offset:192
    v_mfma_f32_16x16x32_bf16 v[92:95], v[124:127], v[252:255], v[92:95]
    s_cmp_lg_u32 s8, 2
    s_cbranch_scc1 .Lnc2_102
    s_add_u32 s51, s50, 1
.Llw_103:
    ds_read_b32 v20, v15 offset:56
    s_waitcnt lgkmcnt(0)
    v_cmp_le_u32 vcc, s51, v20
    s_cbranch_vccnz .Llwd_104
    s_sub_u32 s23, s23, 1
    s_cbranch_scc1 .Lexit_1
    s_branch .Llw_103
.Llwd_104:
    s_waitcnt vmcnt(0)
    s_mov_b64 exec, 1
    buffer_atomic_add v8, v7, s[4:7], s99 offen
    s_mov_b64 exec, -1
.Lnc2_102:
    s_add_u32 s51, s50, 3
    v_mov_b32 v3, s51
    ds_write_b32 v14, v3 offset:0
    s_branch .Lqepi_86
.Lpair_84:
.Lst_q:
    s_lshl_b32 s26, s18, 14
    s_add_u32 s26, s26, s20
    s_add_u32 s26, s26, 7155712
    s_add_u32 s27, s26, 16384
    s_lshl_b32 s28, s18, 10
    s_add_u32 s28, s28, s20
    s_add_u32 s28, s28, 9252864
    s_lshl_b32 s29, s18, 10
    s_add_u32 s29, s29, s44
    v_and_b32 v13, 0x30, v2
    v_add_u32 v13, 159744, v13
    v_lshrrev_b32 v60, 4, v2
    v_and_b32 v61, 15, v2
    s_mul_i32 s30, s8, 10752
    s_add_u32 s30, s30, 98304
    v_mul_u32_u24 v45, 336, v61
    v_add_u32 v45, s30, v45
    v_lshl_add_u32 v46, v60, 3, v45
    v_lshl_add_u32 v44, v60, 4, v45
    v_and_b32 v3, 1, v60
    v_lshl_add_u32 v45, v3, 6, v45
    v_lshrrev_b32 v3, 1, v60
    v_mul_u32_u24 v3, 5376, v3
    v_add_u32 v45, v45, v3
    s_lshl_b32 s42, s19, 12
    s_add_u32 s42, s42, s22
    s_add_u32 s42, s42, 6860800
    s_lshl_b32 s43, s19, 8
    s_add_u32 s43, s43, s22
    s_add_u32 s43, s43, 6926336
    v_lshlrev_b32 v50, 5, v60
    v_mov_b32 v56, 0x358637bd
    v_mov_b32 v57, 0x358637bd
    v_mov_b32 v58, 0x358637bd
    v_mov_b32 v59, 0x358637bd
    s_add_u32 s51, s50, 1
.Llw_105:
    ds_read_b128 v[60:63], v15 offset:16
    s_waitcnt lgkmcnt(0)
    v_min_u32 v60, v60, v61
    v_min3_u32 v60, v60, v62, v63
    v_cmp_le_u32 vcc, s51, v60
    s_cbranch_vccnz .Llwd_106
    s_sub_u32 s23, s23, 1
    s_cbranch_scc1 .Lexit_1
    s_branch .Llw_105
.Llwd_106:
    s_add_u32 s29, s29, 7024640
    s_mov_b64 exec, 0xffff
    buffer_load_dword v0, v9, s[4:7], s29 offen sc1
    s_mov_b64 exec, -1
    ds_read_b128 v[96:99], v1 offset:0
    ds_read_b128 v[100:103], v1 offset:1024
    ds_read_b128 v[104:107], v1 offset:2048
    ds_read_b128 v[108:111], v1 offset:3072
    ds_read_b128 v[112:115], v1 offset:4096
    ds_read_b128 v[116:119], v1 offset:5120
    ds_read_b128 v[120:123], v1 offset:6144
    ds_read_b128 v[124:127], v1 offset:7168
    s_mov_b64 exec, 0xffff
    s_waitcnt vmcnt(0)
    v_cmp_le_u32 vcc, 1, v0
    s_nop 0
    s_cmp_eq_u64 vcc, exec
    s_cbranch_scc1 .Lpolld_110
.Lpoll_107:
    s_cmp_eq_u32 s45, 0
    s_cbranch_scc1 .Lpolls_108
    buffer_load_dword v3, v9, s[4:7], s29 offen sc1
    s_branch .Lpollc_109
.Lpolls_108:
    v_mov_b32 v3, 0
    buffer_atomic_add v3, v9, s[4:7], s29 offen sc0
.Lpollc_109:
    s_waitcnt vmcnt(0)
    v_cmp_le_u32 vcc, 1, v3
    s_nop 0
    s_cmp_eq_u64 vcc, exec
    s_cbranch_scc1 .Lpolld_110
    s_sub_u32 s23, s23, 1
    s_cbranch_scc1 .Lexit_1
    s_branch .Lpoll_107
.Lpolld_110:
    s_mov_b64 exec, -1
    buffer_load_dwordx4 v[128:131], v1, s[4:7], s26 offen sc1
    buffer_load_dwordx4 v[144:147], v1, s[4:7], s27 offen sc1
    buffer_load_dwordx4 v[132:135], v1, s[4:7], s26 offen offset:1024 sc1
    buffer_load_dwordx4 v[148:151], v1, s[4:7], s27 offen offset:1024 sc1
    buffer_load_dwordx2 v[32:33], v6, s[4:7], s28 offen sc1
    buffer_load_dwordx2 v[34:35], v6, s[4:7], s28 offen offset:128 sc1
    buffer_load_dwordx2 v[36:37], v6, s[4:7], s28 offen offset:1024 sc1
    buffer_load_dwordx2 v[38:39], v6, s[4:7], s28 offen offset:1152 sc1
    buffer_load_dwordx4 v[136:139], v1, s[4:7], s26 offen offset:2048 sc1
    buffer_load_dwordx4 v[152:155], v1, s[4:7], s27 offen offset:2048 sc1
    buffer_load_dwordx4 v[140:143], v1, s[4:7], s26 offen offset:3072 sc1
    s_add_u32 s26, s26, 4096
    buffer_load_dwordx4 v[156:159], v1, s[4:7], s27 offen offset:3072 sc1
    s_add_u32 s27, s27, 4096
    buffer_load_dwordx4 v[160:163], v1, s[4:7], s26 offen sc1
    buffer_load_dwordx4 v[176:179], v1, s[4:7], s27 offen sc1
    buffer_load_dwordx4 v[164:167], v1, s[4:7], s26 offen offset:1024 sc1
    buffer_load_dwordx4 v[180:183], v1, s[4:7], s27 offen offset:1024 sc1
    s_waitcnt lgkmcnt(0)
    s_waitcnt vmcnt(14)
    v_mfma_f32_16x16x32_bf16 v[64:67], v[96:99], v[128:131], 0
    buffer_load_dwordx4 v[168:171], v1, s[4:7], s26 offen offset:2048 sc1
    v_mfma_f32_16x16x32_bf16 v[80:83], v[96:99], v[144:147], 0
    ds_read_b128 v[96:99], v1 offset:8192
    v_mfma_f32_16x16x32_bf16 v[68:71], v[100:103], v[128:131], 0
    v_mfma_f32_16x16x32_bf16 v[84:87], v[100:103], v[144:147], 0
    ds_read_b128 v[100:103], v1 offset:9216
    v_mfma_f32_16x16x32_bf16 v[72:75], v[104:107], v[128:131], 0
    buffer_load_dwordx4 v[184:187], v1, s[4:7], s27 offen offset:2048 sc1
    v_mfma_f32_16x16x32_bf16 v[88:91], v[104:107], v[144:147], 0
    ds_read_b128 v[104:107], v1 offset:10240
    v_mfma_f32_16x16x32_bf16 v[76:79], v[108:111], v[128:131], 0
    v_mfma_f32_16x16x32_bf16 v[92:95], v[108:111], v[144:147], 0
    ds_read_b128 v[108:111], v1 offset:11264
    s_waitcnt vmcnt(14)
    v_mfma_f32_16x16x32_bf16 v[64:67], v[112:115], v[132:135], v[64:67]
    buffer_load_dwordx4 v[172:175], v1, s[4:7], s26 offen offset:3072 sc1
    s_add_u32 s26, s26, 4096
    v_mfma_f32_16x16x32_bf16 v[80:83], v[112:115], v[148:151], v[80:83]
    ds_read_b128 v[112:115], v1 offset:12288
    v_mfma_f32_16x16x32_bf16 v[68:71], v[116:119], v[132:135], v[68:71]
    v_mfma_f32_16x16x32_bf16 v[84:87], v[116:119], v[148:151], v[84:87]
    ds_read_b128 v[116:119], v1 offset:13312
    v_mfma_f32_16x16x32_bf16 v[72:75], v[120:123], v[132:135], v[72:75]
    buffer_load_dwordx4 v[188:191], v1, s[4:7], s27 offen offset:3072 sc1
    s_add_u32 s27, s27, 4096
    v_mfma_f32_16x16x32_bf16 v[88:91], v[120:123], v[148:151], v[88:91]
    ds_read_b128 v[120:123], v1 offset:14336
    v_mfma_f32_16x16x32_bf16 v[76:79], v[124:127], v[132:135], v[76:79]
    v_mfma_f32_16x16x32_bf16 v[92:95], v[124:127], v[148:151], v[92:95]
    ds_read_b128 v[124:127], v1 offset:15360
    s_waitcnt vmcnt(10) lgkmcnt(7)
    v_mfma_f32_16x16x32_bf16 v[64:67], v[96:99], v[136:139], v[64:67]
    buffer_load_dwordx4 v[192:195], v1, s[4:7], s26 offen sc1
    v_pk_add_f32 v[32:33], v[32:33], v[34:35]
    v_mfma_f32_16x16x32_bf16 v[80:83], v[96:99], v[152:155], v[80:83]
    ds_read_b128 v[96:99], v1 offset:16384
    s_waitcnt lgkmcnt(7)
    v_mfma_f32_16x16x32_bf16 v[68:71], v[100:103], v[136:139], v[68:71]
    v_permlane32_swap_b32 v32, v33
    v_add_f32 v32, v32, v33
    v_mfma_f32_16x16x32_bf16 v[84:87], v[100:103], v[152:155], v[84:87]
    ds_read_b128 v[100:103], v1 offset:17408
    s_waitcnt lgkmcnt(7)
    v_mfma_f32_16x16x32_bf16 v[72:75], v[104:107], v[136:139], v[72:75]
    buffer_load_dwordx4 v[208:211], v1, s[4:7], s27 offen sc1
    v_mov_b32 v33, v32
    v_mfma_f32_16x16x32_bf16 v[88:91], v[104:107], v[152:155], v[88:91]
    ds_read_b128 v[104:107], v1 offset:18432
    s_waitcnt lgkmcnt(7)
    v_mfma_f32_16x16x32_bf16 v[76:79], v[108:111], v[136:139], v[76:79]
    v_permlane16_swap_b32 v32, v33
    v_add_f32 v32, v32, v33
    v_mfma_f32_16x16x32_bf16 v[92:95], v[108:111], v[152:155], v[92:95]
    ds_read_b128 v[108:111], v1 offset:19456
    s_waitcnt vmcnt(10) lgkmcnt(7)
    v_mfma_f32_16x16x32_bf16 v[64:67], v[112:115], v[140:143], v[64:67]
    buffer_load_dwordx4 v[196:199], v1, s[4:7], s26 offen offset:1024 sc1
    v_mov_b32 v33, v32
    v_mfma_f32_16x16x32_bf16 v[80:83], v[112:115], v[156:159], v[80:83]
    ds_read_b128 v[112:115], v1 offset:20480
    s_waitcnt lgkmcnt(7)
    v_mfma_f32_16x16x32_bf16 v[68:71], v[116:119], v[140:143], v[68:71]
    v_permlane32_swap_b32 v32, v33
    v_mul_f32 v32, 0x3b000000, v32
    v_mfma_f32_16x16x32_bf16 v[84:87], v[116:119], v[156:159], v[84:87]
    ds_read_b128 v[116:119], v1 offset:21504
    s_waitcnt lgkmcnt(7)
    v_mfma_f32_16x16x32_bf16 v[72:75], v[120:123], v[140:143], v[72:75]
    buffer_load_dwordx4 v[212:215], v1, s[4:7], s27 offen offset:1024 sc1
    v_mul_f32 v33, 0x3b000000, v33
    v_mfma_f32_16x16x32_bf16 v[88:91], v[120:123], v[156:159], v[88:91]
    ds_read_b128 v[120:123], v1 offset:22528
    s_waitcnt lgkmcnt(7)
    v_mfma_f32_16x16x32_bf16 v[76:79], v[124:127], v[140:143], v[76:79]
    v_fma_f32 v33, -v32, v32, v33
    v_max_f32 v33, 0, v33
    v_mfma_f32_16x16x32_bf16 v[92:95], v[124:127], v[156:159], v[92:95]
    ds_read_b128 v[124:127], v1 offset:23552
    s_waitcnt vmcnt(10) lgkmcnt(7)
    v_mfma_f32_16x16x32_bf16 v[64:67], v[96:99], v[160:163], v[64:67]
    buffer_load_dwordx4 v[200:203], v1, s[4:7], s26 offen offset:2048 sc1
    v_add_f32 v34, 0x3727c5ac, v33
    v_mfma_f32_16x16x32_bf16 v[80:83], v[96:99], v[176:179], v[80:83]
    ds_read_b128 v[96:99], v1 offset:24576
    s_waitcnt lgkmcnt(7)
    v_mfma_f32_16x16x32_bf16 v[68:71], v[100:103], v[160:163], v[68:71]
    v_rsq_f32 v34, v34
    v_mov_b32 v33, v32
    v_mfma_f32_16x16x32_bf16 v[84:87], v[100:103], v[176:179], v[84:87]
    ds_read_b128 v[100:103], v1 offset:25600
    s_waitcnt lgkmcnt(7)
    v_mfma_f32_16x16x32_bf16 v[72:75], v[104:107], v[160:163], v[72:75]
    buffer_load_dwordx4 v[216:219], v1, s[4:7], s27 offen offset:2048 sc1
    v_mul_f32 v40, 0x3fb8aa3b, v34
    v_mfma_f32_16x16x32_bf16 v[88:91], v[104:107], v[176:179], v[88:91]
    ds_read_b128 v[104:107], v1 offset:26624
    s_waitcnt lgkmcnt(7)
    v_mfma_f32_16x16x32_bf16 v[76:79], v[108:111], v[160:163], v[76:79]
    v_mov_b32 v35, v34
    v_pk_add_f32 v[36:37], v[36:37], v[38:39]
    v_mfma_f32_16x16x32_bf16 v[92:95], v[108:111], v[176:179], v[92:95]
    ds_read_b128 v[108:111], v1 offset:27648
    s_waitcnt vmcnt(10) lgkmcnt(7)
    v_mfma_f32_16x16x32_bf16 v[64:67], v[112:115], v[164:167], v[64:67]
    buffer_load_dwordx4 v[204:207], v1, s[4:7], s26 offen offset:3072 sc1
    s_add_u32 s26, s26, 4096
    v_mfma_f32_16x16x32_bf16 v[80:83], v[112:115], v[180:183], v[80:83]
    ds_read_b128 v[112:115], v1 offset:28672
    s_waitcnt lgkmcnt(7)
    v_mfma_f32_16x16x32_bf16 v[68:71], v[116:119], v[164:167], v[68:71]
    v_permlane32_swap_b32 v36, v37
    v_add_f32 v36, v36, v37
    v_mfma_f32_16x16x32_bf16 v[84:87], v[116:119], v[180:183], v[84:87]
    ds_read_b128 v[116:119], v1 offset:29696
    s_waitcnt lgkmcnt(7)
    v_mfma_f32_16x16x32_bf16 v[72:75], v[120:123], v[164:167], v[72:75]
    buffer_load_dwordx4 v[220:223], v1, s[4:7], s27 offen offset:3072 sc1
    s_add_u32 s27, s27, 4096
    v_mfma_f32_16x16x32_bf16 v[88:91], v[120:123], v[180:183], v[88:91]
    ds_read_b128 v[120:123], v1 offset:30720
    s_waitcnt lgkmcnt(7)
    v_mfma_f32_16x16x32_bf16 v[76:79], v[124:127], v[164:167], v[76:79]
    v_mov_b32 v37, v36
    s_nop 1
    v_permlane16_swap_b32 v36, v37
    v_mfma_f32_16x16x32_bf16 v[92:95], v[124:127], v[180:183], v[92:95]
    ds_read_b128 v[124:127], v1 offset:31744
    s_waitcnt vmcnt(10) lgkmcnt(7)
    v_mfma_f32_16x16x32_bf16 v[64:67], v[96:99], v[168:171], v[64:67]
    buffer_load_dwordx4 v[224:227], v1, s[4:7], s26 offen sc1
    v_add_f32 v36, v36, v37
    v_mfma_f32_16x16x32_bf16 v[80:83], v[96:99], v[184:187], v[80:83]
    ds_read_b128 v[96:99], v1 offset:32768
    s_waitcnt lgkmcnt(7)
    v_mfma_f32_16x16x32_bf16 v[68:71], v[100:103], v[168:171], v[68:71]
    v_mov_b32 v37, v36
    s_nop 1
    v_permlane32_swap_b32 v36, v37
    v_mfma_f32_16x16x32_bf16 v[84:87], v[100:103], v[184:187], v[84:87]
    ds_read_b128 v[100:103], v1 offset:33792
    s_waitcnt lgkmcnt(7)
    v_mfma_f32_16x16x32_bf16 v[72:75], v[104:107], v[168:171], v[72:75]
    buffer_load_dwordx4 v[240:243], v1, s[4:7], s27 offen sc1
    v_mul_f32 v36, 0x3b000000, v36
    v_mfma_f32_16x16x32_bf16 v[88:91], v[104:107], v[184:187], v[88:91]
    ds_read_b128 v[104:107], v1 offset:34816
    s_waitcnt lgkmcnt(7)
    v_mfma_f32_16x16x32_bf16 v[76:79], v[108:111], v[168:171], v[76:79]
    v_mul_f32 v37, 0x3b000000, v37
    v_fma_f32 v37, -v36, v36, v37
    v_mfma_f32_16x16x32_bf16 v[92:95], v[108:111], v[184:187], v[92:95]
    ds_read_b128 v[108:111], v1 offset:35840
    s_waitcnt vmcnt(10) lgkmcnt(7)
    v_mfma_f32_16x16x32_bf16 v[64:67], v[112:115], v[172:175], v[64:67]
    buffer_load_dwordx4 v[228:231], v1, s[4:7], s26 offen offset:1024 sc1
    v_max_f32 v37, 0, v37
    v_mfma_f32_16x16x32_bf16 v[80:83], v[112:115], v[188:191], v[80:83]
    ds_read_b128 v[112:115], v1 offset:36864
    s_waitcnt lgkmcnt(7)
    v_mfma_f32_16x16x32_bf16 v[68:71], v[116:119], v[172:175], v[68:71]
    v_add_f32 v38, 0x3727c5ac, v37
    v_rsq_f32 v38, v38
    v_mfma_f32_16x16x32_bf16 v[84:87], v[116:119], v[188:191], v[84:87]
    ds_read_b128 v[116:119], v1 offset:37888
    s_waitcnt lgkmcnt(7)
    v_mfma_f32_16x16x32_bf16 v[72:75], v[120:123], v[172:175], v[72:75]
    buffer_load_dwordx4 v[244:247], v1, s[4:7], s27 offen offset:1024 sc1
    v_mov_b32 v37, v36
    v_mfma_f32_16x16x32_bf16 v[88:91], v[120:123], v[188:191], v[88:91]
    ds_read_b128 v[120:123], v1 offset:38912
    s_waitcnt lgkmcnt(7)
    v_mfma_f32_16x16x32_bf16 v[76:79], v[124:127], v[172:175], v[76:79]
    v_mul_f32 v42, 0x3fb8aa3b, v38
    v_mov_b32 v39, v38
    v_mfma_f32_16x16x32_bf16 v[92:95], v[124:127], v[188:191], v[92:95]
    ds_read_b128 v[124:127], v1 offset:39936
    s_waitcnt vmcnt(10) lgkmcnt(7)
    v_mfma_f32_16x16x32_bf16 v[64:67], v[96:99], v[192:195], v[64:67]
    buffer_load_dwordx4 v[232:235], v1, s[4:7], s26 offen offset:2048 sc1
    v_permlane32_swap_b32 v40, v42
    v_mfma_f32_16x16x32_bf16 v[80:83], v[96:99], v[208:211], v[80:83]
    ds_read_b128 v[96:99], v1 offset:40960
    s_waitcnt lgkmcnt(7)
    v_mfma_f32_16x16x32_bf16 v[68:71], v[100:103], v[192:195], v[68:71]
    v_mov_b32 v41, v40
    v_mfma_f32_16x16x32_bf16 v[84:87], v[100:103], v[208:211], v[84:87]
    ds_read_b128 v[100:103], v1 offset:41984
    s_waitcnt lgkmcnt(7)
    v_mfma_f32_16x16x32_bf16 v[72:75], v[104:107], v[192:195], v[72:75]
    buffer_load_dwordx4 v[248:251], v1, s[4:7], s27 offen offset:2048 sc1
    v_mfma_f32_16x16x32_bf16 v[88:91], v[104:107], v[208:211], v[88:91]
    ds_read_b128 v[104:107], v1 offset:43008
    s_waitcnt lgkmcnt(7)
    v_mfma_f32_16x16x32_bf16 v[76:79], v[108:111], v[192:195], v[76:79]
    v_mfma_f32_16x16x32_bf16 v[92:95], v[108:111], v[208:211], v[92:95]
    ds_read_b128 v[108:111], v1 offset:44032
    s_waitcnt vmcnt(10) lgkmcnt(7)
    v_mfma_f32_16x16x32_bf16 v[64:67], v[112:115], v[196:199], v[64:67]
    buffer_load_dwordx4 v[236:239], v1, s[4:7], s26 offen offset:3072 sc1
    v_mfma_f32_16x16x32_bf16 v[80:83], v[112:115], v[212:215], v[80:83]
    ds_read_b128 v[112:115], v1 offset:45056
    s_waitcnt lgkmcnt(7)
    v_mfma_f32_16x16x32_bf16 v[68:71], v[116:119], v[196:199], v[68:71]
    v_mfma_f32_16x16x32_bf16 v[84:87], v[116:119], v[212:215], v[84:87]
    ds_read_b128 v[116:119], v1 offset:46080
    s_waitcnt lgkmcnt(7)
    v_mfma_f32_16x16x32_bf16 v[72:75], v[120:123], v[196:199], v[72:75]
    buffer_load_dwordx4 v[252:255], v1, s[4:7], s27 offen offset:3072 sc1
    v_mfma_f32_16x16x32_bf16 v[88:91], v[120:123], v[212:215], v[88:91]
    ds_read_b128 v[120:123], v1 offset:47104
    s_waitcnt lgkmcnt(7)
    v_mfma_f32_16x16x32_bf16 v[76:79], v[124:127], v[196:199], v[76:79]
    v_mfma_f32_16x16x32_bf16 v[92:95], v[124:127], v[212:215], v[92:95]
    ds_read_b128 v[124:127], v1 offset:48128
    s_waitcnt vmcnt(10) lgkmcnt(7)
    v_mfma_f32_16x16x32_bf16 v[64:67], v[96:99], v[200:203], v[64:67]
    v_mfma_f32_16x16x32_bf16 v[80:83], v[96:99], v[216:219], v[80:83]
    ds_read_b128 v[96:99], v1 offset:49152
    s_waitcnt lgkmcnt(7)
    v_mfma_f32_16x16x32_bf16 v[68:71], v[100:103], v[200:203], v[68:71]
    v_mfma_f32_16x16x32_bf16 v[84:87], v[100:103], v[216:219], v[84:87]
    ds_read_b128 v[100:103], v1 offset:50176
    s_waitcnt lgkmcnt(7)
    v_mfma_f32_16x16x32_bf16 v[72:75], v[104:107], v[200:203], v[72:75]
    v_mfma_f32_16x16x32_bf16 v[88:91], v[104:107], v[216:219], v[88:91]
    ds_read_b128 v[104:107], v1 offset:51200
    s_waitcnt lgkmcnt(7)
    v_mfma_f32_16x16x32_bf16 v[76:79], v[108:111], v[200:203], v[76:79]
    v_mfma_f32_16x16x32_bf16 v[92:95], v[108:111], v[216:219], v[92:95]
    ds_read_b128 v[108:111], v1 offset:52224
    s_waitcnt vmcnt(8) lgkmcnt(7)
    v_mfma_f32_16x16x32_bf16 v[64:67], v[112:115], v[204:207], v[64:67]
    v_mfma_f32_16x16x32_bf16 v[80:83], v[112:115], v[220:223], v[80:83]
    ds_read_b128 v[112:115], v1 offset:53248
    s_waitcnt lgkmcnt(7)
    v_mfma_f32_16x16x32_bf16 v[68:71], v[116:119], v[204:207], v[68:71]
    v_mfma_f32_16x16x32_bf16 v[84:87], v[116:119], v[220:223], v[84:87]
    ds_read_b128 v[116:119], v1 offset:54272
    s_waitcnt lgkmcnt(7)
    v_mfma_f32_16x16x32_bf16 v[72:75], v[120:123], v[204:207], v[72:75]
    v_mfma_f32_16x16x32_bf16 v[88:91], v[120:123], v[220:223], v[88:91]
    ds_read_b128 v[120:123], v1 offset:55296
    s_waitcnt lgkmcnt(7)
    v_mfma_f32_16x16x32_bf16 v[76:79], v[124:127], v[204:207], v[76:79]
    v_mfma_f32_16x16x32_bf16 v[92:95], v[124:127], v[220:223], v[92:95]
    ds_read_b128 v[124:127], v1 offset:56320
    s_waitcnt vmcnt(6) lgkmcnt(7)
    v_mfma_f32_16x16x32_bf16 v[64:67], v[96:99], v[224:227], v[64:67]
    v_mfma_f32_16x16x32_bf16 v[80:83], v[96:99], v[240:243], v[80:83]
    ds_read_b128 v[96:99], v1 offset:57344
    s_waitcnt lgkmcnt(7)
    v_mfma_f32_16x16x32_bf16 v[68:71], v[100:103], v[224:227], v[68:71]
    v_mfma_f32_16x16x32_bf16 v[84:87], v[100:103], v[240:243], v[84:87]
    ds_read_b128 v[100:103], v1 offset:58368
    s_waitcnt lgkmcnt(7)
    v_mfma_f32_16x16x32_bf16 v[72:75], v[104:107], v[224:227], v[72:75]
    v_mfma_f32_16x16x32_bf16 v[88:91], v[104:107], v[240:243], v[88:91]
    ds_read_b128 v[104:107], v1 offset:59392
    s_waitcnt lgkmcnt(7)
    v_mfma_f32_16x16x32_bf16 v[76:79], v[108:111], v[224:227], v[76:79]
    v_mfma_f32_16x16x32_bf16 v[92:95], v[108:111], v[240:243], v[92:95]
    ds_read_b128 v[108:111], v1 offset:60416
    s_waitcnt vmcnt(4) lgkmcnt(7)
    v_mfma_f32_16x16x32_bf16 v[64:67], v[112:115], v[228:231], v[64:67]
    v_mfma_f32_16x16x32_bf16 v[80:83], v[112:115], v[244:247], v[80:83]
    ds_read_b128 v[112:115], v1 offset:61440
    s_waitcnt lgkmcnt(7)
    v_mfma_f32_16x16x32_bf16 v[68:71], v[116:119], v[228:231], v[68:71]
    v_mfma_f32_16x16x32_bf16 v[84:87], v[116:119], v[244:247], v[84:87]
    ds_read_b128 v[116:119], v1 offset:62464
    s_waitcnt lgkmcnt(7)
    v_mfma_f32_16x16x32_bf16 v[72:75], v[120:123], v[228:231], v[72:75]
    v_mfma_f32_16x16x32_bf16 v[88:91], v[120:123], v[244:247], v[88:91]
    ds_read_b128 v[120:123], v1 offset:63488
    s_waitcnt lgkmcnt(7)
    v_mfma_f32_16x16x32_bf16 v[76:79], v[124:127], v[228:231], v[76:79]
    v_mfma_f32_16x16x32_bf16 v[92:95], v[124:127], v[244:247], v[92:95]
    ds_read_b128 v[124:127], v1 offset:64512
    s_waitcnt vmcnt(2) lgkmcnt(7)
    v_mfma_f32_16x16x32_bf16 v[64:67], v[96:99], v[232:235], v[64:67]
    v_mfma_f32_16x16x32_bf16 v[80:83], v[96:99], v[248:251], v[80:83]
    s_waitcnt lgkmcnt(6)
    v_mfma_f32_16x16x32_bf16 v[68:71], v[100:103], v[232:235], v[68:71]
    v_mfma_f32_16x16x32_bf16 v[84:87], v[100:103], v[248:251], v[84:87]
    s_waitcnt lgkmcnt(5)
    v_mfma_f32_16x16x32_bf16 v[72:75], v[104:107], v[232:235], v[72:75]
    v_mfma_f32_16x16x32_bf16 v[88:91], v[104:107], v[248:251], v[88:91]
    s_waitcnt lgkmcnt(4)
    v_mfma_f32_16x16x32_bf16 v[76:79], v[108:111], v[232:235], v[76:79]
    v_mfma_f32_16x16x32_bf16 v[92:95], v[108:111], v[248:251], v[92:95]
    s_waitcnt vmcnt(0) lgkmcnt(3)
    v_mfma_f32_16x16x32_bf16 v[64:67], v[112:115], v[236:239], v[64:67]
    ds_read_b128 v[96:99], v13 offset:0
    v_mfma_f32_16x16x32_bf16 v[80:83], v[112:115], v[252:255], v[80:83]
    s_waitcnt lgkmcnt(3)
    v_mfma_f32_16x16x32_bf16 v[68:71], v[116:119], v[236:239], v[68:71]
    ds_read_b128 v[100:103], v13 offset:64
    v_mfma_f32_16x16x32_bf16 v[84:87], v[116:119], v[252:255], v[84:87]
    s_waitcnt lgkmcnt(3)
    v_mfma_f32_16x16x32_bf16 v[72:75], v[120:123], v[236:239], v[72:75]
    ds_read_b128 v[104:107], v13 offset:128
    v_mfma_f32_16x16x32_bf16 v[88:91], v[120:123], v[252:255], v[88:91]
    s_waitcnt lgkmcnt(3)
    v_mfma_f32_16x16x32_bf16 v[76:79], v[124:127], v[236:239], v[76:79]
    ds_read_b128 v[108:111], v13 offset:192
    v_mfma_f32_16x16x32_bf16 v[92:95], v[124:127], v[252:255], v[92:95]
    s_add_u32 s51, s50, 3
    v_mov_b32 v3, s51
    ds_write_b32 v14, v3 offset:0
.Lqepi_86:
    s_waitcnt lgkmcnt(1)
    s_nop 3
    v_pk_fma_f32 v[64:65], v[96:97], v[32:33], v[64:65] neg_lo:[0,1,0] neg_hi:[0,1,0]
    v_pk_fma_f32 v[66:67], v[98:99], v[32:33], v[66:67] neg_lo:[0,1,0] neg_hi:[0,1,0]
    v_pk_fma_f32 v[68:69], v[100:101], v[32:33], v[68:69] neg_lo:[0,1,0] neg_hi:[0,1,0]
    v_pk_fma_f32 v[70:71], v[102:103], v[32:33], v[70:71] neg_lo:[0,1,0] neg_hi:[0,1,0]
    v_pk_fma_f32 v[72:73], v[104:105], v[32:33], v[72:73] neg_lo:[0,1,0] neg_hi:[0,1,0]
    v_pk_fma_f32 v[74:75], v[106:107], v[32:33], v[74:75] neg_lo:[0,1,0] neg_hi:[0,1,0]
    v_pk_fma_f32 v[76:77], v[108:109], v[32:33], v[76:77] neg_lo:[0,1,0] neg_hi:[0,1,0]
    v_pk_fma_f32 v[78:79], v[110:111], v[32:33], v[78:79] neg_lo:[0,1,0] neg_hi:[0,1,0]
    v_pk_fma_f32 v[80:81], v[96:97], v[36:37], v[80:81] neg_lo:[0,1,0] neg_hi:[0,1,0]
    v_pk_fma_f32 v[82:83], v[98:99], v[36:37], v[82:83] neg_lo:[0,1,0] neg_hi:[0,1,0]
    v_pk_fma_f32 v[84:85], v[100:101], v[36:37], v[84:85] neg_lo:[0,1,0] neg_hi:[0,1,0]
    v_pk_fma_f32 v[86:87], v[102:103], v[36:37], v[86:87] neg_lo:[0,1,0] neg_hi:[0,1,0]
    v_pk_fma_f32 v[88:89], v[104:105], v[36:37], v[88:89] neg_lo:[0,1,0] neg_hi:[0,1,0]
    v_pk_fma_f32 v[90:91], v[106:107], v[36:37], v[90:91] neg_lo:[0,1,0] neg_hi:[0,1,0]
    v_pk_fma_f32 v[92:93], v[108:109], v[36:37], v[92:93] neg_lo:[0,1,0] neg_hi:[0,1,0]
    v_pk_fma_f32 v[94:95], v[110:111], v[36:37], v[94:95] neg_lo:[0,1,0] neg_hi:[0,1,0]
    v_permlane32_swap_b32 v64, v80
    v_permlane32_swap_b32 v65, v81
    v_permlane32_swap_b32 v66, v82
    v_permlane32_swap_b32 v67, v83
    v_permlane32_swap_b32 v68, v84
    v_permlane32_swap_b32 v69, v85
    v_permlane32_swap_b32 v70, v86
    v_permlane32_swap_b32 v71, v87
    v_pk_mul_f32 v[72:73], v[72:73], v[34:35]
    v_pk_mul_f32 v[74:75], v[74:75], v[34:35]
    v_cvt_pk_bf16_f32 v72, v72, v73
    v_cvt_pk_bf16_f32 v73, v74, v75
    ds_write_b64 v46, v[72:73] offset:256
    v_pk_mul_f32 v[76:77], v[76:77], v[34:35]
    v_pk_mul_f32 v[78:79], v[78:79], v[34:35]
    v_cvt_pk_bf16_f32 v76, v76, v77
    v_cvt_pk_bf16_f32 v77, v78, v79
    ds_write_b64 v46, v[76:77] offset:288
    v_pk_mul_f32 v[88:89], v[88:89], v[38:39]
    v_pk_mul_f32 v[90:91], v[90:91], v[38:39]
    v_cvt_pk_bf16_f32 v88, v88, v89
    v_cvt_pk_bf16_f32 v89, v90, v91
    ds_write_b64 v46, v[88:89] offset:5632
    v_pk_mul_f32 v[92:93], v[92:93], v[38:39]
    v_pk_mul_f32 v[94:95], v[94:95], v[38:39]
    v_cvt_pk_bf16_f32 v92, v92, v93
    v_cvt_pk_bf16_f32 v93, v94, v95
    ds_write_b64 v46, v[92:93] offset:5664
    v_max3_f32 v72, v64, v65, v66
    v_max3_f32 v72, v72, v67, v68
    v_max3_f32 v72, v72, v69, v70
    v_max3_f32 v72, v72, v71, v80
    v_max3_f32 v72, v72, v81, v82
    v_max3_f32 v72, v72, v83, v84
    v_max3_f32 v72, v72, v85, v86
    v_max_f32 v72, v72, v87
    v_min3_f32 v74, v64, v65, v66
    v_min3_f32 v74, v74, v67, v68
    v_min3_f32 v74, v74, v69, v70
    v_min3_f32 v74, v74, v71, v80
    v_min3_f32 v74, v74, v81, v82
    v_min3_f32 v74, v74, v83, v84
    v_min3_f32 v74, v74, v85, v86
    v_min_f32 v74, v74, v87
    v_mul_f32 v73, v72, v40
    v_mul_f32 v72, v72, v40
    v_mul_f32 v75, v74, v40
    v_mul_f32 v74, v74, v40
    v_pk_fma_f32 v[96:97], v[64:65], v[40:41], v[72:73] neg_lo:[0,0,1] neg_hi:[0,0,1]
    v_pk_fma_f32 v[112:113], v[64:65], v[40:41], v[74:75] neg_lo:[0,1,0] neg_hi:[0,1,0]
    v_pk_fma_f32 v[98:99], v[66:67], v[40:41], v[72:73] neg_lo:[0,0,1] neg_hi:[0,0,1]
    v_pk_fma_f32 v[114:115], v[66:67], v[40:41], v[74:75] neg_lo:[0,1,0] neg_hi:[0,1,0]
    v_pk_fma_f32 v[100:101], v[68:69], v[40:41], v[72:73] neg_lo:[0,0,1] neg_hi:[0,0,1]
    v_pk_fma_f32 v[116:117], v[68:69], v[40:41], v[74:75] neg_lo:[0,1,0] neg_hi:[0,1,0]
    v_pk_fma_f32 v[102:103], v[70:71], v[40:41], v[72:73] neg_lo:[0,0,1] neg_hi:[0,0,1]
    v_pk_fma_f32 v[118:119], v[70:71], v[40:41], v[74:75] neg_lo:[0,1,0] neg_hi:[0,1,0]
    v_pk_fma_f32 v[104:105], v[80:81], v[40:41], v[72:73] neg_lo:[0,0,1] neg_hi:[0,0,1]
    v_pk_fma_f32 v[120:121], v[80:81], v[40:41], v[74:75] neg_lo:[0,1,0] neg_hi:[0,1,0]
    v_pk_fma_f32 v[106:107], v[82:83], v[40:41], v[72:73] neg_lo:[0,0,1] neg_hi:[0,0,1]
    v_pk_fma_f32 v[122:123], v[82:83], v[40:41], v[74:75] neg_lo:[0,1,0] neg_hi:[0,1,0]
    v_pk_fma_f32 v[108:109], v[84:85], v[40:41], v[72:73] neg_lo:[0,0,1] neg_hi:[0,0,1]
    v_pk_fma_f32 v[124:125], v[84:85], v[40:41], v[74:75] neg_lo:[0,1,0] neg_hi:[0,1,0]
    v_pk_fma_f32 v[110:111], v[86:87], v[40:41], v[72:73] neg_lo:[0,0,1] neg_hi:[0,0,1]
    v_pk_fma_f32 v[126:127], v[86:87], v[40:41], v[74:75] neg_lo:[0,1,0] neg_hi:[0,1,0]
    v_exp_f32 v96, v96
    v_exp_f32 v97, v97
    v_exp_f32 v98, v98
    v_exp_f32 v99, v99
    v_exp_f32 v100, v100
    v_exp_f32 v101, v101
    v_exp_f32 v102, v102
    v_exp_f32 v103, v103
    v_exp_f32 v104, v104
    v_exp_f32 v105, v105
    v_exp_f32 v106, v106
    v_exp_f32 v107, v107
    v_exp_f32 v108, v108
    v_exp_f32 v109, v109
    v_exp_f32 v110, v110
    v_exp_f32 v111, v111
    v_exp_f32 v112, v112
    v_exp_f32 v113, v113
    v_exp_f32 v114, v114
    v_exp_f32 v115, v115
    v_exp_f32 v116, v116
    v_exp_f32 v117, v117
    v_exp_f32 v118, v118
    v_exp_f32 v119, v119
    v_exp_f32 v120, v120
    v_exp_f32 v121, v121
    v_exp_f32 v122, v122
    v_exp_f32 v123, v123
    v_exp_f32 v124, v124
    v_exp_f32 v125, v125
    v_exp_f32 v126, v126
    v_exp_f32 v127, v127
    v_pk_add_f32 v[76:77], v[96:97], v[98:99]
    v_pk_add_f32 v[76:77], v[76:77], v[100:101]
    v_pk_add_f32 v[76:77], v[76:77], v[102:103]
    v_pk_add_f32 v[76:77], v[76:77], v[104:105]
    v_pk_add_f32 v[76:77], v[76:77], v[106:107]
    v_pk_add_f32 v[76:77], v[76:77], v[108:109]
    v_pk_add_f32 v[76:77], v[76:77], v[110:111]
    v_pk_add_f32 v[78:79], v[112:113], v[114:115]
    v_pk_add_f32 v[78:79], v[78:79], v[116:117]
    v_pk_add_f32 v[78:79], v[78:79], v[118:119]
    v_pk_add_f32 v[78:79], v[78:79], v[120:121]
    v_pk_add_f32 v[78:79], v[78:79], v[122:123]
    v_pk_add_f32 v[78:79], v[78:79], v[124:125]
    v_pk_add_f32 v[78:79], v[78:79], v[126:127]
    v_add_f32 v76, v76, v77
    v_add_f32 v78, v78, v79
    v_rcp_f32 v76, v76
    v_rcp_f32 v78, v78
    v_mov_b32 v77, v76
    v_mov_b32 v79, v78
    v_pk_mul_f32 v[96:97], v[96:97], v[76:77]
    v_pk_mul_f32 v[112:113], v[112:113], v[78:79]
    v_pk_mul_f32 v[98:99], v[98:99], v[76:77]
    v_pk_mul_f32 v[114:115], v[114:115], v[78:79]
    v_cvt_pk_bf16_f32 v64, v96, v97
    v_cvt_pk_bf16_f32 v65, v98, v99
    v_cvt_pk_bf16_f32 v66, v112, v113
    v_cvt_pk_bf16_f32 v67, v114, v115
    ds_write_b128 v45, v[64:67] offset:128
    v_pk_mul_f32 v[100:101], v[100:101], v[76:77]
    v_pk_mul_f32 v[116:117], v[116:117], v[78:79]
    v_pk_mul_f32 v[102:103], v[102:103], v[76:77]
    v_pk_mul_f32 v[118:119], v[118:119], v[78:79]
    v_cvt_pk_bf16_f32 v68, v100, v101
    v_cvt_pk_bf16_f32 v69, v102, v103
    v_cvt_pk_bf16_f32 v70, v116, v117
    v_cvt_pk_bf16_f32 v71, v118, v119
    ds_write_b128 v45, v[68:71] offset:144
    v_pk_mul_f32 v[104:105], v[104:105], v[76:77]
    v_pk_mul_f32 v[120:121], v[120:121], v[78:79]
    v_pk_mul_f32 v[106:107], v[106:107], v[76:77]
    v_pk_mul_f32 v[122:123], v[122:123], v[78:79]
    v_cvt_pk_bf16_f32 v80, v104, v105
    v_cvt_pk_bf16_f32 v81, v106, v107
    v_cvt_pk_bf16_f32 v82, v120, v121
    v_cvt_pk_bf16_f32 v83, v122, v123
    ds_write_b128 v45, v[80:83] offset:160
    v_pk_mul_f32 v[108:109], v[108:109], v[76:77]
    v_pk_mul_f32 v[124:125], v[124:125], v[78:79]
    v_pk_mul_f32 v[110:111], v[110:111], v[76:77]
    v_pk_mul_f32 v[126:127], v[126:127], v[78:79]
    v_cvt_pk_bf16_f32 v84, v108, v109
    v_cvt_pk_bf16_f32 v85, v110, v111
    v_cvt_pk_bf16_f32 v86, v124, v125
    v_cvt_pk_bf16_f32 v87, v126, v127
    ds_write_b128 v45, v[84:87] offset:176
    s_add_u32 s51, s50, 1
    v_mov_b32 v3, s51
    ds_write_b32 v14, v3 offset:32
    s_add_u32 s51, s50, 2
.Llw_111:
    ds_read_b128 v[60:63], v15 offset:16
    s_waitcnt lgkmcnt(0)
    v_min_u32 v60, v60, v61
    v_min3_u32 v60, v60, v62, v63
    v_cmp_le_u32 vcc, s51, v60
    s_cbranch_vccnz .Llwd_112
    s_sub_u32 s23, s23, 1
    s_cbranch_scc1 .Lexit_1
    s_branch .Llw_111
.Llwd_112:
    s_mov_b32 s51, 2
.Llw_113:
    ds_read_b128 v[60:63], v15 offset:80
    s_waitcnt lgkmcnt(0)
    v_min_u32 v60, v60, v61
    v_min3_u32 v60, v60, v62, v63
    v_cmp_le_u32 vcc, s51, v60
    s_cbranch_vccnz .Llwd_114
    s_sub_u32 s23, s23, 1
    s_cbranch_scc1 .Lexit_1
    s_branch .Llw_113
.Llwd_114:
    ds_read_b128 v[88:91], v13 offset:256
    ds_read_b128 v[92:95], v13 offset:320
    ds_read_b128 v[96:99], v4 offset:0
    ds_read_b128 v[100:103], v4 offset:1024
    ds_read_b128 v[104:107], v4 offset:2048
    ds_read_b128 v[108:111], v4 offset:3072
    ds_read_b128 v[112:115], v4 offset:4096
    ds_read_b128 v[116:119], v4 offset:5120
    ds_read_b128 v[120:123], v4 offset:6144
    ds_read_b128 v[124:127], v4 offset:7168
    s_waitcnt lgkmcnt(7)
    v_mfma_f32_16x16x32_bf16 v[72:75], v[96:99], v[128:131], 0
    v_mfma_f32_16x16x32_bf16 v[80:83], v[96:99], v[144:147], 0
    ds_read_b128 v[96:99], v4 offset:8192
    s_waitcnt lgkmcnt(7)
    v_mfma_f32_16x16x32_bf16 v[76:79], v[100:103], v[128:131], 0
    v_mfma_f32_16x16x32_bf16 v[84:87], v[100:103], v[144:147], 0
    ds_read_b128 v[100:103], v4 offset:9216
    s_waitcnt lgkmcnt(7)
    v_mfma_f32_16x16x32_bf16 v[72:75], v[104:107], v[132:135], v[72:75]
    v_mfma_f32_16x16x32_bf16 v[80:83], v[104:107], v[148:151], v[80:83]
    ds_read_b128 v[104:107], v4 offset:10240
    s_waitcnt lgkmcnt(7)
    v_mfma_f32_16x16x32_bf16 v[76:79], v[108:111], v[132:135], v[76:79]
    v_mfma_f32_16x16x32_bf16 v[84:87], v[108:111], v[148:151], v[84:87]
    ds_read_b128 v[108:111], v4 offset:11264
    s_waitcnt lgkmcnt(7)
    v_mfma_f32_16x16x32_bf16 v[72:75], v[112:115], v[136:139], v[72:75]
    v_mfma_f32_16x16x32_bf16 v[80:83], v[112:115], v[152:155], v[80:83]
    ds_read_b128 v[112:115], v4 offset:12288
    s_waitcnt lgkmcnt(7)
    v_mfma_f32_16x16x32_bf16 v[76:79], v[116:119], v[136:139], v[76:79]
    v_mfma_f32_16x16x32_bf16 v[84:87], v[116:119], v[152:155], v[84:87]
    ds_read_b128 v[116:119], v4 offset:13312
    s_waitcnt lgkmcnt(7)
    v_mfma_f32_16x16x32_bf16 v[72:75], v[120:123], v[140:143], v[72:75]
    v_mfma_f32_16x16x32_bf16 v[80:83], v[120:123], v[156:159], v[80:83]
    ds_read_b128 v[120:123], v4 offset:14336
    s_waitcnt lgkmcnt(7)
    v_mfma_f32_16x16x32_bf16 v[76:79], v[124:127], v[140:143], v[76:79]
    v_mfma_f32_16x16x32_bf16 v[84:87], v[124:127], v[156:159], v[84:87]
    ds_read_b128 v[124:127], v4 offset:15360
    s_waitcnt lgkmcnt(7)
    v_mfma_f32_16x16x32_bf16 v[72:75], v[96:99], v[160:163], v[72:75]
    v_mfma_f32_16x16x32_bf16 v[80:83], v[96:99], v[176:179], v[80:83]
    ds_read_b128 v[96:99], v4 offset:16384
    s_waitcnt lgkmcnt(7)
    v_mfma_f32_16x16x32_bf16 v[76:79], v[100:103], v[160:163], v[76:79]
    v_mfma_f32_16x16x32_bf16 v[84:87], v[100:103], v[176:179], v[84:87]
    ds_read_b128 v[100:103], v4 offset:17408
    s_waitcnt lgkmcnt(7)
    v_mfma_f32_16x16x32_bf16 v[72:75], v[104:107], v[164:167], v[72:75]
    v_mfma_f32_16x16x32_bf16 v[80:83], v[104:107], v[180:183], v[80:83]
    ds_read_b128 v[104:107], v4 offset:18432
    s_waitcnt lgkmcnt(7)
    v_mfma_f32_16x16x32_bf16 v[76:79], v[108:111], v[164:167], v[76:79]
    v_mfma_f32_16x16x32_bf16 v[84:87], v[108:111], v[180:183], v[84:87]
    ds_read_b128 v[108:111], v4 offset:19456
    s_waitcnt lgkmcnt(7)
    v_mfma_f32_16x16x32_bf16 v[72:75], v[112:115], v[168:171], v[72:75]
    v_mfma_f32_16x16x32_bf16 v[80:83], v[112:115], v[184:187], v[80:83]
    ds_read_b128 v[112:115], v4 offset:20480
    s_waitcnt lgkmcnt(7)
    v_mfma_f32_16x16x32_bf16 v[76:79], v[116:119], v[168:171], v[76:79]
    v_mfma_f32_16x16x32_bf16 v[84:87], v[116:119], v[184:187], v[84:87]
    ds_read_b128 v[116:119], v4 offset:21504
    s_waitcnt lgkmcnt(7)
    v_mfma_f32_16x16x32_bf16 v[72:75], v[120:123], v[172:175], v[72:75]
    v_mfma_f32_16x16x32_bf16 v[80:83], v[120:123], v[188:191], v[80:83]
    ds_read_b128 v[120:123], v4 offset:22528
    s_waitcnt lgkmcnt(7)
    v_mfma_f32_16x16x32_bf16 v[76:79], v[124:127], v[172:175], v[76:79]
    v_mfma_f32_16x16x32_bf16 v[84:87], v[124:127], v[188:191], v[84:87]
    ds_read_b128 v[124:127], v4 offset:23552
    s_waitcnt lgkmcnt(7)
    v_mfma_f32_16x16x32_bf16 v[72:75], v[96:99], v[192:195], v[72:75]
    v_mfma_f32_16x16x32_bf16 v[80:83], v[96:99], v[208:211], v[80:83]
    ds_read_b128 v[96:99], v4 offset:24576
    s_waitcnt lgkmcnt(7)
    v_mfma_f32_16x16x32_bf16 v[76:79], v[100:103], v[192:195], v[76:79]
    v_mfma_f32_16x16x32_bf16 v[84:87], v[100:103], v[208:211], v[84:87]
    ds_read_b128 v[100:103], v4 offset:25600
    s_waitcnt lgkmcnt(7)
    v_mfma_f32_16x16x32_bf16 v[72:75], v[104:107], v[196:199], v[72:75]
    v_mfma_f32_16x16x32_bf16 v[80:83], v[104:107], v[212:215], v[80:83]
    ds_read_b128 v[104:107], v4 offset:26624
    s_waitcnt lgkmcnt(7)
    v_mfma_f32_16x16x32_bf16 v[76:79], v[108:111], v[196:199], v[76:79]
    v_mfma_f32_16x16x32_bf16 v[84:87], v[108:111], v[212:215], v[84:87]
    ds_read_b128 v[108:111], v4 offset:27648
    s_waitcnt lgkmcnt(7)
    v_mfma_f32_16x16x32_bf16 v[72:75], v[112:115], v[200:203], v[72:75]
    v_mfma_f32_16x16x32_bf16 v[80:83], v[112:115], v[216:219], v[80:83]
    ds_read_b128 v[112:115], v4 offset:28672
    s_waitcnt lgkmcnt(7)
    v_mfma_f32_16x16x32_bf16 v[76:79], v[116:119], v[200:203], v[76:79]
    v_mfma_f32_16x16x32_bf16 v[84:87], v[116:119], v[216:219], v[84:87]
    ds_read_b128 v[116:119], v4 offset:29696
    s_waitcnt lgkmcnt(7)
    v_mfma_f32_16x16x32_bf16 v[72:75], v[120:123], v[204:207], v[72:75]
    v_mfma_f32_16x16x32_bf16 v[80:83], v[120:123], v[220:223], v[80:83]
    ds_read_b128 v[120:123], v4 offset:30720
    s_waitcnt lgkmcnt(7)
    v_mfma_f32_16x16x32_bf16 v[76:79], v[124:127], v[204:207], v[76:79]
    v_mfma_f32_16x16x32_bf16 v[84:87], v[124:127], v[220:223], v[84:87]
    ds_read_b128 v[124:127], v4 offset:31744
    s_waitcnt lgkmcnt(7)
    v_mfma_f32_16x16x32_bf16 v[72:75], v[96:99], v[224:227], v[72:75]
    v_mfma_f32_16x16x32_bf16 v[80:83], v[96:99], v[240:243], v[80:83]
    s_waitcnt lgkmcnt(6)
    v_mfma_f32_16x16x32_bf16 v[76:79], v[100:103], v[224:227], v[76:79]
    v_mfma_f32_16x16x32_bf16 v[84:87], v[100:103], v[240:243], v[84:87]
    s_waitcnt lgkmcnt(5)
    v_mfma_f32_16x16x32_bf16 v[72:75], v[104:107], v[228:231], v[72:75]
    v_mfma_f32_16x16x32_bf16 v[80:83], v[104:107], v[244:247], v[80:83]
    s_waitcnt lgkmcnt(4)
    v_mfma_f32_16x16x32_bf16 v[76:79], v[108:111], v[228:231], v[76:79]
    v_mfma_f32_16x16x32_bf16 v[84:87], v[108:111], v[244:247], v[84:87]
    s_waitcnt lgkmcnt(3)
    v_mfma_f32_16x16x32_bf16 v[72:75], v[112:115], v[232:235], v[72:75]
    v_mfma_f32_16x16x32_bf16 v[80:83], v[112:115], v[248:251], v[80:83]
    s_waitcnt lgkmcnt(2)
    v_mfma_f32_16x16x32_bf16 v[76:79], v[116:119], v[232:235], v[76:79]
    v_mfma_f32_16x16x32_bf16 v[84:87], v[116:119], v[248:251], v[84:87]
    s_waitcnt lgkmcnt(1)
    v_mfma_f32_16x16x32_bf16 v[72:75], v[120:123], v[236:239], v[72:75]
    v_mfma_f32_16x16x32_bf16 v[80:83], v[120:123], v[252:255], v[80:83]
    s_waitcnt lgkmcnt(0)
    v_mfma_f32_16x16x32_bf16 v[76:79], v[124:127], v[236:239], v[76:79]
    v_mfma_f32_16x16x32_bf16 v[84:87], v[124:127], v[252:255], v[84:87]
    s_nop 3
    v_pk_fma_f32 v[72:73], v[88:89], v[32:33], v[72:73] neg_lo:[0,1,0] neg_hi:[0,1,0]
    v_pk_fma_f32 v[74:75], v[90:91], v[32:33], v[74:75] neg_lo:[0,1,0] neg_hi:[0,1,0]
    s_nop 0
    v_pk_fma_f32 v[76:77], v[92:93], v[32:33], v[76:77] neg_lo:[0,1,0] neg_hi:[0,1,0]
    v_pk_fma_f32 v[78:79], v[94:95], v[32:33], v[78:79] neg_lo:[0,1,0] neg_hi:[0,1,0]
    v_pk_fma_f32 v[80:81], v[88:89], v[36:37], v[80:81] neg_lo:[0,1,0] neg_hi:[0,1,0]
    v_pk_fma_f32 v[82:83], v[90:91], v[36:37], v[82:83] neg_lo:[0,1,0] neg_hi:[0,1,0]
    v_pk_fma_f32 v[84:85], v[92:93], v[36:37], v[84:85] neg_lo:[0,1,0] neg_hi:[0,1,0]
    v_pk_fma_f32 v[86:87], v[94:95], v[36:37], v[86:87] neg_lo:[0,1,0] neg_hi:[0,1,0]
    v_permlane32_swap_b32 v72, v80
    v_permlane32_swap_b32 v73, v81
    v_permlane32_swap_b32 v74, v82
    v_permlane32_swap_b32 v75, v83
    v_permlane32_swap_b32 v76, v84
    v_permlane32_swap_b32 v77, v85
    v_permlane32_swap_b32 v78, v86
    v_permlane32_swap_b32 v79, v87
    v_max3_f32 v64, v72, v73, v74
    v_max3_f32 v64, v64, v75, v76
    v_max3_f32 v64, v64, v77, v78
    v_max3_f32 v64, v64, v79, v80
    v_max3_f32 v64, v64, v81, v82
    v_max3_f32 v64, v64, v83, v84
    v_max3_f32 v64, v64, v85, v86
    v_max_f32 v64, v64, v87
    v_min3_f32 v66, v72, v73, v74
    v_min3_f32 v66, v66, v75, v76
    v_min3_f32 v66, v66, v77, v78
    v_min3_f32 v66, v66, v79, v80
    v_min3_f32 v66, v66, v81, v82
    v_min3_f32 v66, v66, v83, v84
    v_min3_f32 v66, v66, v85, v86
    v_min_f32 v66, v66, v87
    v_mul_f32 v65, v64, v40
    v_mul_f32 v64, v64, v40
    v_mul_f32 v67, v66, v40
    v_mul_f32 v66, v66, v40
    v_pk_fma_f32 v[96:97], v[72:73], v[40:41], v[64:65] neg_lo:[0,0,1] neg_hi:[0,0,1]
    v_pk_fma_f32 v[112:113], v[72:73], v[40:41], v[66:67] neg_lo:[0,1,0] neg_hi:[0,1,0]
    v_pk_fma_f32 v[98:99], v[74:75], v[40:41], v[64:65] neg_lo:[0,0,1] neg_hi:[0,0,1]
    v_pk_fma_f32 v[114:115], v[74:75], v[40:41], v[66:67] neg_lo:[0,1,0] neg_hi:[0,1,0]
    v_pk_fma_f32 v[100:101], v[76:77], v[40:41], v[64:65] neg_lo:[0,0,1] neg_hi:[0,0,1]
    v_pk_fma_f32 v[116:117], v[76:77], v[40:41], v[66:67] neg_lo:[0,1,0] neg_hi:[0,1,0]
    v_pk_fma_f32 v[102:103], v[78:79], v[40:41], v[64:65] neg_lo:[0,0,1] neg_hi:[0,0,1]
    v_pk_fma_f32 v[118:119], v[78:79], v[40:41], v[66:67] neg_lo:[0,1,0] neg_hi:[0,1,0]
    v_pk_fma_f32 v[104:105], v[80:81], v[40:41], v[64:65] neg_lo:[0,0,1] neg_hi:[0,0,1]
    v_pk_fma_f32 v[120:121], v[80:81], v[40:41], v[66:67] neg_lo:[0,1,0] neg_hi:[0,1,0]
    v_pk_fma_f32 v[106:107], v[82:83], v[40:41], v[64:65] neg_lo:[0,0,1] neg_hi:[0,0,1]
    v_pk_fma_f32 v[122:123], v[82:83], v[40:41], v[66:67] neg_lo:[0,1,0] neg_hi:[0,1,0]
    v_pk_fma_f32 v[108:109], v[84:85], v[40:41], v[64:65] neg_lo:[0,0,1] neg_hi:[0,0,1]
    v_pk_fma_f32 v[124:125], v[84:85], v[40:41], v[66:67] neg_lo:[0,1,0] neg_hi:[0,1,0]
    v_pk_fma_f32 v[110:111], v[86:87], v[40:41], v[64:65] neg_lo:[0,0,1] neg_hi:[0,0,1]
    v_pk_fma_f32 v[126:127], v[86:87], v[40:41], v[66:67] neg_lo:[0,1,0] neg_hi:[0,1,0]
    v_exp_f32 v96, v96
    v_exp_f32 v97, v97
    v_exp_f32 v98, v98
    v_exp_f32 v99, v99
    v_exp_f32 v100, v100
    v_exp_f32 v101, v101
    v_exp_f32 v102, v102
    v_exp_f32 v103, v103
    v_exp_f32 v104, v104
    v_exp_f32 v105, v105
    v_exp_f32 v106, v106
    v_exp_f32 v107, v107
    v_exp_f32 v108, v108
    v_exp_f32 v109, v109
    v_exp_f32 v110, v110
    v_exp_f32 v111, v111
    v_exp_f32 v112, v112
    v_exp_f32 v113, v113
    v_exp_f32 v114, v114
    v_exp_f32 v115, v115
    v_exp_f32 v116, v116
    v_exp_f32 v117, v117
    v_exp_f32 v118, v118
    v_exp_f32 v119, v119
    v_exp_f32 v120, v120
    v_exp_f32 v121, v121
    v_exp_f32 v122, v122
    v_exp_f32 v123, v123
    v_exp_f32 v124, v124
    v_exp_f32 v125, v125
    v_exp_f32 v126, v126
    v_exp_f32 v127, v127
    v_pk_add_f32 v[68:69], v[96:97], v[98:99]
    v_pk_add_f32 v[68:69], v[68:69], v[100:101]
    v_pk_add_f32 v[68:69], v[68:69], v[102:103]
    v_pk_add_f32 v[68:69], v[68:69], v[104:105]
    v_pk_add_f32 v[68:69], v[68:69], v[106:107]
    v_pk_add_f32 v[68:69], v[68:69], v[108:109]
    v_pk_add_f32 v[68:69], v[68:69], v[110:111]
    v_pk_add_f32 v[70:71], v[112:113], v[114:115]
    v_pk_add_f32 v[70:71], v[70:71], v[116:117]
    v_pk_add_f32 v[70:71], v[70:71], v[118:119]
    v_pk_add_f32 v[70:71], v[70:71], v[120:121]
    v_pk_add_f32 v[70:71], v[70:71], v[122:123]
    v_pk_add_f32 v[70:71], v[70:71], v[124:125]
    v_pk_add_f32 v[70:71], v[70:71], v[126:127]
    v_add_f32 v68, v68, v69
    v_add_f32 v70, v70, v71
    v_rcp_f32 v68, v68
    v_rcp_f32 v70, v70
    v_mov_b32 v69, v68
    v_mov_b32 v71, v70
    v_pk_mul_f32 v[96:97], v[96:97], v[68:69]
    v_pk_mul_f32 v[112:113], v[112:113], v[70:71]
    v_pk_mul_f32 v[98:99], v[98:99], v[68:69]
    v_pk_mul_f32 v[114:115], v[114:115], v[70:71]
    v_cvt_pk_bf16_f32 v72, v96, v97
    v_cvt_pk_bf16_f32 v73, v98, v99
    v_cvt_pk_bf16_f32 v74, v112, v113
    v_cvt_pk_bf16_f32 v75, v114, v115
    ds_write_b128 v45, v[72:75] offset:0
    v_pk_mul_f32 v[100:101], v[100:101], v[68:69]
    v_pk_mul_f32 v[116:117], v[116:117], v[70:71]
    v_pk_mul_f32 v[102:103], v[102:103], v[68:69]
    v_pk_mul_f32 v[118:119], v[118:119], v[70:71]
    v_cvt_pk_bf16_f32 v76, v100, v101
    v_cvt_pk_bf16_f32 v77, v102, v103
    v_cvt_pk_bf16_f32 v78, v116, v117
    v_cvt_pk_bf16_f32 v79, v118, v119
    ds_write_b128 v45, v[76:79] offset:16
    v_pk_mul_f32 v[104:105], v[104:105], v[68:69]
    v_pk_mul_f32 v[120:121], v[120:121], v[70:71]
    v_pk_mul_f32 v[106:107], v[106:107], v[68:69]
    v_pk_mul_f32 v[122:123], v[122:123], v[70:71]
    v_cvt_pk_bf16_f32 v80, v104, v105
    v_cvt_pk_bf16_f32 v81, v106, v107
    v_cvt_pk_bf16_f32 v82, v120, v121
    v_cvt_pk_bf16_f32 v83, v122, v123
    ds_write_b128 v45, v[80:83] offset:32
    v_pk_mul_f32 v[108:109], v[108:109], v[68:69]
    v_pk_mul_f32 v[124:125], v[124:125], v[70:71]
    v_pk_mul_f32 v[110:111], v[110:111], v[68:69]
    v_pk_mul_f32 v[126:127], v[126:127], v[70:71]
    v_cvt_pk_bf16_f32 v84, v108, v109
    v_cvt_pk_bf16_f32 v85, v110, v111
    v_cvt_pk_bf16_f32 v86, v124, v125
    v_cvt_pk_bf16_f32 v87, v126, v127
    ds_write_b128 v45, v[84:87] offset:48
    ds_read_b128 v[160:163], v44 offset:0
    ds_read_b128 v[164:167], v44 offset:64
    ds_read_b128 v[168:171], v44 offset:5376
    ds_read_b128 v[172:175], v44 offset:5440
    s_lshl_b32 s30, s19, 12
    s_add_u32 s30, s30, s44
    s_add_u32 s30, s30, 7025408
    v_lshlrev_b32 v47, 10, v2
    s_lshl_b32 s26, s18, 14
    s_lshl_b32 s27, s19, 10
    s_add_u32 s26, s26, s27
    s_add_u32 s26, s26, s20
    s_add_u32 s26, s26, 9383936
    s_add_u32 s27, s26, 16384
    s_add_u32 s51, s50, 4
    v_mov_b32 v3, s51
    ds_write_b32 v14, v3 offset:0
    s_cmp_lg_u32 s8, 0
    s_cbranch_scc1 .Lkvw_115
    s_add_u32 s51, s50, 1
.Llw_118:
    ds_read_b128 v[252:255], v15 offset:128
    s_waitcnt lgkmcnt(0)
    v_min_u32 v252, v252, v253
    v_min3_u32 v252, v252, v254, v255
    v_cmp_le_u32 vcc, s51, v252
    s_cbranch_vccnz .Llwd_119
    s_sub_u32 s23, s23, 1
    s_cbranch_scc1 .Lexit_1
    s_branch .Llw_118
.Llwd_119:
    s_mov_b64 exec, 0xf
.Lpoll_120:
    v_mov_b32 v3, 0
    buffer_atomic_add v3, v47, s[4:7], s30 offen sc0
.Lpollc_122:
    s_waitcnt vmcnt(0)
    v_cmp_le_u32 vcc, 16, v3
    s_nop 0
    s_cmp_eq_u64 vcc, exec
    s_cbranch_scc1 .Lpolld_123
    s_sub_u32 s23, s23, 1
    s_cbranch_scc1 .Lexit_1
    s_branch .Lpoll_120
.Lpolld_123:
    s_mov_b64 exec, -1
.Lkvg_116:
    s_add_u32 s51, s50, 1
    v_mov_b32 v3, s51
    ds_write_b32 v14, v3 offset:52
    s_branch .Lkvx_117
.Lkvw_115:
    s_add_u32 s51, s50, 1
.Llw_124:
    ds_read_b32 v252, v15 offset:52
    s_waitcnt lgkmcnt(0)
    v_cmp_le_u32 vcc, s51, v252
    s_cbranch_vccnz .Llwd_125
    s_sub_u32 s23, s23, 1
    s_cbranch_scc1 .Lexit_1
    s_branch .Llw_124
.Llwd_125:
.Lkvx_117:
    s_cmp_eq_u32 s21, 0
    s_cbranch_scc0 .Lmode_126
    s_waitcnt vmcnt(0)
    v_lshlrev_b32 v16, 16, v24
    v_and_b32 v17, 0xffff0000, v24
    v_lshlrev_b32 v18, 16, v25
    v_and_b32 v19, 0xffff0000, v25
    v_lshlrev_b32 v20, 16, v26
    v_and_b32 v21, 0xffff0000, v26
    v_lshlrev_b32 v22, 16, v27
    v_and_b32 v23, 0xffff0000, v27
    v_lshlrev_b32 v24, 16, v28
    v_and_b32 v25, 0xffff0000, v28
    v_lshlrev_b32 v26, 16, v29
    v_and_b32 v27, 0xffff0000, v29
    v_lshlrev_b32 v28, 16, v30
    v_and_b32 v29, 0xffff0000, v30
    v_lshlrev_b32 v30, 16, v31
    v_and_b32 v31, 0xffff0000, v31
    s_add_u32 s51, s50, 1
.Llw_127:
    ds_read_b32 v252, v15 offset:48
    s_waitcnt lgkmcnt(0)
    v_cmp_le_u32 vcc, s51, v252
    s_cbranch_vccnz .Llwd_128
    s_sub_u32 s23, s23, 1
    s_cbranch_scc1 .Lexit_1
    s_branch .Llw_127
.Llwd_128:
    v_readfirstlane_b32 s45, v252
    s_nop 0
    s_sub_u32 s45, s45, 1
.Lmode_126:
    buffer_load_dword v64, v7, s[4:7], s42 offen sc1
    buffer_load_dword v65, v7, s[4:7], s42 offen offset:256 sc1
    buffer_load_dword v66, v7, s[4:7], s42 offen offset:512 sc1
    buffer_load_dword v67, v7, s[4:7], s42 offen offset:768 sc1
    buffer_load_dword v68, v7, s[4:7], s42 offen offset:1024 sc1
    buffer_load_dword v69, v7, s[4:7], s42 offen offset:1280 sc1
    buffer_load_dword v70, v7, s[4:7], s42 offen offset:1536 sc1
    buffer_load_dword v71, v7, s[4:7], s42 offen offset:1792 sc1
    buffer_load_dword v72, v7, s[4:7], s42 offen offset:2048 sc1
    buffer_load_dword v73, v7, s[4:7], s42 offen offset:2304 sc1
    buffer_load_dword v74, v7, s[4:7], s42 offen offset:2560 sc1
    buffer_load_dword v75, v7, s[4:7], s42 offen offset:2816 sc1
    buffer_load_dword v76, v7, s[4:7], s42 offen offset:3072 sc1
    buffer_load_dword v77, v7, s[4:7], s42 offen offset:3328 sc1
    buffer_load_dword v78, v7, s[4:7], s42 offen offset:3584 sc1
    buffer_load_dword v79, v7, s[4:7], s42 offen offset:3840 sc1
    buffer_load_dwordx4 v[80:83], v50, s[4:7], s43 offen sc1
    buffer_load_dwordx4 v[84:87], v50, s[4:7], s43 offen offset:16 sc1
    buffer_load_dwordx4 v[88:91], v50, s[4:7], s43 offen offset:128 sc1
    buffer_load_dwordx4 v[92:95], v50, s[4:7], s43 offen offset:144 sc1
    s_waitcnt vmcnt(4)
    v_cvt_pk_bf16_f32 v96, v64, v65
    v_cvt_pk_bf16_f32 v97, v66, v67
    v_cvt_pk_bf16_f32 v98, v68, v69
    v_cvt_pk_bf16_f32 v99, v70, v71
    v_cvt_pk_bf16_f32 v100, v72, v73
    v_cvt_pk_bf16_f32 v101, v74, v75
    v_cvt_pk_bf16_f32 v102, v76, v77
    v_cvt_pk_bf16_f32 v103, v78, v79
    s_waitcnt vmcnt(0) lgkmcnt(0)
    v_cvt_pk_bf16_f32 v104, v80, v81
    v_cvt_pk_bf16_f32 v105, v82, v83
    v_cvt_pk_bf16_f32 v106, v84, v85
    v_cvt_pk_bf16_f32 v107, v86, v87
    v_cvt_pk_bf16_f32 v108, v88, v89
    v_cvt_pk_bf16_f32 v109, v90, v91
    v_cvt_pk_bf16_f32 v110, v92, v93
    v_cvt_pk_bf16_f32 v111, v94, v95
    v_mfma_f32_16x16x32_bf16 v[116:119], v[104:107], v[160:163], v[56:59]
    v_mfma_f32_16x16x32_bf16 v[112:115], v[96:99], v[160:163], 0
    v_mfma_f32_16x16x32_bf16 v[124:127], v[108:111], v[164:167], v[56:59]
    v_mfma_f32_16x16x32_bf16 v[120:123], v[100:103], v[164:167], 0
    v_mfma_f32_16x16x32_bf16 v[132:135], v[104:107], v[168:171], v[56:59]
    v_mfma_f32_16x16x32_bf16 v[128:131], v[96:99], v[168:171], 0
    v_mfma_f32_16x16x32_bf16 v[140:143], v[108:111], v[172:175], v[56:59]
    v_mfma_f32_16x16x32_bf16 v[136:139], v[100:103], v[172:175], 0
    s_nop 0
    v_rcp_f32 v116, v116
    s_nop 0
    v_rcp_f32 v124, v124
    s_nop 0
    v_rcp_f32 v132, v132
    s_nop 0
    v_rcp_f32 v140, v140
    v_mov_b32 v117, v116
    v_mov_b32 v125, v124
    v_mov_b32 v133, v132
    v_mov_b32 v141, v140
    v_pk_mul_f32 v[112:113], v[112:113], v[116:117]
    v_pk_mul_f32 v[114:115], v[114:115], v[116:117]
    v_cvt_pk_bf16_f32 v64, v112, v113
    v_cvt_pk_bf16_f32 v65, v114, v115
    v_pk_mul_f32 v[120:121], v[120:121], v[124:125]
    v_pk_mul_f32 v[122:123], v[122:123], v[124:125]
    v_cvt_pk_bf16_f32 v66, v120, v121
    v_cvt_pk_bf16_f32 v67, v122, v123
    v_pk_mul_f32 v[128:129], v[128:129], v[132:133]
    v_pk_mul_f32 v[130:131], v[130:131], v[132:133]
    v_cvt_pk_bf16_f32 v68, v128, v129
    v_cvt_pk_bf16_f32 v69, v130, v131
    v_pk_mul_f32 v[136:137], v[136:137], v[140:141]
    v_pk_mul_f32 v[138:139], v[138:139], v[140:141]
    v_cvt_pk_bf16_f32 v70, v136, v137
    v_cvt_pk_bf16_f32 v71, v138, v139
    s_cmp_eq_u32 s49, 0
    s_cbranch_scc1 .Lsts_129
    buffer_store_dwordx4 v[64:67], v1, s[4:7], s26 offen
    buffer_store_dwordx4 v[68:71], v1, s[4:7], s27 offen
    s_branch .Lstd_130
.Lsts_129:
    buffer_store_dwordx4 v[64:67], v1, s[4:7], s26 offen sc1
    buffer_store_dwordx4 v[68:71], v1, s[4:7], s27 offen sc1
.Lstd_130:
    s_waitcnt vmcnt(0)
    s_cmp_eq_u32 s45, 0
    s_cbranch_scc1 .Lsts_131
    s_mov_b64 exec, 0x101
    buffer_store_dword v8, v9, s[4:7], s48 offen offset:128
    s_mov_b64 exec, -1
    s_branch .Lstd_132
.Lsts_131:
    s_mov_b64 exec, 0x101
    buffer_store_dword v8, v9, s[4:7], s48 offen offset:128 sc1
    s_mov_b64 exec, -1
.Lstd_132:
    s_mul_i32 s26, s16, 16384
    s_add_u32 s26, s26, s20
    s_add_u32 s26, s26, 9383936
    s_lshl_b32 s29, s16, 10
    s_add_u32 s29, s29, s44
    s_add_u32 s29, s29, 7024640
    s_add_u32 s51, s50, 3
.Llw_133:
    ds_read_b128 v[44:47], v15 offset:16
    s_waitcnt lgkmcnt(0)
    v_min_u32 v44, v44, v45
    v_min3_u32 v44, v44, v46, v47
    v_cmp_le_u32 vcc, s51, v44
    s_cbranch_vccnz .Llwd_134
    s_sub_u32 s23, s23, 1
    s_cbranch_scc1 .Lexit_1
    s_branch .Llw_133
.Llwd_134:
    ds_read_b128 v[128:131], v5 offset:12288
    ds_read_b128 v[132:135], v5 offset:13312
    ds_read_b128 v[136:139], v5 offset:14336
    ds_read_b128 v[140:143], v5 offset:15360
    ds_read_b128 v[144:147], v5 offset:16384
    ds_read_b128 v[148:151], v5 offset:17408
    ds_read_b128 v[152:155], v5 offset:18432
    ds_read_b128 v[156:159], v5 offset:19456
    ds_read_b128 v[160:163], v5 offset:20480
    ds_read_b128 v[164:167], v5 offset:21504
    ds_read_b128 v[168:171], v5 offset:22528
    ds_read_b128 v[172:175], v5 offset:23552
    ds_read_b128 v[176:179], v5 offset:24576
    ds_read_b128 v[180:183], v5 offset:25600
    ds_read_b128 v[184:187], v5 offset:26624
    s_waitcnt lgkmcnt(8)
    ds_read_b128 v[188:191], v5 offset:27648
    s_mov_b64 exec, 0xffff
    buffer_load_dword v0, v7, s[4:7], s29 offen offset:128 sc1
    s_mov_b64 exec, -1
    ds_read_b128 v[192:195], v1 offset:0
    ds_read_b128 v[196:199], v1 offset:1024
    ds_read_b128 v[200:203], v1 offset:2048
    ds_read_b128 v[204:207], v1 offset:3072
    ds_read_b128 v[208:211], v1 offset:4096
    ds_read_b128 v[212:215], v1 offset:5120
    s_waitcnt lgkmcnt(8)
    ds_read_b128 v[216:219], v1 offset:6144
    ds_read_b128 v[220:223], v1 offset:7168
    ds_read_b128 v[224:227], v1 offset:8192
    ds_read_b128 v[228:231], v1 offset:9216
    ds_read_b128 v[232:235], v1 offset:10240
    ds_read_b128 v[236:239], v1 offset:11264
    ds_read_b128 v[240:243], v1 offset:12288
    s_waitcnt lgkmcnt(8)
    ds_read_b128 v[244:247], v1 offset:13312
    ds_read_b128 v[248:251], v1 offset:14336
    ds_read_b128 v[252:255], v1 offset:15360
    s_mov_b64 exec, 0xffff
    s_waitcnt vmcnt(0)
    v_cmp_le_u32 vcc, 1, v0
    s_nop 0
    s_cmp_eq_u64 vcc, exec
    s_cbranch_scc1 .Lpolld_138
.Lpoll_135:
    s_cmp_eq_u32 s45, 0
    s_cbranch_scc1 .Lpolls_136
    buffer_load_dword v3, v7, s[4:7], s29 offen offset:128 sc1
    s_branch .Lpollc_137
.Lpolls_136:
    v_mov_b32 v3, 0
    buffer_atomic_add v3, v7, s[4:7], s29 offen offset:128 sc0
.Lpollc_137:
    s_waitcnt vmcnt(0)
    v_cmp_le_u32 vcc, 1, v3
    s_nop 0
    s_cmp_eq_u64 vcc, exec
    s_cbranch_scc1 .Lpolld_138
    s_sub_u32 s23, s23, 1
    s_cbranch_scc1 .Lexit_1
    s_branch .Lpoll_135
.Lpolld_138:
    s_mov_b64 exec, -1
    buffer_load_dwordx4 v[64:67], v1, s[4:7], s26 offen sc1
    buffer_load_dwordx4 v[68:71], v1, s[4:7], s26 offen offset:1024 sc1
    buffer_load_dwordx4 v[72:75], v1, s[4:7], s26 offen offset:2048 sc1
    buffer_load_dwordx4 v[76:79], v1, s[4:7], s26 offen offset:3072 sc1
    s_add_u32 s26, s26, 4096
    buffer_load_dwordx4 v[80:83], v1, s[4:7], s26 offen sc1
    buffer_load_dwordx4 v[84:87], v1, s[4:7], s26 offen offset:1024 sc1
    buffer_load_dwordx4 v[88:91], v1, s[4:7], s26 offen offset:2048 sc1
    buffer_load_dwordx4 v[92:95], v1, s[4:7], s26 offen offset:3072 sc1
    s_add_u32 s26, s26, 4096
    buffer_load_dwordx4 v[96:99], v1, s[4:7], s26 offen sc1
    buffer_load_dwordx4 v[100:103], v1, s[4:7], s26 offen offset:1024 sc1
    buffer_load_dwordx4 v[104:107], v1, s[4:7], s26 offen offset:2048 sc1
    buffer_load_dwordx4 v[108:111], v1, s[4:7], s26 offen offset:3072 sc1
    s_add_u32 s26, s26, 4096
    buffer_load_dwordx4 v[112:115], v1, s[4:7], s26 offen sc1
    buffer_load_dwordx4 v[116:119], v1, s[4:7], s26 offen offset:1024 sc1
    buffer_load_dwordx4 v[120:123], v1, s[4:7], s26 offen offset:2048 sc1
    buffer_load_dwordx4 v[124:127], v1, s[4:7], s26 offen offset:3072 sc1
    s_waitcnt lgkmcnt(0)
    s_waitcnt vmcnt(15)
    v_mfma_f32_16x16x32_bf16 v[16:19], v[128:131], v[64:67], v[16:19]
    v_mfma_f32_16x16x32_bf16 v[20:23], v[132:135], v[64:67], v[20:23]
    v_mfma_f32_16x16x32_bf16 v[24:27], v[136:139], v[64:67], v[24:27]
    v_mfma_f32_16x16x32_bf16 v[28:31], v[140:143], v[64:67], v[28:31]
    s_waitcnt vmcnt(14)
    v_mfma_f32_16x16x32_bf16 v[16:19], v[144:147], v[68:71], v[16:19]
    ds_read_b128 v[128:131], v1 offset:16384
    ds_read_b128 v[132:135], v1 offset:17408
    v_mfma_f32_16x16x32_bf16 v[20:23], v[148:151], v[68:71], v[20:23]
    v_mfma_f32_16x16x32_bf16 v[24:27], v[152:155], v[68:71], v[24:27]
    ds_read_b128 v[136:139], v1 offset:18432
    ds_read_b128 v[140:143], v1 offset:19456
    v_mfma_f32_16x16x32_bf16 v[28:31], v[156:159], v[68:71], v[28:31]
    s_waitcnt vmcnt(13)
    v_mfma_f32_16x16x32_bf16 v[16:19], v[160:163], v[72:75], v[16:19]
    ds_read_b128 v[144:147], v1 offset:20480
    ds_read_b128 v[148:151], v1 offset:21504
    v_mfma_f32_16x16x32_bf16 v[20:23], v[164:167], v[72:75], v[20:23]
    v_mfma_f32_16x16x32_bf16 v[24:27], v[168:171], v[72:75], v[24:27]
    ds_read_b128 v[152:155], v1 offset:22528
    ds_read_b128 v[156:159], v1 offset:23552
    v_mfma_f32_16x16x32_bf16 v[28:31], v[172:175], v[72:75], v[28:31]
    s_waitcnt vmcnt(12)
    v_mfma_f32_16x16x32_bf16 v[16:19], v[176:179], v[76:79], v[16:19]
    ds_read_b128 v[160:163], v1 offset:24576
    ds_read_b128 v[164:167], v1 offset:25600
    v_mfma_f32_16x16x32_bf16 v[20:23], v[180:183], v[76:79], v[20:23]
    v_mfma_f32_16x16x32_bf16 v[24:27], v[184:187], v[76:79], v[24:27]
    ds_read_b128 v[168:171], v1 offset:26624
    ds_read_b128 v[172:175], v1 offset:27648
    v_mfma_f32_16x16x32_bf16 v[28:31], v[188:191], v[76:79], v[28:31]
    s_waitcnt vmcnt(11)
    v_mfma_f32_16x16x32_bf16 v[16:19], v[192:195], v[80:83], v[16:19]
    ds_read_b128 v[176:179], v1 offset:28672
    ds_read_b128 v[180:183], v1 offset:29696
    v_mfma_f32_16x16x32_bf16 v[20:23], v[196:199], v[80:83], v[20:23]
    v_mfma_f32_16x16x32_bf16 v[24:27], v[200:203], v[80:83], v[24:27]
    ds_read_b128 v[184:187], v1 offset:30720
    s_waitcnt lgkmcnt(8)
    ds_read_b128 v[188:191], v1 offset:31744
    v_mfma_f32_16x16x32_bf16 v[28:31], v[204:207], v[80:83], v[28:31]
    s_waitcnt vmcnt(10)
    v_mfma_f32_16x16x32_bf16 v[16:19], v[208:211], v[84:87], v[16:19]
    ds_read_b128 v[192:195], v1 offset:32768
    ds_read_b128 v[196:199], v1 offset:33792
    v_mfma_f32_16x16x32_bf16 v[20:23], v[212:215], v[84:87], v[20:23]
    v_mfma_f32_16x16x32_bf16 v[24:27], v[216:219], v[84:87], v[24:27]
    ds_read_b128 v[200:203], v1 offset:34816
    ds_read_b128 v[204:207], v1 offset:35840
    v_mfma_f32_16x16x32_bf16 v[28:31], v[220:223], v[84:87], v[28:31]
    s_waitcnt vmcnt(9)
    v_mfma_f32_16x16x32_bf16 v[16:19], v[224:227], v[88:91], v[16:19]
    ds_read_b128 v[208:211], v1 offset:36864
    ds_read_b128 v[212:215], v1 offset:37888
    v_mfma_f32_16x16x32_bf16 v[20:23], v[228:231], v[88:91], v[20:23]
    v_mfma_f32_16x16x32_bf16 v[24:27], v[232:235], v[88:91], v[24:27]
    s_waitcnt lgkmcnt(8)
    ds_read_b128 v[216:219], v1 offset:38912
    ds_read_b128 v[220:223], v1 offset:39936
    v_mfma_f32_16x16x32_bf16 v[28:31], v[236:239], v[88:91], v[28:31]
    s_waitcnt vmcnt(8)
    v_mfma_f32_16x16x32_bf16 v[16:19], v[240:243], v[92:95], v[16:19]
    ds_read_b128 v[224:227], v1 offset:40960
    ds_read_b128 v[228:231], v1 offset:41984
    v_mfma_f32_16x16x32_bf16 v[20:23], v[244:247], v[92:95], v[20:23]
    v_mfma_f32_16x16x32_bf16 v[24:27], v[248:251], v[92:95], v[24:27]
    ds_read_b128 v[232:235], v1 offset:43008
    ds_read_b128 v[236:239], v1 offset:44032
    v_mfma_f32_16x16x32_bf16 v[28:31], v[252:255], v[92:95], v[28:31]
    s_waitcnt vmcnt(7)
    v_mfma_f32_16x16x32_bf16 v[16:19], v[128:131], v[96:99], v[16:19]
    ds_read_b128 v[240:243], v1 offset:45056
    s_waitcnt lgkmcnt(8)
    ds_read_b128 v[244:247], v1 offset:46080
    v_mfma_f32_16x16x32_bf16 v[20:23], v[132:135], v[96:99], v[20:23]
    v_mfma_f32_16x16x32_bf16 v[24:27], v[136:139], v[96:99], v[24:27]
    ds_read_b128 v[248:251], v1 offset:47104
    ds_read_b128 v[252:255], v1 offset:48128
    v_mfma_f32_16x16x32_bf16 v[28:31], v[140:143], v[96:99], v[28:31]
    s_waitcnt vmcnt(6)
    v_mfma_f32_16x16x32_bf16 v[16:19], v[144:147], v[100:103], v[16:19]
    v_mfma_f32_16x16x32_bf16 v[20:23], v[148:151], v[100:103], v[20:23]
    v_mfma_f32_16x16x32_bf16 v[24:27], v[152:155], v[100:103], v[24:27]
    v_mfma_f32_16x16x32_bf16 v[28:31], v[156:159], v[100:103], v[28:31]
    s_waitcnt vmcnt(5)
    v_mfma_f32_16x16x32_bf16 v[16:19], v[160:163], v[104:107], v[16:19]
    v_mfma_f32_16x16x32_bf16 v[20:23], v[164:167], v[104:107], v[20:23]
    v_mfma_f32_16x16x32_bf16 v[24:27], v[168:171], v[104:107], v[24:27]
    v_mfma_f32_16x16x32_bf16 v[28:31], v[172:175], v[104:107], v[28:31]
    s_waitcnt vmcnt(4)
    v_mfma_f32_16x16x32_bf16 v[16:19], v[176:179], v[108:111], v[16:19]
    v_mfma_f32_16x16x32_bf16 v[20:23], v[180:183], v[108:111], v[20:23]
    v_mfma_f32_16x16x32_bf16 v[24:27], v[184:187], v[108:111], v[24:27]
    v_mfma_f32_16x16x32_bf16 v[28:31], v[188:191], v[108:111], v[28:31]
    s_waitcnt vmcnt(3)
    v_mfma_f32_16x16x32_bf16 v[16:19], v[192:195], v[112:115], v[16:19]
    v_mfma_f32_16x16x32_bf16 v[20:23], v[196:199], v[112:115], v[20:23]
    v_mfma_f32_16x16x32_bf16 v[24:27], v[200:203], v[112:115], v[24:27]
    v_mfma_f32_16x16x32_bf16 v[28:31], v[204:207], v[112:115], v[28:31]
    s_waitcnt vmcnt(2) lgkmcnt(8)
    v_mfma_f32_16x16x32_bf16 v[16:19], v[208:211], v[116:119], v[16:19]
    v_mfma_f32_16x16x32_bf16 v[20:23], v[212:215], v[116:119], v[20:23]
    v_mfma_f32_16x16x32_bf16 v[24:27], v[216:219], v[116:119], v[24:27]
    v_mfma_f32_16x16x32_bf16 v[28:31], v[220:223], v[116:119], v[28:31]
    s_waitcnt vmcnt(1) lgkmcnt(4)
    v_mfma_f32_16x16x32_bf16 v[16:19], v[224:227], v[120:123], v[16:19]
    v_mfma_f32_16x16x32_bf16 v[20:23], v[228:231], v[120:123], v[20:23]
    v_mfma_f32_16x16x32_bf16 v[24:27], v[232:235], v[120:123], v[24:27]
    v_mfma_f32_16x16x32_bf16 v[28:31], v[236:239], v[120:123], v[28:31]
    s_waitcnt vmcnt(0) lgkmcnt(0)
    v_mfma_f32_16x16x32_bf16 v[16:19], v[240:243], v[124:127], v[16:19]
    v_mfma_f32_16x16x32_bf16 v[20:23], v[244:247], v[124:127], v[20:23]
    v_mfma_f32_16x16x32_bf16 v[24:27], v[248:251], v[124:127], v[24:27]
    v_mfma_f32_16x16x32_bf16 v[28:31], v[252:255], v[124:127], v[28:31]
    s_nop 4
    v_cvt_pk_bf16_f32 v64, v16, v17
    v_cvt_pk_bf16_f32 v65, v18, v19
    v_cvt_pk_bf16_f32 v66, v20, v21
    v_cvt_pk_bf16_f32 v67, v22, v23
    v_cvt_pk_bf16_f32 v68, v24, v25
    v_cvt_pk_bf16_f32 v69, v26, v27
    v_cvt_pk_bf16_f32 v70, v28, v29
    v_cvt_pk_bf16_f32 v71, v30, v31
    s_add_u32 s26, s24, 7155712
    s_add_u32 s27, s25, 9252864
    s_cmp_eq_u32 s49, 0
    s_cbranch_scc1 .Lsts_139
    buffer_store_dwordx4 v[64:67], v1, s[4:7], s26 offen
    buffer_store_dwordx4 v[68:71], v1, s[4:7], s26 offen offset:1024
    s_branch .Lstd_140
.Lsts_139:
    buffer_store_dwordx4 v[64:67], v1, s[4:7], s26 offen sc1
    buffer_store_dwordx4 v[68:71], v1, s[4:7], s26 offen offset:1024 sc1
.Lstd_140:
    v_pk_add_f32 v[72:73], v[16:17], v[18:19]
    v_pk_mul_f32 v[74:75], v[16:17], v[16:17]
    v_pk_fma_f32 v[74:75], v[18:19], v[18:19], v[74:75]
    v_pk_add_f32 v[72:73], v[72:73], v[20:21]
    v_pk_fma_f32 v[74:75], v[20:21], v[20:21], v[74:75]
    v_pk_add_f32 v[72:73], v[72:73], v[22:23]
    v_pk_fma_f32 v[74:75], v[22:23], v[22:23], v[74:75]
    v_pk_add_f32 v[72:73], v[72:73], v[24:25]
    v_pk_fma_f32 v[74:75], v[24:25], v[24:25], v[74:75]
    v_pk_add_f32 v[72:73], v[72:73], v[26:27]
    v_pk_fma_f32 v[74:75], v[26:27], v[26:27], v[74:75]
    v_pk_add_f32 v[72:73], v[72:73], v[28:29]
    v_pk_fma_f32 v[74:75], v[28:29], v[28:29], v[74:75]
    v_pk_add_f32 v[72:73], v[72:73], v[30:31]
    v_pk_fma_f32 v[74:75], v[30:31], v[30:31], v[74:75]
    v_add_f32 v72, v72, v73
    v_add_f32 v73, v74, v75
    s_nop 1
    v_permlane32_swap_b32 v72, v73
    v_add_f32 v72, v72, v73
    v_mov_b32 v73, v72
    s_nop 1
    v_permlane16_swap_b32 v72, v73
    v_add_f32 v72, v72, v73
    v_mov_b32 v73, v72
    s_nop 1
    v_permlane32_swap_b32 v72, v73
    s_cmp_eq_u32 s49, 0
    s_cbranch_scc1 .Lsts_141
    s_mov_b64 exec, 0xffff
    buffer_store_dwordx2 v[72:73], v6, s[4:7], s27 offen
    s_mov_b64 exec, -1
    s_branch .Lstd_142
.Lsts_141:
    s_mov_b64 exec, 0xffff
    buffer_store_dwordx2 v[72:73], v6, s[4:7], s27 offen sc1
    s_mov_b64 exec, -1
.Lstd_142:
    s_add_u32 s51, s50, 4
.Llw_143:
    ds_read_b128 v[44:47], v15 offset:16
    s_waitcnt lgkmcnt(0)
    v_min_u32 v44, v44, v45
    v_min3_u32 v44, v44, v46, v47
    v_cmp_le_u32 vcc, s51, v44
    s_cbranch_vccnz .Llwd_144
    s_sub_u32 s23, s23, 1
    s_cbranch_scc1 .Lexit_1
    s_branch .Llw_143
.Llwd_144:
    ds_read_b128 v[128:131], v1 offset:49152
    ds_read_b128 v[132:135], v1 offset:50176
    ds_read_b128 v[136:139], v1 offset:51200
    ds_read_b128 v[140:143], v1 offset:52224
    ds_read_b128 v[144:147], v1 offset:53248
    ds_read_b128 v[148:151], v1 offset:54272
    ds_read_b128 v[152:155], v1 offset:55296
    ds_read_b128 v[156:159], v1 offset:56320
    ds_read_b128 v[160:163], v1 offset:57344
    ds_read_b128 v[164:167], v1 offset:58368
    ds_read_b128 v[168:171], v1 offset:59392
    ds_read_b128 v[172:175], v1 offset:60416
    s_waitcnt vmcnt(0)
    s_cmp_eq_u32 s45, 0
    s_cbranch_scc1 .Lsts_145
    s_mov_b64 exec, 1
    buffer_store_dword v8, v9, s[4:7], s47 offen offset:256
    s_mov_b64 exec, -1
    s_branch .Lstd_146
.Lsts_145:
    s_mov_b64 exec, 1
    buffer_store_dword v8, v9, s[4:7], s47 offen offset:256 sc1
    s_mov_b64 exec, -1
.Lstd_146:
    s_mul_i32 s26, s16, 16384
    s_add_u32 s26, s26, s20
    s_add_u32 s26, s26, 7155712
    s_lshl_b32 s29, s16, 10
    s_add_u32 s29, s29, s44
    s_add_u32 s29, s29, 7024640
    s_lshl_b32 s27, s16, 10
    s_add_u32 s27, s27, 9252864
    s_mov_b32 s51, 4
.Llw_147:
    ds_read_b128 v[44:47], v15 offset:80
    s_waitcnt lgkmcnt(0)
    v_min_u32 v44, v44, v45
    v_min3_u32 v44, v44, v46, v47
    v_cmp_le_u32 vcc, s51, v44
    s_cbranch_vccnz .Llwd_148
    s_sub_u32 s23, s23, 1
    s_cbranch_scc1 .Lexit_1
    s_branch .Llw_147
.Llwd_148:
    v_and_b32 v3, 0x30, v2
    v_add_u32 v3, 160128, v3
    ds_read_b128 v[240:243], v3 offset:0
    ds_read_b128 v[244:247], v3 offset:64
    ds_read_b128 v[248:251], v3 offset:128
    ds_read_b128 v[252:255], v3 offset:192
    ds_read_b128 v[176:179], v1 offset:61440
    ds_read_b128 v[180:183], v1 offset:62464
    ds_read_b128 v[184:187], v1 offset:63488
    ds_read_b128 v[188:191], v1 offset:64512
    s_mov_b64 exec, 0xff
    buffer_load_dword v0, v7, s[4:7], s29 offen offset:256 sc1
    s_mov_b64 exec, -1
    ds_read_b128 v[192:195], v4 offset:0
    ds_read_b128 v[196:199], v4 offset:1024
    ds_read_b128 v[200:203], v4 offset:2048
    ds_read_b128 v[204:207], v4 offset:3072
    ds_read_b128 v[208:211], v4 offset:4096
    ds_read_b128 v[212:215], v4 offset:5120
    ds_read_b128 v[216:219], v4 offset:6144
    s_waitcnt lgkmcnt(8)
    ds_read_b128 v[220:223], v4 offset:7168
    ds_read_b128 v[224:227], v4 offset:8192
    ds_read_b128 v[228:231], v4 offset:9216
    ds_read_b128 v[232:235], v4 offset:10240
    ds_read_b128 v[236:239], v4 offset:11264
    s_mov_b64 exec, 0xff
    s_waitcnt vmcnt(0)
    v_cmp_le_u32 vcc, 1, v0
    s_nop 0
    s_cmp_eq_u64 vcc, exec
    s_cbranch_scc1 .Lpolld_152
.Lpoll_149:
    s_cmp_eq_u32 s45, 0
    s_cbranch_scc1 .Lpolls_150
    buffer_load_dword v3, v7, s[4:7], s29 offen offset:256 sc1
    s_branch .Lpollc_151
.Lpolls_150:
    v_mov_b32 v3, 0
    buffer_atomic_add v3, v7, s[4:7], s29 offen offset:256 sc0
.Lpollc_151:
    s_waitcnt vmcnt(0)
    v_cmp_le_u32 vcc, 1, v3
    s_nop 0
    s_cmp_eq_u64 vcc, exec
    s_cbranch_scc1 .Lpolld_152
    s_sub_u32 s23, s23, 1
    s_cbranch_scc1 .Lexit_1
    s_branch .Lpoll_149
.Lpolld_152:
    s_mov_b64 exec, -1
    buffer_load_dwordx4 v[64:67], v1, s[4:7], s26 offen sc1
    buffer_load_dwordx4 v[68:71], v1, s[4:7], s26 offen offset:1024 sc1
    buffer_load_dwordx2 v[32:33], v6, s[4:7], s27 offen sc1
    buffer_load_dwordx2 v[34:35], v6, s[4:7], s27 offen offset:128 sc1
    buffer_load_dwordx4 v[72:75], v1, s[4:7], s26 offen offset:2048 sc1
    buffer_load_dwordx4 v[76:79], v1, s[4:7], s26 offen offset:3072 sc1
    s_add_u32 s26, s26, 4096
    buffer_load_dwordx4 v[80:83], v1, s[4:7], s26 offen sc1
    buffer_load_dwordx4 v[84:87], v1, s[4:7], s26 offen offset:1024 sc1
    buffer_load_dwordx4 v[88:91], v1, s[4:7], s26 offen offset:2048 sc1
    buffer_load_dwordx4 v[92:95], v1, s[4:7], s26 offen offset:3072 sc1
    s_add_u32 s26, s26, 4096
    buffer_load_dwordx4 v[96:99], v1, s[4:7], s26 offen sc1
    buffer_load_dwordx4 v[100:103], v1, s[4:7], s26 offen offset:1024 sc1
    buffer_load_dwordx4 v[104:107], v1, s[4:7], s26 offen offset:2048 sc1
    buffer_load_dwordx4 v[108:111], v1, s[4:7], s26 offen offset:3072 sc1
    s_add_u32 s26, s26, 4096
    buffer_load_dwordx4 v[112:115], v1, s[4:7], s26 offen sc1
    buffer_load_dwordx4 v[116:119], v1, s[4:7], s26 offen offset:1024 sc1
    buffer_load_dwordx4 v[120:123], v1, s[4:7], s26 offen offset:2048 sc1
    buffer_load_dwordx4 v[124:127], v1, s[4:7], s26 offen offset:3072 sc1
    s_add_u32 s51, s50, 5
    v_mov_b32 v3, s51
    ds_write_b32 v14, v3 offset:0
    s_waitcnt lgkmcnt(0)
    s_waitcnt vmcnt(17)
    v_mfma_f32_16x16x32_bf16 v[48:51], v[128:131], v[64:67], 0
    v_mfma_f32_16x16x32_bf16 v[52:55], v[132:135], v[64:67], 0
    v_mfma_f32_16x16x32_bf16 v[56:59], v[136:139], v[64:67], 0
    v_mfma_f32_16x16x32_bf16 v[60:63], v[140:143], v[64:67], 0
    s_waitcnt vmcnt(16)
    v_mfma_f32_16x16x32_bf16 v[48:51], v[144:147], v[68:71], v[48:51]
    ds_read_b128 v[128:131], v4 offset:12288
    ds_read_b128 v[132:135], v4 offset:13312
    v_mfma_f32_16x16x32_bf16 v[52:55], v[148:151], v[68:71], v[52:55]
    v_mfma_f32_16x16x32_bf16 v[56:59], v[152:155], v[68:71], v[56:59]
    ds_read_b128 v[136:139], v4 offset:14336
    ds_read_b128 v[140:143], v4 offset:15360
    v_mfma_f32_16x16x32_bf16 v[60:63], v[156:159], v[68:71], v[60:63]
    s_waitcnt vmcnt(13)
    v_mfma_f32_16x16x32_bf16 v[48:51], v[160:163], v[72:75], v[48:51]
    ds_read_b128 v[144:147], v4 offset:16384
    ds_read_b128 v[148:151], v4 offset:17408
    v_mfma_f32_16x16x32_bf16 v[52:55], v[164:167], v[72:75], v[52:55]
    v_pk_add_f32 v[32:33], v[32:33], v[34:35]
    v_mfma_f32_16x16x32_bf16 v[56:59], v[168:171], v[72:75], v[56:59]
    ds_read_b128 v[152:155], v4 offset:18432
    ds_read_b128 v[156:159], v4 offset:19456
    v_mfma_f32_16x16x32_bf16 v[60:63], v[172:175], v[72:75], v[60:63]
    v_permlane32_swap_b32 v32, v33
    s_waitcnt vmcnt(12)
    v_mfma_f32_16x16x32_bf16 v[48:51], v[176:179], v[76:79], v[48:51]
    ds_read_b128 v[160:163], v4 offset:20480
    ds_read_b128 v[164:167], v4 offset:21504
    v_mfma_f32_16x16x32_bf16 v[52:55], v[180:183], v[76:79], v[52:55]
    v_add_f32 v32, v32, v33
    v_mfma_f32_16x16x32_bf16 v[56:59], v[184:187], v[76:79], v[56:59]
    ds_read_b128 v[168:171], v4 offset:22528
    ds_read_b128 v[172:175], v4 offset:23552
    v_mfma_f32_16x16x32_bf16 v[60:63], v[188:191], v[76:79], v[60:63]
    v_mov_b32 v33, v32
    s_waitcnt vmcnt(11)
    v_mfma_f32_16x16x32_bf16 v[48:51], v[192:195], v[80:83], v[48:51]
    ds_read_b128 v[176:179], v4 offset:24576
    ds_read_b128 v[180:183], v4 offset:25600
    v_mfma_f32_16x16x32_bf16 v[52:55], v[196:199], v[80:83], v[52:55]
    v_permlane16_swap_b32 v32, v33
    v_mfma_f32_16x16x32_bf16 v[56:59], v[200:203], v[80:83], v[56:59]
    ds_read_b128 v[184:187], v4 offset:26624
    s_waitcnt lgkmcnt(8)
    ds_read_b128 v[188:191], v4 offset:27648
    v_mfma_f32_16x16x32_bf16 v[60:63], v[204:207], v[80:83], v[60:63]
    v_add_f32 v32, v32, v33
    s_waitcnt vmcnt(10)
    v_mfma_f32_16x16x32_bf16 v[48:51], v[208:211], v[84:87], v[48:51]
    ds_read_b128 v[192:195], v4 offset:28672
    ds_read_b128 v[196:199], v4 offset:29696
    v_mfma_f32_16x16x32_bf16 v[52:55], v[212:215], v[84:87], v[52:55]
    v_mov_b32 v33, v32
    v_mfma_f32_16x16x32_bf16 v[56:59], v[216:219], v[84:87], v[56:59]
    ds_read_b128 v[200:203], v4 offset:30720
    ds_read_b128 v[204:207], v4 offset:31744
    v_mfma_f32_16x16x32_bf16 v[60:63], v[220:223], v[84:87], v[60:63]
    v_permlane32_swap_b32 v32, v33
    s_waitcnt vmcnt(9)
    v_mfma_f32_16x16x32_bf16 v[48:51], v[224:227], v[88:91], v[48:51]
    ds_read_b128 v[208:211], v4 offset:32768
    ds_read_b128 v[212:215], v4 offset:33792
    v_mfma_f32_16x16x32_bf16 v[52:55], v[228:231], v[88:91], v[52:55]
    v_mul_f32 v32, 0x3b000000, v32
    v_mfma_f32_16x16x32_bf16 v[56:59], v[232:235], v[88:91], v[56:59]
    s_waitcnt lgkmcnt(8)
    ds_read_b128 v[216:219], v4 offset:34816
    ds_read_b128 v[220:223], v4 offset:35840
    v_mfma_f32_16x16x32_bf16 v[60:63], v[236:239], v[88:91], v[60:63]
    v_mul_f32 v33, 0x3b000000, v33
    s_waitcnt vmcnt(8)
    v_mfma_f32_16x16x32_bf16 v[48:51], v[128:131], v[92:95], v[48:51]
    ds_read_b128 v[224:227], v4 offset:36864
    ds_read_b128 v[228:231], v4 offset:37888
    v_mfma_f32_16x16x32_bf16 v[52:55], v[132:135], v[92:95], v[52:55]
    v_fma_f32 v33, -v32, v32, v33
    v_mfma_f32_16x16x32_bf16 v[56:59], v[136:139], v[92:95], v[56:59]
    ds_read_b128 v[232:235], v4 offset:38912
    ds_read_b128 v[236:239], v4 offset:39936
    v_mfma_f32_16x16x32_bf16 v[60:63], v[140:143], v[92:95], v[60:63]
    v_max_f32 v33, 0, v33
    s_waitcnt vmcnt(7)
    v_mfma_f32_16x16x32_bf16 v[48:51], v[144:147], v[96:99], v[48:51]
    ds_read_b128 v[128:131], v4 offset:40960
    s_waitcnt lgkmcnt(8)
    ds_read_b128 v[132:135], v4 offset:41984
    v_mfma_f32_16x16x32_bf16 v[52:55], v[148:151], v[96:99], v[52:55]
    v_add_f32 v11, 0x3727c5ac, v33
    v_mfma_f32_16x16x32_bf16 v[56:59], v[152:155], v[96:99], v[56:59]
    ds_read_b128 v[136:139], v4 offset:43008
    ds_read_b128 v[140:143], v4 offset:44032
    v_mfma_f32_16x16x32_bf16 v[60:63], v[156:159], v[96:99], v[60:63]
    v_rsq_f32 v11, v11
    s_waitcnt vmcnt(6)
    v_mfma_f32_16x16x32_bf16 v[48:51], v[160:163], v[100:103], v[48:51]
    ds_read_b128 v[144:147], v4 offset:45056
    ds_read_b128 v[148:151], v4 offset:46080
    v_mfma_f32_16x16x32_bf16 v[52:55], v[164:167], v[100:103], v[52:55]
    v_mul_f32 v10, v32, v11
    v_mfma_f32_16x16x32_bf16 v[56:59], v[168:171], v[100:103], v[56:59]
    ds_read_b128 v[152:155], v4 offset:47104
    ds_read_b128 v[156:159], v4 offset:48128
    v_mfma_f32_16x16x32_bf16 v[60:63], v[172:175], v[100:103], v[60:63]
    v_mul_f32 v38, v11, v11
    s_waitcnt vmcnt(5)
    v_mfma_f32_16x16x32_bf16 v[48:51], v[176:179], v[104:107], v[48:51]
    v_mul_f32 v38, v38, v33
    v_mfma_f32_16x16x32_bf16 v[52:55], v[180:183], v[104:107], v[52:55]
    v_add_f32 v38, 0x3727c5ac, v38
    v_mfma_f32_16x16x32_bf16 v[56:59], v[184:187], v[104:107], v[56:59]
    v_rsq_f32 v38, v38
    v_mfma_f32_16x16x32_bf16 v[60:63], v[188:191], v[104:107], v[60:63]
    v_mul_f32 v38, v38, v11
    s_waitcnt vmcnt(4)
    v_mfma_f32_16x16x32_bf16 v[48:51], v[192:195], v[108:111], v[48:51]
    v_mul_f32 v42, v38, v38
    v_mfma_f32_16x16x32_bf16 v[52:55], v[196:199], v[108:111], v[52:55]
    v_mul_f32 v40, 0xc0135761, v38
    v_mfma_f32_16x16x32_bf16 v[56:59], v[200:203], v[108:111], v[56:59]
    v_mul_f32 v42, v42, v38
    v_mfma_f32_16x16x32_bf16 v[60:63], v[204:207], v[108:111], v[60:63]
    v_rcp_f32 v34, v38
    s_waitcnt vmcnt(3) lgkmcnt(12)
    v_mfma_f32_16x16x32_bf16 v[48:51], v[208:211], v[112:115], v[48:51]
    v_mul_f32 v42, 0xbdd2d3e8, v42
    v_mfma_f32_16x16x32_bf16 v[52:55], v[212:215], v[112:115], v[52:55]
    v_mov_b32 v41, v40
    v_mfma_f32_16x16x32_bf16 v[56:59], v[216:219], v[112:115], v[56:59]
    v_mov_b32 v43, v42
    v_mfma_f32_16x16x32_bf16 v[60:63], v[220:223], v[112:115], v[60:63]
    v_mov_b32 v35, v34
    s_waitcnt vmcnt(2) lgkmcnt(8)
    v_mfma_f32_16x16x32_bf16 v[48:51], v[224:227], v[116:119], v[48:51]
    v_mov_b32 v33, v32
    v_mfma_f32_16x16x32_bf16 v[52:55], v[228:231], v[116:119], v[52:55]
    v_mfma_f32_16x16x32_bf16 v[56:59], v[232:235], v[116:119], v[56:59]
    v_mfma_f32_16x16x32_bf16 v[60:63], v[236:239], v[116:119], v[60:63]
    s_waitcnt vmcnt(1) lgkmcnt(4)
    v_mfma_f32_16x16x32_bf16 v[48:51], v[128:131], v[120:123], v[48:51]
    v_mfma_f32_16x16x32_bf16 v[52:55], v[132:135], v[120:123], v[52:55]
    v_mfma_f32_16x16x32_bf16 v[56:59], v[136:139], v[120:123], v[56:59]
    v_mfma_f32_16x16x32_bf16 v[60:63], v[140:143], v[120:123], v[60:63]
    s_waitcnt vmcnt(0) lgkmcnt(0)
    v_mfma_f32_16x16x32_bf16 v[48:51], v[144:147], v[124:127], v[48:51]
    v_mfma_f32_16x16x32_bf16 v[52:55], v[148:151], v[124:127], v[52:55]
    v_mfma_f32_16x16x32_bf16 v[56:59], v[152:155], v[124:127], v[56:59]
    v_mfma_f32_16x16x32_bf16 v[60:63], v[156:159], v[124:127], v[60:63]
    s_add_u32 s51, s50, 1
    v_mov_b32 v3, s51
    ds_write_b32 v14, v3 offset:64
    s_nop 1
    v_pk_fma_f32 v[48:49], v[240:241], v[32:33], v[48:49] neg_lo:[0,1,0] neg_hi:[0,1,0]
    v_pk_fma_f32 v[50:51], v[242:243], v[32:33], v[50:51] neg_lo:[0,1,0] neg_hi:[0,1,0]
    v_pk_fma_f32 v[52:53], v[244:245], v[32:33], v[52:53] neg_lo:[0,1,0] neg_hi:[0,1,0]
    v_pk_fma_f32 v[54:55], v[246:247], v[32:33], v[54:55] neg_lo:[0,1,0] neg_hi:[0,1,0]
    v_pk_fma_f32 v[56:57], v[248:249], v[32:33], v[56:57] neg_lo:[0,1,0] neg_hi:[0,1,0]
    v_pk_fma_f32 v[58:59], v[250:251], v[32:33], v[58:59] neg_lo:[0,1,0] neg_hi:[0,1,0]
    v_pk_fma_f32 v[60:61], v[252:253], v[32:33], v[60:61] neg_lo:[0,1,0] neg_hi:[0,1,0]
    v_pk_fma_f32 v[62:63], v[254:255], v[32:33], v[62:63] neg_lo:[0,1,0] neg_hi:[0,1,0]
    v_pk_mul_f32 v[64:65], v[48:49], v[48:49]
    v_pk_mul_f32 v[66:67], v[50:51], v[50:51]
    v_pk_mul_f32 v[68:69], v[52:53], v[52:53]
    v_pk_mul_f32 v[70:71], v[54:55], v[54:55]
    v_pk_mul_f32 v[72:73], v[56:57], v[56:57]
    v_pk_mul_f32 v[74:75], v[58:59], v[58:59]
    v_pk_mul_f32 v[76:77], v[60:61], v[60:61]
    v_pk_mul_f32 v[78:79], v[62:63], v[62:63]
    v_pk_fma_f32 v[64:65], v[64:65], v[42:43], v[40:41]
    v_pk_fma_f32 v[66:67], v[66:67], v[42:43], v[40:41]
    v_pk_fma_f32 v[68:69], v[68:69], v[42:43], v[40:41]
    v_pk_fma_f32 v[70:71], v[70:71], v[42:43], v[40:41]
    v_pk_fma_f32 v[72:73], v[72:73], v[42:43], v[40:41]
    v_pk_fma_f32 v[74:75], v[74:75], v[42:43], v[40:41]
    v_pk_fma_f32 v[76:77], v[76:77], v[42:43], v[40:41]
    v_pk_fma_f32 v[78:79], v[78:79], v[42:43], v[40:41]
    v_pk_mul_f32 v[64:65], v[64:65], v[48:49]
    v_pk_mul_f32 v[66:67], v[66:67], v[50:51]
    v_pk_mul_f32 v[68:69], v[68:69], v[52:53]
    v_pk_mul_f32 v[70:71], v[70:71], v[54:55]
    v_pk_mul_f32 v[72:73], v[72:73], v[56:57]
    v_pk_mul_f32 v[74:75], v[74:75], v[58:59]
    v_pk_mul_f32 v[76:77], v[76:77], v[60:61]
    v_pk_mul_f32 v[78:79], v[78:79], v[62:63]
    v_exp_f32 v64, v64
    v_exp_f32 v65, v65
    v_exp_f32 v66, v66
    v_exp_f32 v67, v67
    v_exp_f32 v68, v68
    v_exp_f32 v69, v69
    v_exp_f32 v70, v70
    v_exp_f32 v71, v71
    v_exp_f32 v72, v72
    v_exp_f32 v73, v73
    v_exp_f32 v74, v74
    v_exp_f32 v75, v75
    v_exp_f32 v76, v76
    v_exp_f32 v77, v77
    v_exp_f32 v78, v78
    v_exp_f32 v79, v79
    v_pk_fma_f32 v[64:65], v[64:65], v[34:35], v[34:35]
    v_pk_fma_f32 v[66:67], v[66:67], v[34:35], v[34:35]
    v_pk_fma_f32 v[68:69], v[68:69], v[34:35], v[34:35]
    v_pk_fma_f32 v[70:71], v[70:71], v[34:35], v[34:35]
    v_pk_fma_f32 v[72:73], v[72:73], v[34:35], v[34:35]
    v_pk_fma_f32 v[74:75], v[74:75], v[34:35], v[34:35]
    v_pk_fma_f32 v[76:77], v[76:77], v[34:35], v[34:35]
    v_pk_fma_f32 v[78:79], v[78:79], v[34:35], v[34:35]
    v_rcp_f32 v64, v64
    v_rcp_f32 v65, v65
    v_rcp_f32 v66, v66
    v_rcp_f32 v67, v67
    v_rcp_f32 v68, v68
    v_rcp_f32 v69, v69
    v_rcp_f32 v70, v70
    v_rcp_f32 v71, v71
    v_rcp_f32 v72, v72
    v_rcp_f32 v73, v73
    v_rcp_f32 v74, v74
    v_rcp_f32 v75, v75
    v_rcp_f32 v76, v76
    v_rcp_f32 v77, v77
    v_rcp_f32 v78, v78
    v_rcp_f32 v79, v79
    v_pk_mul_f32 v[64:65], v[64:65], v[48:49]
    v_pk_mul_f32 v[66:67], v[66:67], v[50:51]
    v_pk_mul_f32 v[68:69], v[68:69], v[52:53]
    v_pk_mul_f32 v[70:71], v[70:71], v[54:55]
    v_pk_mul_f32 v[72:73], v[72:73], v[56:57]
    v_pk_mul_f32 v[74:75], v[74:75], v[58:59]
    v_pk_mul_f32 v[76:77], v[76:77], v[60:61]
    v_pk_mul_f32 v[78:79], v[78:79], v[62:63]
    v_cvt_pk_bf16_f32 v80, v64, v65
    v_cvt_pk_bf16_f32 v81, v66, v67
    v_cvt_pk_bf16_f32 v82, v68, v69
    v_cvt_pk_bf16_f32 v83, v70, v71
    v_cvt_pk_bf16_f32 v84, v72, v73
    v_cvt_pk_bf16_f32 v85, v74, v75
    v_cvt_pk_bf16_f32 v86, v76, v77
    v_cvt_pk_bf16_f32 v87, v78, v79
    s_add_u32 s26, s24, 9383936
    s_cmp_eq_u32 s46, 0
    s_cbranch_scc1 .Lhh_153
    s_add_u32 s27, s26, s52
    buffer_store_dwordx4 v[80:83], v1, s[4:7], s27 offen sc1
    buffer_store_dwordx4 v[84:87], v1, s[4:7], s27 offen offset:1024 sc1
.Lhh_153:
    s_cmp_eq_u32 s45, 0
    s_cbranch_scc1 .Lsts_155
    buffer_store_dwordx4 v[80:83], v1, s[4:7], s26 offen
    buffer_store_dwordx4 v[84:87], v1, s[4:7], s26 offen offset:1024
    s_branch .Lstd_156
.Lsts_155:
    buffer_store_dwordx4 v[80:83], v1, s[4:7], s26 offen sc1
    buffer_store_dwordx4 v[84:87], v1, s[4:7], s26 offen offset:1024 sc1
.Lstd_156:
    ds_read_b128 v[128:131], v4 offset:49152
    ds_read_b128 v[132:135], v4 offset:50176
    ds_read_b128 v[136:139], v4 offset:51200
    ds_read_b128 v[140:143], v4 offset:52224
    ds_read_b128 v[144:147], v4 offset:53248
    ds_read_b128 v[148:151], v4 offset:54272
    ds_read_b128 v[152:155], v4 offset:55296
    ds_read_b128 v[156:159], v4 offset:56320
    ds_read_b128 v[160:163], v4 offset:57344
    ds_read_b128 v[164:167], v4 offset:58368
    ds_read_b128 v[168:171], v4 offset:59392
    ds_read_b128 v[172:175], v4 offset:60416
    s_lshl_b32 s26, s16, 4
    v_and_b32 v13, 15, v2
    v_add_u32 v13, s26, v13
    v_and_b32 v38, 0x300, v1
    v_mov_b32 v39, 2147483632
    s_movk_i32 s27, 2048
    s_lshr_b32 s28, s16, 4
    v_add_u32 v36, -1, v13
    v_lshrrev_b32 v37, 8, v36
    v_cmp_ne_u32 s[30:31], s28, v37
    v_cmp_gt_u32 vcc, s27, v36
    v_lshrrev_b32 v3, 4, v36
    v_lshl_add_u32 v3, v3, 14, v38
    v_and_b32 v36, 15, v36
    v_lshl_add_u32 v3, v36, 4, v3
    v_add_u32 v37, s52, v3
    v_cndmask_b32 v3, v3, v37, s[30:31]
    v_cndmask_b32 v32, v39, v3, vcc
    v_add_u32 v36, 1, v13
    v_lshrrev_b32 v37, 8, v36
    v_cmp_ne_u32 s[30:31], s28, v37
    v_cmp_gt_u32 vcc, s27, v36
    v_lshrrev_b32 v3, 4, v36
    v_lshl_add_u32 v3, v3, 14, v38
    v_and_b32 v36, 15, v36
    v_lshl_add_u32 v3, v36, 4, v3
    v_add_u32 v37, s52, v3
    v_cndmask_b32 v3, v3, v37, s[30:31]
    v_cndmask_b32 v33, v39, v3, vcc
    v_add_u32 v36, -2, v13
    v_lshrrev_b32 v37, 8, v36
    v_cmp_ne_u32 s[30:31], s28, v37
    v_cmp_gt_u32 vcc, s27, v36
    v_lshrrev_b32 v3, 4, v36
    v_lshl_add_u32 v3, v3, 14, v38
    v_and_b32 v36, 15, v36
    v_lshl_add_u32 v3, v36, 4, v3
    v_add_u32 v37, s52, v3
    v_cndmask_b32 v3, v3, v37, s[30:31]
    v_cndmask_b32 v34, v39, v3, vcc
    v_add_u32 v36, 2, v13
    v_lshrrev_b32 v37, 8, v36
    v_cmp_ne_u32 s[30:31], s28, v37
    v_cmp_gt_u32 vcc, s27, v36
    v_lshrrev_b32 v3, 4, v36
    v_lshl_add_u32 v3, v3, 14, v38
    v_and_b32 v36, 15, v36
    v_lshl_add_u32 v3, v36, 4, v3
    v_add_u32 v37, s52, v3
    v_cndmask_b32 v3, v3, v37, s[30:31]
    v_cndmask_b32 v35, v39, v3, vcc
    s_mov_b32 s26, 9383936
    s_and_b32 s30, s16, 0x70
    s_or_b32 s31, s16, 15
    v_and_b32 v13, 2, v2
    v_add_u32 v13, -1, v13
    v_bfe_u32 v38, v2, 3, 1
    v_mul_i32_i24 v13, v13, v38
    v_add_u32 v13, s16, v13
    v_max_i32 v13, s30, v13
    v_min_i32 v13, s31, v13
    v_and_b32 v38, 0x1c, v7
    v_lshl_add_u32 v13, v13, 10, v38
    s_add_u32 s29, s44, 7025024
    v_and_b32 v36, 1, v2
    v_bfe_u32 v37, v2, 1, 1
    v_lshlrev_b32 v36, 2, v36
    v_lshl_add_u32 v36, v37, 4, v36
    v_mov_b32 v40, v10
    v_mov_b32 v41, v10
    v_mov_b32 v42, v11
    v_mov_b32 v43, v11
    v_pk_fma_f32 v[48:49], v[16:17], v[42:43], v[40:41] neg_lo:[0,0,1] neg_hi:[0,0,1]
    v_pk_fma_f32 v[50:51], v[18:19], v[42:43], v[40:41] neg_lo:[0,0,1] neg_hi:[0,0,1]
    v_pk_fma_f32 v[52:53], v[20:21], v[42:43], v[40:41] neg_lo:[0,0,1] neg_hi:[0,0,1]
    v_pk_fma_f32 v[54:55], v[22:23], v[42:43], v[40:41] neg_lo:[0,0,1] neg_hi:[0,0,1]
    v_pk_fma_f32 v[56:57], v[24:25], v[42:43], v[40:41] neg_lo:[0,0,1] neg_hi:[0,0,1]
    v_pk_fma_f32 v[58:59], v[26:27], v[42:43], v[40:41] neg_lo:[0,0,1] neg_hi:[0,0,1]
    v_pk_fma_f32 v[60:61], v[28:29], v[42:43], v[40:41] neg_lo:[0,0,1] neg_hi:[0,0,1]
    v_pk_fma_f32 v[62:63], v[30:31], v[42:43], v[40:41] neg_lo:[0,0,1] neg_hi:[0,0,1]
    s_waitcnt vmcnt(0)
    s_cmp_eq_u32 s46, 0
    s_cbranch_scc1 .Lhh2_154
    s_mov_b64 exec, 1
    buffer_store_dword v8, v7, s[4:7], s47 offen offset:896 sc1
    s_mov_b64 exec, -1
.Lhh2_154:
    s_cmp_eq_u32 s45, 0
    s_cbranch_scc1 .Lsts_157
    s_mov_b64 exec, 1
    buffer_store_dword v8, v9, s[4:7], s47 offen offset:384
    s_mov_b64 exec, -1
    s_branch .Lstd_158
.Lsts_157:
    s_mov_b64 exec, 1
    buffer_store_dword v8, v9, s[4:7], s47 offen offset:384 sc1
    s_mov_b64 exec, -1
.Lstd_158:
    ds_read_b128 v[176:179], v4 offset:61440
    ds_read_b128 v[180:183], v4 offset:62464
    s_waitcnt lgkmcnt(8)
    ds_read_b128 v[184:187], v4 offset:63488
    ds_read_b128 v[188:191], v4 offset:64512
    s_mov_b64 exec, 0xffff
    buffer_load_dword v0, v13, s[4:7], s29 offen sc1
    s_mov_b64 exec, -1
    ds_read_b128 v[192:195], v5 offset:0
    ds_read_b128 v[196:199], v5 offset:1024
    ds_read_b128 v[200:203], v5 offset:2048
    ds_read_b128 v[204:207], v5 offset:3072
    ds_read_b128 v[208:211], v5 offset:4096
    s_waitcnt lgkmcnt(8)
    ds_read_b128 v[212:215], v5 offset:5120
    ds_read_b128 v[216:219], v5 offset:6144
    ds_read_b128 v[220:223], v5 offset:7168
    ds_read_b128 v[224:227], v5 offset:8192
    ds_read_b128 v[228:231], v5 offset:9216
    ds_read_b128 v[232:235], v5 offset:10240
    ds_read_b128 v[236:239], v5 offset:11264
    s_mov_b64 exec, 0xffff
    s_waitcnt vmcnt(0)
    v_cmp_le_u32 vcc, 1, v0
    s_nop 0
    s_cmp_eq_u64 vcc, exec
    s_cbranch_scc1 .Lpolld_162
.Lpoll_159:
    s_cmp_eq_u32 s45, 0
    s_cbranch_scc1 .Lpolls_160
    buffer_load_dword v3, v13, s[4:7], s29 offen sc1
    s_branch .Lpollc_161
.Lpolls_160:
    v_mov_b32 v3, 0
    buffer_atomic_add v3, v13, s[4:7], s29 offen sc0
.Lpollc_161:
    s_waitcnt vmcnt(0)
    v_cmp_le_u32 vcc, 1, v3
    s_nop 0
    s_cmp_eq_u64 vcc, exec
    s_cbranch_scc1 .Lpolld_162
    s_sub_u32 s23, s23, 1
    s_cbranch_scc1 .Lexit_1
    s_branch .Lpoll_159
.Lpolld_162:
    s_mov_b64 exec, -1
    s_waitcnt lgkmcnt(8)
    ds_read_b128 v[44:47], v15 offset:16
    s_cmp_eq_u32 s53, 0
    s_cbranch_scc1 .Lrh_163
    s_add_u32 s29, s53, s44
    s_mov_b64 exec, 0xf
.Lpoll_164:
    v_mov_b32 v3, 0
    buffer_atomic_add v3, v36, s[4:7], s29 offen sc0
.Lpollc_166:
    s_waitcnt vmcnt(0)
    v_cmp_le_u32 vcc, 1, v3
    s_nop 0
    s_cmp_eq_u64 vcc, exec
    s_cbranch_scc1 .Lpolld_167
    s_sub_u32 s23, s23, 1
    s_cbranch_scc1 .Lexit_1
    s_branch .Lpoll_164
.Lpolld_167:
    s_mov_b64 exec, -1
.Lrh_163:
    buffer_load_dwordx4 v[64:67], v32, s[4:7], s26 offen sc1
    buffer_load_dwordx4 v[68:71], v32, s[4:7], s26 offen offset:1024 sc1
    buffer_load_dwordx4 v[72:75], v32, s[4:7], s26 offen offset:2048 sc1
    buffer_load_dwordx4 v[76:79], v32, s[4:7], s26 offen offset:3072 sc1
    s_add_u32 s26, s26, 4096
    buffer_load_dwordx4 v[80:83], v33, s[4:7], s26 offen sc1
    buffer_load_dwordx4 v[84:87], v33, s[4:7], s26 offen offset:1024 sc1
    buffer_load_dwordx4 v[88:91], v33, s[4:7], s26 offen offset:2048 sc1
    buffer_load_dwordx4 v[92:95], v33, s[4:7], s26 offen offset:3072 sc1
    s_add_u32 s26, s26, 4096
    buffer_load_dwordx4 v[96:99], v34, s[4:7], s26 offen sc1
    buffer_load_dwordx4 v[100:103], v34, s[4:7], s26 offen offset:1024 sc1
    buffer_load_dwordx4 v[104:107], v34, s[4:7], s26 offen offset:2048 sc1
    buffer_load_dwordx4 v[108:111], v34, s[4:7], s26 offen offset:3072 sc1
    s_add_u32 s26, s26, 4096
    buffer_load_dwordx4 v[112:115], v35, s[4:7], s26 offen sc1
    buffer_load_dwordx4 v[116:119], v35, s[4:7], s26 offen offset:1024 sc1
    buffer_load_dwordx4 v[120:123], v35, s[4:7], s26 offen offset:2048 sc1
    buffer_load_dwordx4 v[124:127], v35, s[4:7], s26 offen offset:3072 sc1
    s_add_u32 s51, s50, 6
    v_mov_b32 v3, s51
    ds_write_b32 v14, v3 offset:0
    s_waitcnt lgkmcnt(0)
    s_waitcnt vmcnt(15)
    v_mfma_f32_16x16x32_bf16 v[48:51], v[128:131], v[64:67], v[48:51]
    v_mfma_f32_16x16x32_bf16 v[52:55], v[132:135], v[64:67], v[52:55]
    v_mfma_f32_16x16x32_bf16 v[56:59], v[136:139], v[64:67], v[56:59]
    v_mfma_f32_16x16x32_bf16 v[60:63], v[140:143], v[64:67], v[60:63]
    s_waitcnt vmcnt(14)
    v_mfma_f32_16x16x32_bf16 v[48:51], v[144:147], v[68:71], v[48:51]
    s_add_u32 s51, s50, 5
    v_min_u32 v44, v44, v45
    v_min3_u32 v44, v44, v46, v47
    v_cmp_le_u32 vcc, s51, v44
    s_cbranch_vccnz .Llt_168
    s_add_u32 s51, s50, 5
.Llw_169:
    ds_read_b128 v[44:47], v15 offset:16
    s_waitcnt lgkmcnt(0)
    v_min_u32 v44, v44, v45
    v_min3_u32 v44, v44, v46, v47
    v_cmp_le_u32 vcc, s51, v44
    s_cbranch_vccnz .Llwd_170
    s_sub_u32 s23, s23, 1
    s_cbranch_scc1 .Lexit_1
    s_branch .Llw_169
.Llwd_170:
.Llt_168:
    ds_read_b128 v[128:131], v5 offset:12288
    ds_read_b128 v[132:135], v5 offset:13312
    v_mfma_f32_16x16x32_bf16 v[52:55], v[148:151], v[68:71], v[52:55]
    v_mfma_f32_16x16x32_bf16 v[56:59], v[152:155], v[68:71], v[56:59]
    ds_read_b128 v[136:139], v5 offset:14336
    ds_read_b128 v[140:143], v5 offset:15360
    v_mfma_f32_16x16x32_bf16 v[60:63], v[156:159], v[68:71], v[60:63]
    s_waitcnt vmcnt(13)
    v_mfma_f32_16x16x32_bf16 v[48:51], v[160:163], v[72:75], v[48:51]
    ds_read_b128 v[144:147], v5 offset:16384
    ds_read_b128 v[148:151], v5 offset:17408
    v_mfma_f32_16x16x32_bf16 v[52:55], v[164:167], v[72:75], v[52:55]
    v_mfma_f32_16x16x32_bf16 v[56:59], v[168:171], v[72:75], v[56:59]
    ds_read_b128 v[152:155], v5 offset:18432
    ds_read_b128 v[156:159], v5 offset:19456
    v_mfma_f32_16x16x32_bf16 v[60:63], v[172:175], v[72:75], v[60:63]
    s_waitcnt vmcnt(12)
    v_mfma_f32_16x16x32_bf16 v[48:51], v[176:179], v[76:79], v[48:51]
    ds_read_b128 v[160:163], v5 offset:20480
    ds_read_b128 v[164:167], v5 offset:21504
    v_mfma_f32_16x16x32_bf16 v[52:55], v[180:183], v[76:79], v[52:55]
    v_mfma_f32_16x16x32_bf16 v[56:59], v[184:187], v[76:79], v[56:59]
    ds_read_b128 v[168:171], v5 offset:22528
    ds_read_b128 v[172:175], v5 offset:23552
    v_mfma_f32_16x16x32_bf16 v[60:63], v[188:191], v[76:79], v[60:63]
    s_waitcnt vmcnt(11)
    v_mfma_f32_16x16x32_bf16 v[48:51], v[192:195], v[80:83], v[48:51]
    ds_read_b128 v[176:179], v5 offset:24576
    ds_read_b128 v[180:183], v5 offset:25600
    v_mfma_f32_16x16x32_bf16 v[52:55], v[196:199], v[80:83], v[52:55]
    v_mfma_f32_16x16x32_bf16 v[56:59], v[200:203], v[80:83], v[56:59]
    ds_read_b128 v[184:187], v5 offset:26624
    s_waitcnt lgkmcnt(8)
    ds_read_b128 v[188:191], v5 offset:27648
    v_mfma_f32_16x16x32_bf16 v[60:63], v[204:207], v[80:83], v[60:63]
    s_waitcnt vmcnt(10)
    v_mfma_f32_16x16x32_bf16 v[48:51], v[208:211], v[84:87], v[48:51]
    ds_read_b128 v[192:195], v1 offset:0
    ds_read_b128 v[196:199], v1 offset:1024
    v_mfma_f32_16x16x32_bf16 v[52:55], v[212:215], v[84:87], v[52:55]
    v_mfma_f32_16x16x32_bf16 v[56:59], v[216:219], v[84:87], v[56:59]
    ds_read_b128 v[200:203], v1 offset:2048
    ds_read_b128 v[204:207], v1 offset:3072
    v_mfma_f32_16x16x32_bf16 v[60:63], v[220:223], v[84:87], v[60:63]
    s_waitcnt vmcnt(9)
    v_mfma_f32_16x16x32_bf16 v[48:51], v[224:227], v[88:91], v[48:51]
    ds_read_b128 v[208:211], v1 offset:4096
    ds_read_b128 v[212:215], v1 offset:5120
    v_mfma_f32_16x16x32_bf16 v[52:55], v[228:231], v[88:91], v[52:55]
    v_mfma_f32_16x16x32_bf16 v[56:59], v[232:235], v[88:91], v[56:59]
    s_waitcnt lgkmcnt(8)
    ds_read_b128 v[216:219], v1 offset:6144
    ds_read_b128 v[220:223], v1 offset:7168
    v_mfma_f32_16x16x32_bf16 v[60:63], v[236:239], v[88:91], v[60:63]
    s_waitcnt vmcnt(8)
    v_mfma_f32_16x16x32_bf16 v[48:51], v[128:131], v[92:95], v[48:51]
    ds_read_b128 v[224:227], v1 offset:8192
    ds_read_b128 v[228:231], v1 offset:9216
    v_mfma_f32_16x16x32_bf16 v[52:55], v[132:135], v[92:95], v[52:55]
    v_mfma_f32_16x16x32_bf16 v[56:59], v[136:139], v[92:95], v[56:59]
    ds_read_b128 v[232:235], v1 offset:10240
    ds_read_b128 v[236:239], v1 offset:11264
    v_mfma_f32_16x16x32_bf16 v[60:63], v[140:143], v[92:95], v[60:63]
    s_waitcnt vmcnt(7)
    v_mfma_f32_16x16x32_bf16 v[48:51], v[144:147], v[96:99], v[48:51]
    ds_read_b128 v[128:131], v1 offset:12288
    s_waitcnt lgkmcnt(8)
    ds_read_b128 v[132:135], v1 offset:13312
    v_mfma_f32_16x16x32_bf16 v[52:55], v[148:151], v[96:99], v[52:55]
    v_mfma_f32_16x16x32_bf16 v[56:59], v[152:155], v[96:99], v[56:59]
    ds_read_b128 v[136:139], v1 offset:14336
    ds_read_b128 v[140:143], v1 offset:15360
    v_mfma_f32_16x16x32_bf16 v[60:63], v[156:159], v[96:99], v[60:63]
    s_waitcnt vmcnt(6)
    v_mfma_f32_16x16x32_bf16 v[48:51], v[160:163], v[100:103], v[48:51]
    ds_read_b128 v[144:147], v1 offset:16384
    ds_read_b128 v[148:151], v1 offset:17408
    v_mfma_f32_16x16x32_bf16 v[52:55], v[164:167], v[100:103], v[52:55]
    v_mfma_f32_16x16x32_bf16 v[56:59], v[168:171], v[100:103], v[56:59]
    ds_read_b128 v[152:155], v1 offset:18432
    ds_read_b128 v[156:159], v1 offset:19456
    v_mfma_f32_16x16x32_bf16 v[60:63], v[172:175], v[100:103], v[60:63]
    s_waitcnt vmcnt(5)
    v_mfma_f32_16x16x32_bf16 v[48:51], v[176:179], v[104:107], v[48:51]
    v_mfma_f32_16x16x32_bf16 v[52:55], v[180:183], v[104:107], v[52:55]
    v_mfma_f32_16x16x32_bf16 v[56:59], v[184:187], v[104:107], v[56:59]
    v_mfma_f32_16x16x32_bf16 v[60:63], v[188:191], v[104:107], v[60:63]
    s_waitcnt vmcnt(4)
    v_mfma_f32_16x16x32_bf16 v[48:51], v[192:195], v[108:111], v[48:51]
    v_mfma_f32_16x16x32_bf16 v[52:55], v[196:199], v[108:111], v[52:55]
    v_mfma_f32_16x16x32_bf16 v[56:59], v[200:203], v[108:111], v[56:59]
    v_mfma_f32_16x16x32_bf16 v[60:63], v[204:207], v[108:111], v[60:63]
    s_waitcnt vmcnt(3) lgkmcnt(12)
    v_mfma_f32_16x16x32_bf16 v[48:51], v[208:211], v[112:115], v[48:51]
    v_mfma_f32_16x16x32_bf16 v[52:55], v[212:215], v[112:115], v[52:55]
    v_mfma_f32_16x16x32_bf16 v[56:59], v[216:219], v[112:115], v[56:59]
    v_mfma_f32_16x16x32_bf16 v[60:63], v[220:223], v[112:115], v[60:63]
    s_waitcnt vmcnt(2) lgkmcnt(8)
    v_mfma_f32_16x16x32_bf16 v[48:51], v[224:227], v[116:119], v[48:51]
    v_mfma_f32_16x16x32_bf16 v[52:55], v[228:231], v[116:119], v[52:55]
    v_mfma_f32_16x16x32_bf16 v[56:59], v[232:235], v[116:119], v[56:59]
    v_mfma_f32_16x16x32_bf16 v[60:63], v[236:239], v[116:119], v[60:63]
    s_waitcnt vmcnt(1) lgkmcnt(4)
    v_mfma_f32_16x16x32_bf16 v[48:51], v[128:131], v[120:123], v[48:51]
    v_mfma_f32_16x16x32_bf16 v[52:55], v[132:135], v[120:123], v[52:55]
    v_mfma_f32_16x16x32_bf16 v[56:59], v[136:139], v[120:123], v[56:59]
    v_mfma_f32_16x16x32_bf16 v[60:63], v[140:143], v[120:123], v[60:63]
    s_waitcnt vmcnt(0) lgkmcnt(0)
    v_mfma_f32_16x16x32_bf16 v[48:51], v[144:147], v[124:127], v[48:51]
    v_mfma_f32_16x16x32_bf16 v[52:55], v[148:151], v[124:127], v[52:55]
    v_mfma_f32_16x16x32_bf16 v[56:59], v[152:155], v[124:127], v[56:59]
    v_mfma_f32_16x16x32_bf16 v[60:63], v[156:159], v[124:127], v[60:63]
    s_add_u32 s51, s50, 7
    v_mov_b32 v3, s51
    ds_write_b32 v14, v3 offset:0
    s_nop 1
    v_cvt_pk_bf16_f32 v64, v48, v49
    v_cvt_pk_bf16_f32 v65, v50, v51
    v_cvt_pk_bf16_f32 v66, v52, v53
    v_cvt_pk_bf16_f32 v67, v54, v55
    v_cvt_pk_bf16_f32 v68, v56, v57
    v_cvt_pk_bf16_f32 v69, v58, v59
    v_cvt_pk_bf16_f32 v70, v60, v61
    v_cvt_pk_bf16_f32 v71, v62, v63
    s_add_u32 s26, s24, 7155712
    s_add_u32 s27, s25, 9252864
    s_cmp_eq_u32 s45, 0
    s_cbranch_scc1 .Lsts_171
    buffer_store_dwordx4 v[64:67], v1, s[4:7], s26 offen
    buffer_store_dwordx4 v[68:71], v1, s[4:7], s26 offen offset:1024
    s_branch .Lstd_172
.Lsts_171:
    buffer_store_dwordx4 v[64:67], v1, s[4:7], s26 offen sc1
    buffer_store_dwordx4 v[68:71], v1, s[4:7], s26 offen offset:1024 sc1
.Lstd_172:
    v_pk_add_f32 v[72:73], v[48:49], v[50:51]
    v_pk_mul_f32 v[74:75], v[48:49], v[48:49]
    v_pk_fma_f32 v[74:75], v[50:51], v[50:51], v[74:75]
    v_pk_add_f32 v[72:73], v[72:73], v[52:53]
    v_pk_fma_f32 v[74:75], v[52:53], v[52:53], v[74:75]
    v_pk_add_f32 v[72:73], v[72:73], v[54:55]
    v_pk_fma_f32 v[74:75], v[54:55], v[54:55], v[74:75]
    v_pk_add_f32 v[72:73], v[72:73], v[56:57]
    v_pk_fma_f32 v[74:75], v[56:57], v[56:57], v[74:75]
    v_pk_add_f32 v[72:73], v[72:73], v[58:59]
    v_pk_fma_f32 v[74:75], v[58:59], v[58:59], v[74:75]
    v_pk_add_f32 v[72:73], v[72:73], v[60:61]
    v_pk_fma_f32 v[74:75], v[60:61], v[60:61], v[74:75]
    v_pk_add_f32 v[72:73], v[72:73], v[62:63]
    v_pk_fma_f32 v[74:75], v[62:63], v[62:63], v[74:75]
    v_add_f32 v72, v72, v73
    v_add_f32 v73, v74, v75
    s_nop 1
    v_permlane32_swap_b32 v72, v73
    v_add_f32 v72, v72, v73
    v_mov_b32 v73, v72
    s_nop 1
    v_permlane16_swap_b32 v72, v73
    v_add_f32 v72, v72, v73
    v_mov_b32 v73, v72
    s_nop 1
    v_permlane32_swap_b32 v72, v73
    s_cmp_eq_u32 s45, 0
    s_cbranch_scc1 .Lsts_173
    s_mov_b64 exec, 0xffff
    buffer_store_dwordx2 v[72:73], v6, s[4:7], s27 offen
    s_mov_b64 exec, -1
    s_branch .Lstd_174
.Lsts_173:
    s_mov_b64 exec, 0xffff
    buffer_store_dwordx2 v[72:73], v6, s[4:7], s27 offen sc1
    s_mov_b64 exec, -1
.Lstd_174:
    v_pk_add_f32 v[16:17], v[16:17], v[48:49]
    v_pk_add_f32 v[18:19], v[18:19], v[50:51]
    v_pk_add_f32 v[20:21], v[20:21], v[52:53]
    v_pk_add_f32 v[22:23], v[22:23], v[54:55]
    v_pk_add_f32 v[24:25], v[24:25], v[56:57]
    v_pk_add_f32 v[26:27], v[26:27], v[58:59]
    v_pk_add_f32 v[28:29], v[28:29], v[60:61]
    v_pk_add_f32 v[30:31], v[30:31], v[62:63]
    s_lshl_b32 s26, s18, 14
    s_add_u32 s26, s26, s20
    s_add_u32 s26, s26, 7155712
    s_add_u32 s27, s26, 16384
    s_lshl_b32 s28, s18, 10
    s_add_u32 s28, s28, s20
    s_add_u32 s28, s28, 9252864
    s_lshl_b32 s29, s18, 10
    s_add_u32 s29, s29, s44
    s_add_u32 s29, s29, 7025152
    s_mul_i32 s30, s18, 57344
    s_add_u32 s30, s30, s20
    s_add_u32 s30, s30, 11481088
    s_lshl_b32 s32, s19, 9
    s_add_u32 s32, s32, s30
    s_add_u32 s32, s32, 49152
    s_mul_i32 s31, s19, 3072
    s_add_u32 s30, s30, s31
    s_add_u32 s31, s30, 57344
    v_bfe_u32 v3, v2, 4, 1
    v_mul_u32_u24 v13, 57344, v3
    v_lshrrev_b32 v3, 5, v2
    v_lshl_add_u32 v13, v3, 8, v13
    v_and_b32 v3, 0xf0, v1
    v_add_u32 v13, v13, v3
    v_and_b32 v3, 0x30, v2
    v_add_u32 v3, 160384, v3
    ds_read_b128 v[224:227], v3 offset:0
    ds_read_b128 v[228:231], v3 offset:64
    ds_read_b128 v[232:235], v3 offset:128
    ds_read_b128 v[236:239], v3 offset:192
    ds_read_b128 v[240:243], v3 offset:256
    ds_read_b128 v[244:247], v3 offset:320
    ds_read_b128 v[248:251], v3 offset:384
    s_waitcnt vmcnt(0)
    s_cmp_eq_u32 s45, 0
    s_cbranch_scc1 .Lsts_175
    s_mov_b64 exec, 1
    buffer_store_dword v8, v9, s[4:7], s47 offen offset:512
    s_mov_b64 exec, -1
    s_branch .Lstd_176
.Lsts_175:
    s_mov_b64 exec, 1
    buffer_store_dword v8, v9, s[4:7], s47 offen offset:512 sc1
    s_mov_b64 exec, -1
.Lstd_176:
.Lst_w3:
    s_add_u32 s51, s50, 6
.Llw_177:
    ds_read_b128 v[252:255], v15 offset:16
    s_waitcnt lgkmcnt(0)
    v_min_u32 v252, v252, v253
    v_min3_u32 v252, v252, v254, v255
    v_cmp_le_u32 vcc, s51, v252
    s_cbranch_vccnz .Llwd_178
    s_sub_u32 s23, s23, 1
    s_cbranch_scc1 .Lexit_1
    s_branch .Llw_177
.Llwd_178:
    s_mov_b64 exec, 0xffff
    buffer_load_dword v0, v9, s[4:7], s29 offen sc1
    s_mov_b64 exec, -1
    ds_read_b128 v[104:107], v1 offset:21504
    ds_read_b128 v[108:111], v1 offset:22528
    ds_read_b128 v[112:115], v1 offset:23552
    ds_read_b128 v[116:119], v1 offset:24576
    ds_read_b128 v[120:123], v1 offset:25600
    ds_read_b128 v[124:127], v1 offset:26624
    ds_read_b128 v[128:131], v1 offset:27648
    ds_read_b128 v[132:135], v1 offset:28672
    ds_read_b128 v[136:139], v1 offset:29696
    ds_read_b128 v[140:143], v1 offset:30720
    ds_read_b128 v[144:147], v1 offset:31744
    ds_read_b128 v[148:151], v1 offset:32768
    ds_read_b128 v[152:155], v1 offset:33792
    ds_read_b128 v[156:159], v1 offset:34816
    s_mov_b64 exec, 0xffff
    s_waitcnt vmcnt(0)
    v_cmp_le_u32 vcc, 1, v0
    s_nop 0
    s_cmp_eq_u64 vcc, exec
    s_cbranch_scc1 .Lpolld_182
.Lpoll_179:
    s_cmp_eq_u32 s45, 0
    s_cbranch_scc1 .Lpolls_180
    buffer_load_dword v3, v9, s[4:7], s29 offen sc1
    s_branch .Lpollc_181
.Lpolls_180:
    v_mov_b32 v3, 0
    buffer_atomic_add v3, v9, s[4:7], s29 offen sc0
.Lpollc_181:
    s_waitcnt vmcnt(0)
    v_cmp_le_u32 vcc, 1, v3
    s_nop 0
    s_cmp_eq_u64 vcc, exec
    s_cbranch_scc1 .Lpolld_182
    s_sub_u32 s23, s23, 1
    s_cbranch_scc1 .Lexit_1
    s_branch .Lpoll_179
.Lpolld_182:
    s_mov_b64 exec, -1
    buffer_load_dwordx4 v[160:163], v1, s[4:7], s26 offen sc1
    buffer_load_dwordx4 v[164:167], v1, s[4:7], s27 offen sc1
    buffer_load_dwordx4 v[168:171], v1, s[4:7], s26 offen offset:1024 sc1
    buffer_load_dwordx4 v[172:175], v1, s[4:7], s27 offen offset:1024 sc1
    buffer_load_dwordx2 v[32:33], v6, s[4:7], s28 offen sc1
    buffer_load_dwordx2 v[34:35], v6, s[4:7], s28 offen offset:128 sc1
    buffer_load_dwordx2 v[36:37], v6, s[4:7], s28 offen offset:1024 sc1
    buffer_load_dwordx2 v[38:39], v6, s[4:7], s28 offen offset:1152 sc1
    buffer_load_dwordx4 v[176:179], v1, s[4:7], s26 offen offset:2048 sc1
    buffer_load_dwordx4 v[180:183], v1, s[4:7], s27 offen offset:2048 sc1
    buffer_load_dwordx4 v[184:187], v1, s[4:7], s26 offen offset:3072 sc1
    s_add_u32 s26, s26, 4096
    buffer_load_dwordx4 v[188:191], v1, s[4:7], s27 offen offset:3072 sc1
    s_add_u32 s27, s27, 4096
    buffer_load_dwordx4 v[192:195], v1, s[4:7], s26 offen sc1
    buffer_load_dwordx4 v[196:199], v1, s[4:7], s27 offen sc1
    buffer_load_dwordx4 v[200:203], v1, s[4:7], s26 offen offset:1024 sc1
    buffer_load_dwordx4 v[204:207], v1, s[4:7], s27 offen offset:1024 sc1
    s_waitcnt lgkmcnt(0)
    s_waitcnt vmcnt(14)
    v_mfma_f32_16x16x32_bf16 v[48:51], v[104:107], v[160:163], 0
    s_add_u32 s51, s50, 2
    v_mov_b32 v3, s51
    ds_write_b32 v14, v3 offset:64
    v_mfma_f32_16x16x32_bf16 v[76:79], v[104:107], v[164:167], 0
    ds_read_b128 v[104:107], v1 offset:35840
    v_mfma_f32_16x16x32_bf16 v[52:55], v[108:111], v[160:163], 0
    buffer_load_dwordx4 v[208:211], v1, s[4:7], s26 offen offset:2048 sc1
    v_mfma_f32_16x16x32_bf16 v[80:83], v[108:111], v[164:167], 0
    ds_read_b128 v[108:111], v1 offset:36864
    v_mfma_f32_16x16x32_bf16 v[56:59], v[112:115], v[160:163], 0
    v_mfma_f32_16x16x32_bf16 v[84:87], v[112:115], v[164:167], 0
    ds_read_b128 v[112:115], v1 offset:37888
    v_mfma_f32_16x16x32_bf16 v[60:63], v[116:119], v[160:163], 0
    v_mfma_f32_16x16x32_bf16 v[88:91], v[116:119], v[164:167], 0
    ds_read_b128 v[116:119], v1 offset:38912
    v_mfma_f32_16x16x32_bf16 v[64:67], v[120:123], v[160:163], 0
    buffer_load_dwordx4 v[212:215], v1, s[4:7], s27 offen offset:2048 sc1
    v_mfma_f32_16x16x32_bf16 v[92:95], v[120:123], v[164:167], 0
    ds_read_b128 v[120:123], v1 offset:39936
    v_mfma_f32_16x16x32_bf16 v[68:71], v[124:127], v[160:163], 0
    v_mfma_f32_16x16x32_bf16 v[96:99], v[124:127], v[164:167], 0
    ds_read_b128 v[124:127], v1 offset:40960
    v_mfma_f32_16x16x32_bf16 v[72:75], v[128:131], v[160:163], 0
    v_mfma_f32_16x16x32_bf16 v[100:103], v[128:131], v[164:167], 0
    ds_read_b128 v[128:131], v1 offset:41984
    s_waitcnt vmcnt(14)
    v_mfma_f32_16x16x32_bf16 v[48:51], v[132:135], v[168:171], v[48:51]
    v_mfma_f32_16x16x32_bf16 v[76:79], v[132:135], v[172:175], v[76:79]
    ds_read_b128 v[132:135], v1 offset:43008
    v_mfma_f32_16x16x32_bf16 v[52:55], v[136:139], v[168:171], v[52:55]
    buffer_load_dwordx4 v[216:219], v1, s[4:7], s26 offen offset:3072 sc1
    s_add_u32 s26, s26, 4096
    v_mfma_f32_16x16x32_bf16 v[80:83], v[136:139], v[172:175], v[80:83]
    ds_read_b128 v[136:139], v1 offset:44032
    v_mfma_f32_16x16x32_bf16 v[56:59], v[140:143], v[168:171], v[56:59]
    v_mfma_f32_16x16x32_bf16 v[84:87], v[140:143], v[172:175], v[84:87]
    ds_read_b128 v[140:143], v1 offset:45056
    v_mfma_f32_16x16x32_bf16 v[60:63], v[144:147], v[168:171], v[60:63]
    v_mfma_f32_16x16x32_bf16 v[88:91], v[144:147], v[172:175], v[88:91]
    ds_read_b128 v[144:147], v1 offset:46080
    v_mfma_f32_16x16x32_bf16 v[64:67], v[148:151], v[168:171], v[64:67]
    buffer_load_dwordx4 v[220:223], v1, s[4:7], s27 offen offset:3072 sc1
    s_add_u32 s27, s27, 4096
    v_mfma_f32_16x16x32_bf16 v[92:95], v[148:151], v[172:175], v[92:95]
    ds_read_b128 v[148:151], v1 offset:47104
    v_mfma_f32_16x16x32_bf16 v[68:71], v[152:155], v[168:171], v[68:71]
    v_mfma_f32_16x16x32_bf16 v[96:99], v[152:155], v[172:175], v[96:99]
    ds_read_b128 v[152:155], v1 offset:48128
    v_mfma_f32_16x16x32_bf16 v[72:75], v[156:159], v[168:171], v[72:75]
    v_mfma_f32_16x16x32_bf16 v[100:103], v[156:159], v[172:175], v[100:103]
    ds_read_b128 v[156:159], v1 offset:49152
    s_waitcnt vmcnt(10) lgkmcnt(13)
    v_mfma_f32_16x16x32_bf16 v[48:51], v[104:107], v[176:179], v[48:51]
    v_pk_add_f32 v[32:33], v[32:33], v[34:35]
    v_mfma_f32_16x16x32_bf16 v[76:79], v[104:107], v[180:183], v[76:79]
    ds_read_b128 v[104:107], v1 offset:50176
    s_waitcnt lgkmcnt(13)
    v_mfma_f32_16x16x32_bf16 v[52:55], v[108:111], v[176:179], v[52:55]
    buffer_load_dwordx4 v[160:163], v1, s[4:7], s26 offen sc1
    v_permlane32_swap_b32 v32, v33
    v_mfma_f32_16x16x32_bf16 v[80:83], v[108:111], v[180:183], v[80:83]
    ds_read_b128 v[108:111], v1 offset:51200
    s_waitcnt lgkmcnt(13)
    v_mfma_f32_16x16x32_bf16 v[56:59], v[112:115], v[176:179], v[56:59]
    v_add_f32 v32, v32, v33
    v_mfma_f32_16x16x32_bf16 v[84:87], v[112:115], v[180:183], v[84:87]
    ds_read_b128 v[112:115], v1 offset:52224
    s_waitcnt lgkmcnt(13)
    v_mfma_f32_16x16x32_bf16 v[60:63], v[116:119], v[176:179], v[60:63]
    v_mov_b32 v33, v32
    v_mfma_f32_16x16x32_bf16 v[88:91], v[116:119], v[180:183], v[88:91]
    ds_read_b128 v[116:119], v1 offset:53248
    s_waitcnt lgkmcnt(13)
    v_mfma_f32_16x16x32_bf16 v[64:67], v[120:123], v[176:179], v[64:67]
    buffer_load_dwordx4 v[164:167], v1, s[4:7], s27 offen sc1
    v_permlane16_swap_b32 v32, v33
    v_mfma_f32_16x16x32_bf16 v[92:95], v[120:123], v[180:183], v[92:95]
    ds_read_b128 v[120:123], v1 offset:54272
    s_waitcnt lgkmcnt(13)
    v_mfma_f32_16x16x32_bf16 v[68:71], v[124:127], v[176:179], v[68:71]
    v_add_f32 v32, v32, v33
    v_mfma_f32_16x16x32_bf16 v[96:99], v[124:127], v[180:183], v[96:99]
    ds_read_b128 v[124:127], v1 offset:55296
    s_waitcnt lgkmcnt(13)
    v_mfma_f32_16x16x32_bf16 v[72:75], v[128:131], v[176:179], v[72:75]
    v_mov_b32 v33, v32
    v_mfma_f32_16x16x32_bf16 v[100:103], v[128:131], v[180:183], v[100:103]
    ds_read_b128 v[128:131], v1 offset:56320
    s_waitcnt vmcnt(10) lgkmcnt(13)
    v_mfma_f32_16x16x32_bf16 v[48:51], v[132:135], v[184:187], v[48:51]
    v_permlane32_swap_b32 v32, v33
    v_mfma_f32_16x16x32_bf16 v[76:79], v[132:135], v[188:191], v[76:79]
    ds_read_b128 v[132:135], v1 offset:57344
    s_waitcnt lgkmcnt(13)
    v_mfma_f32_16x16x32_bf16 v[52:55], v[136:139], v[184:187], v[52:55]
    buffer_load_dwordx4 v[168:171], v1, s[4:7], s26 offen offset:1024 sc1
    v_mul_f32 v32, 0x3b000000, v32
    v_mfma_f32_16x16x32_bf16 v[80:83], v[136:139], v[188:191], v[80:83]
    ds_read_b128 v[136:139], v1 offset:58368
    s_waitcnt lgkmcnt(13)
    v_mfma_f32_16x16x32_bf16 v[56:59], v[140:143], v[184:187], v[56:59]
    v_mul_f32 v33, 0x3b000000, v33
    v_mfma_f32_16x16x32_bf16 v[84:87], v[140:143], v[188:191], v[84:87]
    ds_read_b128 v[140:143], v1 offset:59392
    s_waitcnt lgkmcnt(13)
    v_mfma_f32_16x16x32_bf16 v[60:63], v[144:147], v[184:187], v[60:63]
    v_fma_f32 v33, -v32, v32, v33
    v_mfma_f32_16x16x32_bf16 v[88:91], v[144:147], v[188:191], v[88:91]
    ds_read_b128 v[144:147], v1 offset:60416
    s_waitcnt lgkmcnt(13)
    v_mfma_f32_16x16x32_bf16 v[64:67], v[148:151], v[184:187], v[64:67]
    buffer_load_dwordx4 v[172:175], v1, s[4:7], s27 offen offset:1024 sc1
    v_max_f32 v33, 0, v33
    v_mfma_f32_16x16x32_bf16 v[92:95], v[148:151], v[188:191], v[92:95]
    ds_read_b128 v[148:151], v1 offset:61440
    s_waitcnt lgkmcnt(13)
    v_mfma_f32_16x16x32_bf16 v[68:71], v[152:155], v[184:187], v[68:71]
    v_add_f32 v34, 0x3727c5ac, v33
    v_mfma_f32_16x16x32_bf16 v[96:99], v[152:155], v[188:191], v[96:99]
    ds_read_b128 v[152:155], v1 offset:62464
    s_waitcnt lgkmcnt(13)
    v_mfma_f32_16x16x32_bf16 v[72:75], v[156:159], v[184:187], v[72:75]
    v_rsq_f32 v34, v34
    v_mfma_f32_16x16x32_bf16 v[100:103], v[156:159], v[188:191], v[100:103]
    ds_read_b128 v[156:159], v1 offset:63488
    s_waitcnt vmcnt(10) lgkmcnt(13)
    v_mfma_f32_16x16x32_bf16 v[48:51], v[104:107], v[192:195], v[48:51]
    v_mul_f32 v42, v34, v34
    v_mfma_f32_16x16x32_bf16 v[76:79], v[104:107], v[196:199], v[76:79]
    ds_read_b128 v[104:107], v1 offset:64512
    s_waitcnt lgkmcnt(13)
    v_mfma_f32_16x16x32_bf16 v[52:55], v[108:111], v[192:195], v[52:55]
    buffer_load_dwordx4 v[176:179], v1, s[4:7], s26 offen offset:2048 sc1
    v_mul_f32 v40, 0xc0135761, v34
    v_mfma_f32_16x16x32_bf16 v[80:83], v[108:111], v[196:199], v[80:83]
    ds_read_b128 v[108:111], v4 offset:0
    s_waitcnt lgkmcnt(13)
    v_mfma_f32_16x16x32_bf16 v[56:59], v[112:115], v[192:195], v[56:59]
    v_mul_f32 v42, v42, v34
    v_mfma_f32_16x16x32_bf16 v[84:87], v[112:115], v[196:199], v[84:87]
    ds_read_b128 v[112:115], v4 offset:1024
    s_waitcnt lgkmcnt(13)
    v_mfma_f32_16x16x32_bf16 v[60:63], v[116:119], v[192:195], v[60:63]
    v_rcp_f32 v34, v34
    v_mfma_f32_16x16x32_bf16 v[88:91], v[116:119], v[196:199], v[88:91]
    ds_read_b128 v[116:119], v4 offset:2048
    s_waitcnt lgkmcnt(13)
    v_mfma_f32_16x16x32_bf16 v[64:67], v[120:123], v[192:195], v[64:67]
    buffer_load_dwordx4 v[180:183], v1, s[4:7], s27 offen offset:2048 sc1
    v_mul_f32 v42, 0xbdd2d3e8, v42
    v_mfma_f32_16x16x32_bf16 v[92:95], v[120:123], v[196:199], v[92:95]
    ds_read_b128 v[120:123], v4 offset:3072
    s_waitcnt lgkmcnt(13)
    v_mfma_f32_16x16x32_bf16 v[68:71], v[124:127], v[192:195], v[68:71]
    v_mov_b32 v41, v40
    v_mfma_f32_16x16x32_bf16 v[96:99], v[124:127], v[196:199], v[96:99]
    ds_read_b128 v[124:127], v4 offset:4096
    s_waitcnt lgkmcnt(13)
    v_mfma_f32_16x16x32_bf16 v[72:75], v[128:131], v[192:195], v[72:75]
    v_mov_b32 v43, v42
    v_mfma_f32_16x16x32_bf16 v[100:103], v[128:131], v[196:199], v[100:103]
    ds_read_b128 v[128:131], v4 offset:5120
    s_waitcnt vmcnt(10) lgkmcnt(13)
    v_mfma_f32_16x16x32_bf16 v[48:51], v[132:135], v[200:203], v[48:51]
    v_mov_b32 v35, v34
    v_mfma_f32_16x16x32_bf16 v[76:79], v[132:135], v[204:207], v[76:79]
    ds_read_b128 v[132:135], v4 offset:6144
    s_waitcnt lgkmcnt(13)
    v_mfma_f32_16x16x32_bf16 v[52:55], v[136:139], v[200:203], v[52:55]
    buffer_load_dwordx4 v[184:187], v1, s[4:7], s26 offen offset:3072 sc1
    s_add_u32 s26, s26, 4096
    v_mfma_f32_16x16x32_bf16 v[80:83], v[136:139], v[204:207], v[80:83]
    ds_read_b128 v[136:139], v4 offset:7168
    s_waitcnt lgkmcnt(13)
    v_mfma_f32_16x16x32_bf16 v[56:59], v[140:143], v[200:203], v[56:59]
    v_mov_b32 v33, v32
    v_mfma_f32_16x16x32_bf16 v[84:87], v[140:143], v[204:207], v[84:87]
    ds_read_b128 v[140:143], v4 offset:8192
    s_waitcnt lgkmcnt(13)
    v_mfma_f32_16x16x32_bf16 v[60:63], v[144:147], v[200:203], v[60:63]
    v_pk_add_f32 v[36:37], v[36:37], v[38:39]
    v_mfma_f32_16x16x32_bf16 v[88:91], v[144:147], v[204:207], v[88:91]
    ds_read_b128 v[144:147], v4 offset:9216
    s_waitcnt lgkmcnt(13)
    v_mfma_f32_16x16x32_bf16 v[64:67], v[148:151], v[200:203], v[64:67]
    buffer_load_dwordx4 v[188:191], v1, s[4:7], s27 offen offset:3072 sc1
    s_add_u32 s27, s27, 4096
    v_mfma_f32_16x16x32_bf16 v[92:95], v[148:151], v[204:207], v[92:95]
    ds_read_b128 v[148:151], v4 offset:10240
    s_waitcnt lgkmcnt(13)
    v_mfma_f32_16x16x32_bf16 v[68:71], v[152:155], v[200:203], v[68:71]
    v_permlane32_swap_b32 v36, v37
    v_mfma_f32_16x16x32_bf16 v[96:99], v[152:155], v[204:207], v[96:99]
    ds_read_b128 v[152:155], v4 offset:11264
    s_waitcnt lgkmcnt(13)
    v_mfma_f32_16x16x32_bf16 v[72:75], v[156:159], v[200:203], v[72:75]
    v_add_f32 v36, v36, v37
    v_mfma_f32_16x16x32_bf16 v[100:103], v[156:159], v[204:207], v[100:103]
    ds_read_b128 v[156:159], v4 offset:12288
    s_waitcnt vmcnt(10) lgkmcnt(13)
    v_mfma_f32_16x16x32_bf16 v[48:51], v[104:107], v[208:211], v[48:51]
    v_mov_b32 v37, v36
    v_mfma_f32_16x16x32_bf16 v[76:79], v[104:107], v[212:215], v[76:79]
    ds_read_b128 v[104:107], v4 offset:13312
    s_waitcnt lgkmcnt(13)
    v_mfma_f32_16x16x32_bf16 v[52:55], v[108:111], v[208:211], v[52:55]
    buffer_load_dwordx4 v[192:195], v1, s[4:7], s26 offen sc1
    v_permlane16_swap_b32 v36, v37
    v_mfma_f32_16x16x32_bf16 v[80:83], v[108:111], v[212:215], v[80:83]
    ds_read_b128 v[108:111], v4 offset:14336
    s_waitcnt lgkmcnt(13)
    v_mfma_f32_16x16x32_bf16 v[56:59], v[112:115], v[208:211], v[56:59]
    v_add_f32 v36, v36, v37
    v_mfma_f32_16x16x32_bf16 v[84:87], v[112:115], v[212:215], v[84:87]
    ds_read_b128 v[112:115], v4 offset:15360
    s_waitcnt lgkmcnt(13)
    v_mfma_f32_16x16x32_bf16 v[60:63], v[116:119], v[208:211], v[60:63]
    v_mov_b32 v37, v36
    v_mfma_f32_16x16x32_bf16 v[88:91], v[116:119], v[212:215], v[88:91]
    ds_read_b128 v[116:119], v4 offset:16384
    s_waitcnt lgkmcnt(13)
    v_mfma_f32_16x16x32_bf16 v[64:67], v[120:123], v[208:211], v[64:67]
    buffer_load_dwordx4 v[196:199], v1, s[4:7], s27 offen sc1
    v_permlane32_swap_b32 v36, v37
    v_mfma_f32_16x16x32_bf16 v[92:95], v[120:123], v[212:215], v[92:95]
    ds_read_b128 v[120:123], v4 offset:17408
    s_waitcnt lgkmcnt(13)
    v_mfma_f32_16x16x32_bf16 v[68:71], v[124:127], v[208:211], v[68:71]
    v_mul_f32 v36, 0x3b000000, v36
    v_mfma_f32_16x16x32_bf16 v[96:99], v[124:127], v[212:215], v[96:99]
    ds_read_b128 v[124:127], v4 offset:18432
    s_waitcnt lgkmcnt(13)
    v_mfma_f32_16x16x32_bf16 v[72:75], v[128:131], v[208:211], v[72:75]
    v_mul_f32 v37, 0x3b000000, v37
    v_mfma_f32_16x16x32_bf16 v[100:103], v[128:131], v[212:215], v[100:103]
    ds_read_b128 v[128:131], v4 offset:19456
    s_waitcnt vmcnt(10) lgkmcnt(13)
    v_mfma_f32_16x16x32_bf16 v[48:51], v[132:135], v[216:219], v[48:51]
    v_fma_f32 v37, -v36, v36, v37
    v_mfma_f32_16x16x32_bf16 v[76:79], v[132:135], v[220:223], v[76:79]
    ds_read_b128 v[132:135], v4 offset:20480
    s_waitcnt lgkmcnt(13)
    v_mfma_f32_16x16x32_bf16 v[52:55], v[136:139], v[216:219], v[52:55]
    buffer_load_dwordx4 v[200:203], v1, s[4:7], s26 offen offset:1024 sc1
    v_max_f32 v37, 0, v37
    v_mfma_f32_16x16x32_bf16 v[80:83], v[136:139], v[220:223], v[80:83]
    ds_read_b128 v[136:139], v4 offset:21504
    s_waitcnt lgkmcnt(13)
    v_mfma_f32_16x16x32_bf16 v[56:59], v[140:143], v[216:219], v[56:59]
    v_add_f32 v38, 0x3727c5ac, v37
    v_mfma_f32_16x16x32_bf16 v[84:87], v[140:143], v[220:223], v[84:87]
    ds_read_b128 v[140:143], v4 offset:22528
    s_waitcnt lgkmcnt(13)
    v_mfma_f32_16x16x32_bf16 v[60:63], v[144:147], v[216:219], v[60:63]
    v_rsq_f32 v38, v38
    v_mfma_f32_16x16x32_bf16 v[88:91], v[144:147], v[220:223], v[88:91]
    ds_read_b128 v[144:147], v4 offset:23552
    s_waitcnt lgkmcnt(13)
    v_mfma_f32_16x16x32_bf16 v[64:67], v[148:151], v[216:219], v[64:67]
    buffer_load_dwordx4 v[204:207], v1, s[4:7], s27 offen offset:1024 sc1
    v_mul_f32 v46, v38, v38
    v_mfma_f32_16x16x32_bf16 v[92:95], v[148:151], v[220:223], v[92:95]
    ds_read_b128 v[148:151], v4 offset:24576
    s_waitcnt lgkmcnt(13)
    v_mfma_f32_16x16x32_bf16 v[68:71], v[152:155], v[216:219], v[68:71]
    v_mul_f32 v44, 0xc0135761, v38
    v_mfma_f32_16x16x32_bf16 v[96:99], v[152:155], v[220:223], v[96:99]
    ds_read_b128 v[152:155], v4 offset:25600
    s_waitcnt lgkmcnt(13)
    v_mfma_f32_16x16x32_bf16 v[72:75], v[156:159], v[216:219], v[72:75]
    v_mul_f32 v46, v46, v38
    v_mfma_f32_16x16x32_bf16 v[100:103], v[156:159], v[220:223], v[100:103]
    ds_read_b128 v[156:159], v4 offset:26624
    s_waitcnt vmcnt(10) lgkmcnt(13)
    v_mfma_f32_16x16x32_bf16 v[48:51], v[104:107], v[160:163], v[48:51]
    v_rcp_f32 v38, v38
    v_mfma_f32_16x16x32_bf16 v[76:79], v[104:107], v[164:167], v[76:79]
    ds_read_b128 v[104:107], v4 offset:27648
    s_waitcnt lgkmcnt(13)
    v_mfma_f32_16x16x32_bf16 v[52:55], v[108:111], v[160:163], v[52:55]
    buffer_load_dwordx4 v[208:211], v1, s[4:7], s26 offen offset:2048 sc1
    v_mul_f32 v46, 0xbdd2d3e8, v46
    v_mfma_f32_16x16x32_bf16 v[80:83], v[108:111], v[164:167], v[80:83]
    ds_read_b128 v[108:111], v4 offset:28672
    s_waitcnt lgkmcnt(13)
    v_mfma_f32_16x16x32_bf16 v[56:59], v[112:115], v[160:163], v[56:59]
    v_mov_b32 v45, v44
    v_mfma_f32_16x16x32_bf16 v[84:87], v[112:115], v[164:167], v[84:87]
    ds_read_b128 v[112:115], v4 offset:29696
    s_waitcnt lgkmcnt(13)
    v_mfma_f32_16x16x32_bf16 v[60:63], v[116:119], v[160:163], v[60:63]
    v_mov_b32 v47, v46
    v_mfma_f32_16x16x32_bf16 v[88:91], v[116:119], v[164:167], v[88:91]
    ds_read_b128 v[116:119], v4 offset:30720
    s_waitcnt lgkmcnt(13)
    v_mfma_f32_16x16x32_bf16 v[64:67], v[120:123], v[160:163], v[64:67]
    buffer_load_dwordx4 v[212:215], v1, s[4:7], s27 offen offset:2048 sc1
    v_mov_b32 v39, v38
    v_mfma_f32_16x16x32_bf16 v[92:95], v[120:123], v[164:167], v[92:95]
    ds_read_b128 v[120:123], v4 offset:31744
    s_waitcnt lgkmcnt(13)
    v_mfma_f32_16x16x32_bf16 v[68:71], v[124:127], v[160:163], v[68:71]
    v_mov_b32 v37, v36
    v_mfma_f32_16x16x32_bf16 v[96:99], v[124:127], v[164:167], v[96:99]
    ds_read_b128 v[124:127], v4 offset:32768
    s_waitcnt lgkmcnt(13)
    v_mfma_f32_16x16x32_bf16 v[72:75], v[128:131], v[160:163], v[72:75]
    v_mfma_f32_16x16x32_bf16 v[100:103], v[128:131], v[164:167], v[100:103]
    ds_read_b128 v[128:131], v4 offset:33792
    s_waitcnt vmcnt(10) lgkmcnt(13)
    v_mfma_f32_16x16x32_bf16 v[48:51], v[132:135], v[168:171], v[48:51]
    v_mfma_f32_16x16x32_bf16 v[76:79], v[132:135], v[172:175], v[76:79]
    ds_read_b128 v[132:135], v4 offset:34816
    s_waitcnt lgkmcnt(13)
    v_mfma_f32_16x16x32_bf16 v[52:55], v[136:139], v[168:171], v[52:55]
    buffer_load_dwordx4 v[216:219], v1, s[4:7], s26 offen offset:3072 sc1
    v_mfma_f32_16x16x32_bf16 v[80:83], v[136:139], v[172:175], v[80:83]
    ds_read_b128 v[136:139], v4 offset:35840
    s_waitcnt lgkmcnt(13)
    v_mfma_f32_16x16x32_bf16 v[56:59], v[140:143], v[168:171], v[56:59]
    v_mfma_f32_16x16x32_bf16 v[84:87], v[140:143], v[172:175], v[84:87]
    ds_read_b128 v[140:143], v4 offset:36864
    s_waitcnt lgkmcnt(13)
    v_mfma_f32_16x16x32_bf16 v[60:63], v[144:147], v[168:171], v[60:63]
    v_mfma_f32_16x16x32_bf16 v[88:91], v[144:147], v[172:175], v[88:91]
    ds_read_b128 v[144:147], v4 offset:37888
    s_waitcnt lgkmcnt(13)
    v_mfma_f32_16x16x32_bf16 v[64:67], v[148:151], v[168:171], v[64:67]
    buffer_load_dwordx4 v[220:223], v1, s[4:7], s27 offen offset:3072 sc1
    s_add_u32 s51, s50, 8
    v_mov_b32 v3, s51
    ds_write_b32 v14, v3 offset:0
    v_mfma_f32_16x16x32_bf16 v[92:95], v[148:151], v[172:175], v[92:95]
    ds_read_b128 v[148:151], v4 offset:38912
    s_waitcnt lgkmcnt(14)
    v_mfma_f32_16x16x32_bf16 v[68:71], v[152:155], v[168:171], v[68:71]
    v_mfma_f32_16x16x32_bf16 v[96:99], v[152:155], v[172:175], v[96:99]
    ds_read_b128 v[152:155], v4 offset:39936
    s_waitcnt lgkmcnt(14)
    v_mfma_f32_16x16x32_bf16 v[72:75], v[156:159], v[168:171], v[72:75]
    v_mfma_f32_16x16x32_bf16 v[100:103], v[156:159], v[172:175], v[100:103]
    ds_read_b128 v[156:159], v4 offset:40960
    s_waitcnt vmcnt(10) lgkmcnt(14)
    v_mfma_f32_16x16x32_bf16 v[48:51], v[104:107], v[176:179], v[48:51]
    v_mfma_f32_16x16x32_bf16 v[76:79], v[104:107], v[180:183], v[76:79]
    ds_read_b128 v[252:255], v15 offset:16
    s_waitcnt lgkmcnt(8)
    ds_read_b128 v[104:107], v4 offset:41984
    v_mfma_f32_16x16x32_bf16 v[52:55], v[108:111], v[176:179], v[52:55]
    v_mfma_f32_16x16x32_bf16 v[80:83], v[108:111], v[180:183], v[80:83]
    ds_read_b128 v[108:111], v4 offset:43008
    v_mfma_f32_16x16x32_bf16 v[56:59], v[112:115], v[176:179], v[56:59]
    v_mfma_f32_16x16x32_bf16 v[84:87], v[112:115], v[180:183], v[84:87]
    ds_read_b128 v[112:115], v4 offset:44032
    v_mfma_f32_16x16x32_bf16 v[60:63], v[116:119], v[176:179], v[60:63]
    v_mfma_f32_16x16x32_bf16 v[88:91], v[116:119], v[180:183], v[88:91]
    ds_read_b128 v[116:119], v4 offset:45056
    v_mfma_f32_16x16x32_bf16 v[64:67], v[120:123], v[176:179], v[64:67]
    v_mfma_f32_16x16x32_bf16 v[92:95], v[120:123], v[180:183], v[92:95]
    ds_read_b128 v[120:123], v4 offset:46080
    v_mfma_f32_16x16x32_bf16 v[68:71], v[124:127], v[176:179], v[68:71]
    v_mfma_f32_16x16x32_bf16 v[96:99], v[124:127], v[180:183], v[96:99]
    ds_read_b128 v[124:127], v4 offset:47104
    v_mfma_f32_16x16x32_bf16 v[72:75], v[128:131], v[176:179], v[72:75]
    v_mfma_f32_16x16x32_bf16 v[100:103], v[128:131], v[180:183], v[100:103]
    ds_read_b128 v[128:131], v4 offset:48128
    s_waitcnt vmcnt(8)
    v_mfma_f32_16x16x32_bf16 v[48:51], v[132:135], v[184:187], v[48:51]
    v_mfma_f32_16x16x32_bf16 v[76:79], v[132:135], v[188:191], v[76:79]
    s_add_u32 s51, s50, 7
    s_waitcnt lgkmcnt(7)
    v_min_u32 v252, v252, v253
    v_min3_u32 v252, v252, v254, v255
    v_cmp_le_u32 vcc, s51, v252
    s_cbranch_vccnz .Llt_183
    s_add_u32 s51, s50, 7
.Llw_184:
    ds_read_b128 v[252:255], v15 offset:16
    s_waitcnt lgkmcnt(0)
    v_min_u32 v252, v252, v253
    v_min3_u32 v252, v252, v254, v255
    v_cmp_le_u32 vcc, s51, v252
    s_cbranch_vccnz .Llwd_185
    s_sub_u32 s23, s23, 1
    s_cbranch_scc1 .Lexit_1
    s_branch .Llw_184
.Llwd_185:
.Llt_183:
    ds_read_b128 v[132:135], v1 offset:0
    v_mfma_f32_16x16x32_bf16 v[52:55], v[136:139], v[184:187], v[52:55]
    v_mfma_f32_16x16x32_bf16 v[80:83], v[136:139], v[188:191], v[80:83]
    ds_read_b128 v[136:139], v1 offset:1024
    v_mfma_f32_16x16x32_bf16 v[56:59], v[140:143], v[184:187], v[56:59]
    v_mfma_f32_16x16x32_bf16 v[84:87], v[140:143], v[188:191], v[84:87]
    ds_read_b128 v[140:143], v1 offset:2048
    v_mfma_f32_16x16x32_bf16 v[60:63], v[144:147], v[184:187], v[60:63]
    v_mfma_f32_16x16x32_bf16 v[88:91], v[144:147], v[188:191], v[88:91]
    ds_read_b128 v[144:147], v1 offset:3072
    v_mfma_f32_16x16x32_bf16 v[64:67], v[148:151], v[184:187], v[64:67]
    v_mfma_f32_16x16x32_bf16 v[92:95], v[148:151], v[188:191], v[92:95]
    ds_read_b128 v[148:151], v1 offset:4096
    v_mfma_f32_16x16x32_bf16 v[68:71], v[152:155], v[184:187], v[68:71]
    v_mfma_f32_16x16x32_bf16 v[96:99], v[152:155], v[188:191], v[96:99]
    ds_read_b128 v[152:155], v1 offset:5120
    v_mfma_f32_16x16x32_bf16 v[72:75], v[156:159], v[184:187], v[72:75]
    v_mfma_f32_16x16x32_bf16 v[100:103], v[156:159], v[188:191], v[100:103]
    ds_read_b128 v[156:159], v1 offset:6144
    s_waitcnt vmcnt(6) lgkmcnt(13)
    v_mfma_f32_16x16x32_bf16 v[48:51], v[104:107], v[192:195], v[48:51]
    v_mfma_f32_16x16x32_bf16 v[76:79], v[104:107], v[196:199], v[76:79]
    ds_read_b128 v[104:107], v1 offset:7168
    s_waitcnt lgkmcnt(13)
    v_mfma_f32_16x16x32_bf16 v[52:55], v[108:111], v[192:195], v[52:55]
    v_mfma_f32_16x16x32_bf16 v[80:83], v[108:111], v[196:199], v[80:83]
    ds_read_b128 v[108:111], v1 offset:8192
    s_waitcnt lgkmcnt(13)
    v_mfma_f32_16x16x32_bf16 v[56:59], v[112:115], v[192:195], v[56:59]
    v_mfma_f32_16x16x32_bf16 v[84:87], v[112:115], v[196:199], v[84:87]
    ds_read_b128 v[112:115], v1 offset:9216
    s_waitcnt lgkmcnt(13)
    v_mfma_f32_16x16x32_bf16 v[60:63], v[116:119], v[192:195], v[60:63]
    v_mfma_f32_16x16x32_bf16 v[88:91], v[116:119], v[196:199], v[88:91]
    ds_read_b128 v[116:119], v1 offset:10240
    s_waitcnt lgkmcnt(13)
    v_mfma_f32_16x16x32_bf16 v[64:67], v[120:123], v[192:195], v[64:67]
    v_mfma_f32_16x16x32_bf16 v[92:95], v[120:123], v[196:199], v[92:95]
    ds_read_b128 v[120:123], v1 offset:11264
    s_waitcnt lgkmcnt(13)
    v_mfma_f32_16x16x32_bf16 v[68:71], v[124:127], v[192:195], v[68:71]
    v_mfma_f32_16x16x32_bf16 v[96:99], v[124:127], v[196:199], v[96:99]
    ds_read_b128 v[124:127], v1 offset:12288
    s_waitcnt lgkmcnt(13)
    v_mfma_f32_16x16x32_bf16 v[72:75], v[128:131], v[192:195], v[72:75]
    v_mfma_f32_16x16x32_bf16 v[100:103], v[128:131], v[196:199], v[100:103]
    ds_read_b128 v[128:131], v1 offset:13312
    s_waitcnt vmcnt(4) lgkmcnt(13)
    v_mfma_f32_16x16x32_bf16 v[48:51], v[132:135], v[200:203], v[48:51]
    v_mfma_f32_16x16x32_bf16 v[76:79], v[132:135], v[204:207], v[76:79]
    ds_read_b128 v[132:135], v1 offset:14336
    s_waitcnt lgkmcnt(13)
    v_mfma_f32_16x16x32_bf16 v[52:55], v[136:139], v[200:203], v[52:55]
    v_mfma_f32_16x16x32_bf16 v[80:83], v[136:139], v[204:207], v[80:83]
    ds_read_b128 v[136:139], v1 offset:15360
    s_waitcnt lgkmcnt(13)
    v_mfma_f32_16x16x32_bf16 v[56:59], v[140:143], v[200:203], v[56:59]
    v_mfma_f32_16x16x32_bf16 v[84:87], v[140:143], v[204:207], v[84:87]
    ds_read_b128 v[140:143], v1 offset:16384
    s_waitcnt lgkmcnt(13)
    v_mfma_f32_16x16x32_bf16 v[60:63], v[144:147], v[200:203], v[60:63]
    v_mfma_f32_16x16x32_bf16 v[88:91], v[144:147], v[204:207], v[88:91]
    ds_read_b128 v[144:147], v1 offset:17408
    s_waitcnt lgkmcnt(13)
    v_mfma_f32_16x16x32_bf16 v[64:67], v[148:151], v[200:203], v[64:67]
    v_mfma_f32_16x16x32_bf16 v[92:95], v[148:151], v[204:207], v[92:95]
    ds_read_b128 v[148:151], v1 offset:18432
    s_waitcnt lgkmcnt(13)
    v_mfma_f32_16x16x32_bf16 v[68:71], v[152:155], v[200:203], v[68:71]
    v_mfma_f32_16x16x32_bf16 v[96:99], v[152:155], v[204:207], v[96:99]
    ds_read_b128 v[152:155], v1 offset:19456
    s_waitcnt lgkmcnt(13)
    v_mfma_f32_16x16x32_bf16 v[72:75], v[156:159], v[200:203], v[72:75]
    v_mfma_f32_16x16x32_bf16 v[100:103], v[156:159], v[204:207], v[100:103]
    ds_read_b128 v[156:159], v1 offset:20480
    s_waitcnt vmcnt(2) lgkmcnt(13)
    v_mfma_f32_16x16x32_bf16 v[48:51], v[104:107], v[208:211], v[48:51]
    v_mfma_f32_16x16x32_bf16 v[76:79], v[104:107], v[212:215], v[76:79]
    s_waitcnt lgkmcnt(12)
    v_mfma_f32_16x16x32_bf16 v[52:55], v[108:111], v[208:211], v[52:55]
    v_mfma_f32_16x16x32_bf16 v[80:83], v[108:111], v[212:215], v[80:83]
    s_waitcnt lgkmcnt(11)
    v_mfma_f32_16x16x32_bf16 v[56:59], v[112:115], v[208:211], v[56:59]
    v_mfma_f32_16x16x32_bf16 v[84:87], v[112:115], v[212:215], v[84:87]
    s_waitcnt lgkmcnt(10)
    v_mfma_f32_16x16x32_bf16 v[60:63], v[116:119], v[208:211], v[60:63]
    v_mfma_f32_16x16x32_bf16 v[88:91], v[116:119], v[212:215], v[88:91]
    s_waitcnt lgkmcnt(9)
    v_mfma_f32_16x16x32_bf16 v[64:67], v[120:123], v[208:211], v[64:67]
    v_mfma_f32_16x16x32_bf16 v[92:95], v[120:123], v[212:215], v[92:95]
    s_waitcnt lgkmcnt(8)
    v_mfma_f32_16x16x32_bf16 v[68:71], v[124:127], v[208:211], v[68:71]
    v_mfma_f32_16x16x32_bf16 v[96:99], v[124:127], v[212:215], v[96:99]
    s_waitcnt lgkmcnt(7)
    v_mfma_f32_16x16x32_bf16 v[72:75], v[128:131], v[208:211], v[72:75]
    v_mfma_f32_16x16x32_bf16 v[100:103], v[128:131], v[212:215], v[100:103]
    s_waitcnt vmcnt(0) lgkmcnt(6)
    v_mfma_f32_16x16x32_bf16 v[48:51], v[132:135], v[216:219], v[48:51]
    v_mfma_f32_16x16x32_bf16 v[76:79], v[132:135], v[220:223], v[76:79]
    s_waitcnt lgkmcnt(5)
    v_mfma_f32_16x16x32_bf16 v[52:55], v[136:139], v[216:219], v[52:55]
    v_mfma_f32_16x16x32_bf16 v[80:83], v[136:139], v[220:223], v[80:83]
    s_waitcnt lgkmcnt(4)
    v_mfma_f32_16x16x32_bf16 v[56:59], v[140:143], v[216:219], v[56:59]
    v_mfma_f32_16x16x32_bf16 v[84:87], v[140:143], v[220:223], v[84:87]
    s_waitcnt lgkmcnt(3)
    v_mfma_f32_16x16x32_bf16 v[60:63], v[144:147], v[216:219], v[60:63]
    v_mfma_f32_16x16x32_bf16 v[88:91], v[144:147], v[220:223], v[88:91]
    s_waitcnt lgkmcnt(2)
    v_mfma_f32_16x16x32_bf16 v[64:67], v[148:151], v[216:219], v[64:67]
    v_mfma_f32_16x16x32_bf16 v[92:95], v[148:151], v[220:223], v[92:95]
    s_waitcnt lgkmcnt(1)
    v_mfma_f32_16x16x32_bf16 v[68:71], v[152:155], v[216:219], v[68:71]
    v_mfma_f32_16x16x32_bf16 v[96:99], v[152:155], v[220:223], v[96:99]
    s_waitcnt lgkmcnt(0)
    v_mfma_f32_16x16x32_bf16 v[72:75], v[156:159], v[216:219], v[72:75]
    v_mfma_f32_16x16x32_bf16 v[100:103], v[156:159], v[220:223], v[100:103]
    s_add_u32 s51, s50, 9
    v_mov_b32 v3, s51
    ds_write_b32 v14, v3 offset:0
    v_pk_fma_f32 v[48:49], v[224:225], v[32:33], v[48:49] neg_lo:[0,1,0] neg_hi:[0,1,0]
    v_pk_fma_f32 v[50:51], v[226:227], v[32:33], v[50:51] neg_lo:[0,1,0] neg_hi:[0,1,0]
    v_pk_fma_f32 v[52:53], v[228:229], v[32:33], v[52:53] neg_lo:[0,1,0] neg_hi:[0,1,0]
    v_pk_fma_f32 v[54:55], v[230:231], v[32:33], v[54:55] neg_lo:[0,1,0] neg_hi:[0,1,0]
    v_pk_fma_f32 v[56:57], v[232:233], v[32:33], v[56:57] neg_lo:[0,1,0] neg_hi:[0,1,0]
    v_pk_fma_f32 v[58:59], v[234:235], v[32:33], v[58:59] neg_lo:[0,1,0] neg_hi:[0,1,0]
    v_pk_fma_f32 v[60:61], v[236:237], v[32:33], v[60:61] neg_lo:[0,1,0] neg_hi:[0,1,0]
    v_pk_fma_f32 v[62:63], v[238:239], v[32:33], v[62:63] neg_lo:[0,1,0] neg_hi:[0,1,0]
    v_pk_fma_f32 v[64:65], v[240:241], v[32:33], v[64:65] neg_lo:[0,1,0] neg_hi:[0,1,0]
    v_pk_fma_f32 v[66:67], v[242:243], v[32:33], v[66:67] neg_lo:[0,1,0] neg_hi:[0,1,0]
    v_pk_fma_f32 v[68:69], v[244:245], v[32:33], v[68:69] neg_lo:[0,1,0] neg_hi:[0,1,0]
    v_pk_fma_f32 v[70:71], v[246:247], v[32:33], v[70:71] neg_lo:[0,1,0] neg_hi:[0,1,0]
    v_pk_fma_f32 v[72:73], v[248:249], v[32:33], v[72:73] neg_lo:[0,1,0] neg_hi:[0,1,0]
    v_pk_fma_f32 v[74:75], v[250:251], v[32:33], v[74:75] neg_lo:[0,1,0] neg_hi:[0,1,0]
    v_pk_mul_f32 v[104:105], v[48:49], v[48:49]
    v_pk_mul_f32 v[106:107], v[50:51], v[50:51]
    v_pk_mul_f32 v[108:109], v[52:53], v[52:53]
    v_pk_mul_f32 v[110:111], v[54:55], v[54:55]
    v_pk_mul_f32 v[112:113], v[56:57], v[56:57]
    v_pk_mul_f32 v[114:115], v[58:59], v[58:59]
    v_pk_mul_f32 v[116:117], v[60:61], v[60:61]
    v_pk_mul_f32 v[118:119], v[62:63], v[62:63]
    v_pk_mul_f32 v[120:121], v[64:65], v[64:65]
    v_pk_mul_f32 v[122:123], v[66:67], v[66:67]
    v_pk_mul_f32 v[124:125], v[68:69], v[68:69]
    v_pk_mul_f32 v[126:127], v[70:71], v[70:71]
    v_pk_mul_f32 v[128:129], v[72:73], v[72:73]
    v_pk_mul_f32 v[130:131], v[74:75], v[74:75]
    v_pk_fma_f32 v[104:105], v[104:105], v[42:43], v[40:41]
    v_pk_fma_f32 v[106:107], v[106:107], v[42:43], v[40:41]
    v_pk_fma_f32 v[108:109], v[108:109], v[42:43], v[40:41]
    v_pk_fma_f32 v[110:111], v[110:111], v[42:43], v[40:41]
    v_pk_fma_f32 v[112:113], v[112:113], v[42:43], v[40:41]
    v_pk_fma_f32 v[114:115], v[114:115], v[42:43], v[40:41]
    v_pk_fma_f32 v[116:117], v[116:117], v[42:43], v[40:41]
    v_pk_fma_f32 v[118:119], v[118:119], v[42:43], v[40:41]
    v_pk_fma_f32 v[120:121], v[120:121], v[42:43], v[40:41]
    v_pk_fma_f32 v[122:123], v[122:123], v[42:43], v[40:41]
    v_pk_fma_f32 v[124:125], v[124:125], v[42:43], v[40:41]
    v_pk_fma_f32 v[126:127], v[126:127], v[42:43], v[40:41]
    v_pk_fma_f32 v[128:129], v[128:129], v[42:43], v[40:41]
    v_pk_fma_f32 v[130:131], v[130:131], v[42:43], v[40:41]
    v_pk_mul_f32 v[104:105], v[104:105], v[48:49]
    v_pk_mul_f32 v[106:107], v[106:107], v[50:51]
    v_pk_mul_f32 v[108:109], v[108:109], v[52:53]
    v_pk_mul_f32 v[110:111], v[110:111], v[54:55]
    v_pk_mul_f32 v[112:113], v[112:113], v[56:57]
    v_pk_mul_f32 v[114:115], v[114:115], v[58:59]
    v_pk_mul_f32 v[116:117], v[116:117], v[60:61]
    v_pk_mul_f32 v[118:119], v[118:119], v[62:63]
    v_pk_mul_f32 v[120:121], v[120:121], v[64:65]
    v_pk_mul_f32 v[122:123], v[122:123], v[66:67]
    v_pk_mul_f32 v[124:125], v[124:125], v[68:69]
    v_pk_mul_f32 v[126:127], v[126:127], v[70:71]
    v_pk_mul_f32 v[128:129], v[128:129], v[72:73]
    v_pk_mul_f32 v[130:131], v[130:131], v[74:75]
    v_exp_f32 v104, v104
    v_exp_f32 v105, v105
    v_exp_f32 v106, v106
    v_exp_f32 v107, v107
    v_exp_f32 v108, v108
    v_exp_f32 v109, v109
    v_exp_f32 v110, v110
    v_exp_f32 v111, v111
    v_exp_f32 v112, v112
    v_exp_f32 v113, v113
    v_exp_f32 v114, v114
    v_exp_f32 v115, v115
    v_exp_f32 v116, v116
    v_exp_f32 v117, v117
    v_exp_f32 v118, v118
    v_exp_f32 v119, v119
    v_exp_f32 v120, v120
    v_exp_f32 v121, v121
    v_exp_f32 v122, v122
    v_exp_f32 v123, v123
    v_exp_f32 v124, v124
    v_exp_f32 v125, v125
    v_exp_f32 v126, v126
    v_exp_f32 v127, v127
    v_exp_f32 v128, v128
    v_exp_f32 v129, v129
    v_exp_f32 v130, v130
    v_exp_f32 v131, v131
    v_pk_fma_f32 v[104:105], v[104:105], v[34:35], v[34:35]
    v_pk_fma_f32 v[106:107], v[106:107], v[34:35], v[34:35]
    v_pk_fma_f32 v[108:109], v[108:109], v[34:35], v[34:35]
    v_pk_fma_f32 v[110:111], v[110:111], v[34:35], v[34:35]
    v_pk_fma_f32 v[112:113], v[112:113], v[34:35], v[34:35]
    v_pk_fma_f32 v[114:115], v[114:115], v[34:35], v[34:35]
    v_pk_fma_f32 v[116:117], v[116:117], v[34:35], v[34:35]
    v_pk_fma_f32 v[118:119], v[118:119], v[34:35], v[34:35]
    v_pk_fma_f32 v[120:121], v[120:121], v[34:35], v[34:35]
    v_pk_fma_f32 v[122:123], v[122:123], v[34:35], v[34:35]
    v_pk_fma_f32 v[124:125], v[124:125], v[34:35], v[34:35]
    v_pk_fma_f32 v[126:127], v[126:127], v[34:35], v[34:35]
    v_pk_fma_f32 v[128:129], v[128:129], v[34:35], v[34:35]
    v_pk_fma_f32 v[130:131], v[130:131], v[34:35], v[34:35]
    v_rcp_f32 v104, v104
    v_rcp_f32 v105, v105
    v_rcp_f32 v106, v106
    v_rcp_f32 v107, v107
    v_rcp_f32 v108, v108
    v_rcp_f32 v109, v109
    v_rcp_f32 v110, v110
    v_rcp_f32 v111, v111
    v_rcp_f32 v112, v112
    v_rcp_f32 v113, v113
    v_rcp_f32 v114, v114
    v_rcp_f32 v115, v115
    v_rcp_f32 v116, v116
    v_rcp_f32 v117, v117
    v_rcp_f32 v118, v118
    v_rcp_f32 v119, v119
    v_rcp_f32 v120, v120
    v_rcp_f32 v121, v121
    v_rcp_f32 v122, v122
    v_rcp_f32 v123, v123
    v_rcp_f32 v124, v124
    v_rcp_f32 v125, v125
    v_rcp_f32 v126, v126
    v_rcp_f32 v127, v127
    v_rcp_f32 v128, v128
    v_rcp_f32 v129, v129
    v_rcp_f32 v130, v130
    v_rcp_f32 v131, v131
    v_pk_mul_f32 v[104:105], v[104:105], v[48:49]
    v_pk_mul_f32 v[106:107], v[106:107], v[50:51]
    v_pk_mul_f32 v[108:109], v[108:109], v[52:53]
    v_pk_mul_f32 v[110:111], v[110:111], v[54:55]
    v_pk_mul_f32 v[112:113], v[112:113], v[56:57]
    v_pk_mul_f32 v[114:115], v[114:115], v[58:59]
    v_pk_mul_f32 v[116:117], v[116:117], v[60:61]
    v_pk_mul_f32 v[118:119], v[118:119], v[62:63]
    v_pk_mul_f32 v[120:121], v[120:121], v[64:65]
    v_pk_mul_f32 v[122:123], v[122:123], v[66:67]
    v_pk_mul_f32 v[124:125], v[124:125], v[68:69]
    v_pk_mul_f32 v[126:127], v[126:127], v[70:71]
    v_pk_mul_f32 v[128:129], v[128:129], v[72:73]
    v_pk_mul_f32 v[130:131], v[130:131], v[74:75]
    v_cvt_pk_bf16_f32 v160, v104, v105
    v_cvt_pk_bf16_f32 v161, v106, v107
    v_cvt_pk_bf16_f32 v162, v108, v109
    v_cvt_pk_bf16_f32 v163, v110, v111
    v_cvt_pk_bf16_f32 v164, v112, v113
    v_cvt_pk_bf16_f32 v165, v114, v115
    v_cvt_pk_bf16_f32 v166, v116, v117
    v_cvt_pk_bf16_f32 v167, v118, v119
    v_cvt_pk_bf16_f32 v168, v120, v121
    v_cvt_pk_bf16_f32 v169, v122, v123
    v_cvt_pk_bf16_f32 v170, v124, v125
    v_cvt_pk_bf16_f32 v171, v126, v127
    v_cvt_pk_bf16_f32 v184, v128, v129
    v_cvt_pk_bf16_f32 v185, v130, v131
    s_cmp_eq_u32 s49, 0
    s_cbranch_scc1 .Lsts_186
    buffer_store_dwordx4 v[160:163], v1, s[4:7], s30 offen
    buffer_store_dwordx4 v[164:167], v1, s[4:7], s30 offen offset:1024
    buffer_store_dwordx4 v[168:171], v1, s[4:7], s30 offen offset:2048
    s_branch .Lstd_187
.Lsts_186:
    buffer_store_dwordx4 v[160:163], v1, s[4:7], s30 offen sc1
    buffer_store_dwordx4 v[164:167], v1, s[4:7], s30 offen offset:1024 sc1
    buffer_store_dwordx4 v[168:171], v1, s[4:7], s30 offen offset:2048 sc1
.Lstd_187:
    v_pk_fma_f32 v[76:77], v[224:225], v[36:37], v[76:77] neg_lo:[0,1,0] neg_hi:[0,1,0]
    v_pk_fma_f32 v[78:79], v[226:227], v[36:37], v[78:79] neg_lo:[0,1,0] neg_hi:[0,1,0]
    v_pk_fma_f32 v[80:81], v[228:229], v[36:37], v[80:81] neg_lo:[0,1,0] neg_hi:[0,1,0]
    v_pk_fma_f32 v[82:83], v[230:231], v[36:37], v[82:83] neg_lo:[0,1,0] neg_hi:[0,1,0]
    v_pk_fma_f32 v[84:85], v[232:233], v[36:37], v[84:85] neg_lo:[0,1,0] neg_hi:[0,1,0]
    v_pk_fma_f32 v[86:87], v[234:235], v[36:37], v[86:87] neg_lo:[0,1,0] neg_hi:[0,1,0]
    v_pk_fma_f32 v[88:89], v[236:237], v[36:37], v[88:89] neg_lo:[0,1,0] neg_hi:[0,1,0]
    v_pk_fma_f32 v[90:91], v[238:239], v[36:37], v[90:91] neg_lo:[0,1,0] neg_hi:[0,1,0]
    v_pk_fma_f32 v[92:93], v[240:241], v[36:37], v[92:93] neg_lo:[0,1,0] neg_hi:[0,1,0]
    v_pk_fma_f32 v[94:95], v[242:243], v[36:37], v[94:95] neg_lo:[0,1,0] neg_hi:[0,1,0]
    v_pk_fma_f32 v[96:97], v[244:245], v[36:37], v[96:97] neg_lo:[0,1,0] neg_hi:[0,1,0]
    v_pk_fma_f32 v[98:99], v[246:247], v[36:37], v[98:99] neg_lo:[0,1,0] neg_hi:[0,1,0]
    v_pk_fma_f32 v[100:101], v[248:249], v[36:37], v[100:101] neg_lo:[0,1,0] neg_hi:[0,1,0]
    v_pk_fma_f32 v[102:103], v[250:251], v[36:37], v[102:103] neg_lo:[0,1,0] neg_hi:[0,1,0]
    v_pk_mul_f32 v[104:105], v[76:77], v[76:77]
    v_pk_mul_f32 v[106:107], v[78:79], v[78:79]
    v_pk_mul_f32 v[108:109], v[80:81], v[80:81]
    v_pk_mul_f32 v[110:111], v[82:83], v[82:83]
    v_pk_mul_f32 v[112:113], v[84:85], v[84:85]
    v_pk_mul_f32 v[114:115], v[86:87], v[86:87]
    v_pk_mul_f32 v[116:117], v[88:89], v[88:89]
    v_pk_mul_f32 v[118:119], v[90:91], v[90:91]
    v_pk_mul_f32 v[120:121], v[92:93], v[92:93]
    v_pk_mul_f32 v[122:123], v[94:95], v[94:95]
    v_pk_mul_f32 v[124:125], v[96:97], v[96:97]
    v_pk_mul_f32 v[126:127], v[98:99], v[98:99]
    v_pk_mul_f32 v[128:129], v[100:101], v[100:101]
    v_pk_mul_f32 v[130:131], v[102:103], v[102:103]
    v_pk_fma_f32 v[104:105], v[104:105], v[46:47], v[44:45]
    v_pk_fma_f32 v[106:107], v[106:107], v[46:47], v[44:45]
    v_pk_fma_f32 v[108:109], v[108:109], v[46:47], v[44:45]
    v_pk_fma_f32 v[110:111], v[110:111], v[46:47], v[44:45]
    v_pk_fma_f32 v[112:113], v[112:113], v[46:47], v[44:45]
    v_pk_fma_f32 v[114:115], v[114:115], v[46:47], v[44:45]
    v_pk_fma_f32 v[116:117], v[116:117], v[46:47], v[44:45]
    v_pk_fma_f32 v[118:119], v[118:119], v[46:47], v[44:45]
    v_pk_fma_f32 v[120:121], v[120:121], v[46:47], v[44:45]
    v_pk_fma_f32 v[122:123], v[122:123], v[46:47], v[44:45]
    v_pk_fma_f32 v[124:125], v[124:125], v[46:47], v[44:45]
    v_pk_fma_f32 v[126:127], v[126:127], v[46:47], v[44:45]
    v_pk_fma_f32 v[128:129], v[128:129], v[46:47], v[44:45]
    v_pk_fma_f32 v[130:131], v[130:131], v[46:47], v[44:45]
    v_pk_mul_f32 v[104:105], v[104:105], v[76:77]
    v_pk_mul_f32 v[106:107], v[106:107], v[78:79]
    v_pk_mul_f32 v[108:109], v[108:109], v[80:81]
    v_pk_mul_f32 v[110:111], v[110:111], v[82:83]
    v_pk_mul_f32 v[112:113], v[112:113], v[84:85]
    v_pk_mul_f32 v[114:115], v[114:115], v[86:87]
    v_pk_mul_f32 v[116:117], v[116:117], v[88:89]
    v_pk_mul_f32 v[118:119], v[118:119], v[90:91]
    v_pk_mul_f32 v[120:121], v[120:121], v[92:93]
    v_pk_mul_f32 v[122:123], v[122:123], v[94:95]
    v_pk_mul_f32 v[124:125], v[124:125], v[96:97]
    v_pk_mul_f32 v[126:127], v[126:127], v[98:99]
    v_pk_mul_f32 v[128:129], v[128:129], v[100:101]
    v_pk_mul_f32 v[130:131], v[130:131], v[102:103]
    v_exp_f32 v104, v104
    v_exp_f32 v105, v105
    v_exp_f32 v106, v106
    v_exp_f32 v107, v107
    v_exp_f32 v108, v108
    v_exp_f32 v109, v109
    v_exp_f32 v110, v110
    v_exp_f32 v111, v111
    v_exp_f32 v112, v112
    v_exp_f32 v113, v113
    v_exp_f32 v114, v114
    v_exp_f32 v115, v115
    v_exp_f32 v116, v116
    v_exp_f32 v117, v117
    v_exp_f32 v118, v118
    v_exp_f32 v119, v119
    v_exp_f32 v120, v120
    v_exp_f32 v121, v121
    v_exp_f32 v122, v122
    v_exp_f32 v123, v123
    v_exp_f32 v124, v124
    v_exp_f32 v125, v125
    v_exp_f32 v126, v126
    v_exp_f32 v127, v127
    v_exp_f32 v128, v128
    v_exp_f32 v129, v129
    v_exp_f32 v130, v130
    v_exp_f32 v131, v131
    v_pk_fma_f32 v[104:105], v[104:105], v[38:39], v[38:39]
    v_pk_fma_f32 v[106:107], v[106:107], v[38:39], v[38:39]
    v_pk_fma_f32 v[108:109], v[108:109], v[38:39], v[38:39]
    v_pk_fma_f32 v[110:111], v[110:111], v[38:39], v[38:39]
    v_pk_fma_f32 v[112:113], v[112:113], v[38:39], v[38:39]
    v_pk_fma_f32 v[114:115], v[114:115], v[38:39], v[38:39]
    v_pk_fma_f32 v[116:117], v[116:117], v[38:39], v[38:39]
    v_pk_fma_f32 v[118:119], v[118:119], v[38:39], v[38:39]
    v_pk_fma_f32 v[120:121], v[120:121], v[38:39], v[38:39]
    v_pk_fma_f32 v[122:123], v[122:123], v[38:39], v[38:39]
    v_pk_fma_f32 v[124:125], v[124:125], v[38:39], v[38:39]
    v_pk_fma_f32 v[126:127], v[126:127], v[38:39], v[38:39]
    v_pk_fma_f32 v[128:129], v[128:129], v[38:39], v[38:39]
    v_pk_fma_f32 v[130:131], v[130:131], v[38:39], v[38:39]
    v_rcp_f32 v104, v104
    v_rcp_f32 v105, v105
    v_rcp_f32 v106, v106
    v_rcp_f32 v107, v107
    v_rcp_f32 v108, v108
    v_rcp_f32 v109, v109
    v_rcp_f32 v110, v110
    v_rcp_f32 v111, v111
    v_rcp_f32 v112, v112
    v_rcp_f32 v113, v113
    v_rcp_f32 v114, v114
    v_rcp_f32 v115, v115
    v_rcp_f32 v116, v116
    v_rcp_f32 v117, v117
    v_rcp_f32 v118, v118
    v_rcp_f32 v119, v119
    v_rcp_f32 v120, v120
    v_rcp_f32 v121, v121
    v_rcp_f32 v122, v122
    v_rcp_f32 v123, v123
    v_rcp_f32 v124, v124
    v_rcp_f32 v125, v125
    v_rcp_f32 v126, v126
    v_rcp_f32 v127, v127
    v_rcp_f32 v128, v128
    v_rcp_f32 v129, v129
    v_rcp_f32 v130, v130
    v_rcp_f32 v131, v131
    v_pk_mul_f32 v[104:105], v[104:105], v[76:77]
    v_pk_mul_f32 v[106:107], v[106:107], v[78:79]
    v_pk_mul_f32 v[108:109], v[108:109], v[80:81]
    v_pk_mul_f32 v[110:111], v[110:111], v[82:83]
    v_pk_mul_f32 v[112:113], v[112:113], v[84:85]
    v_pk_mul_f32 v[114:115], v[114:115], v[86:87]
    v_pk_mul_f32 v[116:117], v[116:117], v[88:89]
    v_pk_mul_f32 v[118:119], v[118:119], v[90:91]
    v_pk_mul_f32 v[120:121], v[120:121], v[92:93]
    v_pk_mul_f32 v[122:123], v[122:123], v[94:95]
    v_pk_mul_f32 v[124:125], v[124:125], v[96:97]
    v_pk_mul_f32 v[126:127], v[126:127], v[98:99]
    v_pk_mul_f32 v[128:129], v[128:129], v[100:101]
    v_pk_mul_f32 v[130:131], v[130:131], v[102:103]
    v_cvt_pk_bf16_f32 v172, v104, v105
    v_cvt_pk_bf16_f32 v173, v106, v107
    v_cvt_pk_bf16_f32 v174, v108, v109
    v_cvt_pk_bf16_f32 v175, v110, v111
    v_cvt_pk_bf16_f32 v176, v112, v113
    v_cvt_pk_bf16_f32 v177, v114, v115
    v_cvt_pk_bf16_f32 v178, v116, v117
    v_cvt_pk_bf16_f32 v179, v118, v119
    v_cvt_pk_bf16_f32 v180, v120, v121
    v_cvt_pk_bf16_f32 v181, v122, v123
    v_cvt_pk_bf16_f32 v182, v124, v125
    v_cvt_pk_bf16_f32 v183, v126, v127
    v_cvt_pk_bf16_f32 v186, v128, v129
    v_cvt_pk_bf16_f32 v187, v130, v131
    s_nop 0
    v_permlane16_swap_b32 v184, v186
    v_permlane16_swap_b32 v185, v187
    s_cmp_eq_u32 s49, 0
    s_cbranch_scc1 .Lsts_188
    buffer_store_dwordx4 v[172:175], v1, s[4:7], s31 offen
    buffer_store_dwordx4 v[176:179], v1, s[4:7], s31 offen offset:1024
    buffer_store_dwordx4 v[180:183], v1, s[4:7], s31 offen offset:2048
    buffer_store_dwordx4 v[184:187], v13, s[4:7], s32 offen
    s_branch .Lstd_189
.Lsts_188:
    buffer_store_dwordx4 v[172:175], v1, s[4:7], s31 offen sc1
    buffer_store_dwordx4 v[176:179], v1, s[4:7], s31 offen offset:1024 sc1
    buffer_store_dwordx4 v[180:183], v1, s[4:7], s31 offen offset:2048 sc1
    buffer_store_dwordx4 v[184:187], v13, s[4:7], s32 offen sc1
.Lstd_189:
    s_waitcnt vmcnt(0)
    s_cmp_eq_u32 s45, 0
    s_cbranch_scc1 .Lsts_190
    s_mov_b64 exec, 0x101
    buffer_store_dword v8, v9, s[4:7], s48 offen offset:640
    s_mov_b64 exec, -1
    s_branch .Lstd_191
.Lsts_190:
    s_mov_b64 exec, 0x101
    buffer_store_dword v8, v9, s[4:7], s48 offen offset:640 sc1
    s_mov_b64 exec, -1
.Lstd_191:
.Lst_w4:
    s_mul_i32 s26, s16, 57344
    s_add_u32 s26, s26, s20
    s_add_u32 s26, s26, 11481088
    s_lshl_b32 s29, s16, 10
    s_add_u32 s29, s29, s44
    s_add_u32 s29, s29, 7024640
    s_add_u32 s51, s50, 8
.Llw_192:
    ds_read_b128 v[252:255], v15 offset:16
    s_waitcnt lgkmcnt(0)
    v_min_u32 v252, v252, v253
    v_min3_u32 v252, v252, v254, v255
    v_cmp_le_u32 vcc, s51, v252
    s_cbranch_vccnz .Llwd_193
    s_sub_u32 s23, s23, 1
    s_cbranch_scc1 .Lexit_1
    s_branch .Llw_192
.Llwd_193:
    ds_read_b128 v[96:99], v4 offset:49152
    ds_read_b128 v[100:103], v4 offset:50176
    ds_read_b128 v[104:107], v4 offset:51200
    ds_read_b128 v[108:111], v4 offset:52224
    ds_read_b128 v[112:115], v4 offset:53248
    ds_read_b128 v[116:119], v4 offset:54272
    ds_read_b128 v[120:123], v4 offset:55296
    ds_read_b128 v[124:127], v4 offset:56320
    ds_read_b128 v[128:131], v4 offset:57344
    ds_read_b128 v[132:135], v4 offset:58368
    ds_read_b128 v[136:139], v4 offset:59392
    ds_read_b128 v[140:143], v4 offset:60416
    ds_read_b128 v[144:147], v4 offset:61440
    ds_read_b128 v[148:151], v4 offset:62464
    ds_read_b128 v[152:155], v4 offset:63488
    s_waitcnt lgkmcnt(8)
    ds_read_b128 v[156:159], v4 offset:64512
    s_mov_b64 exec, 0xffff
    buffer_load_dword v0, v7, s[4:7], s29 offen offset:640 sc1
    s_mov_b64 exec, -1
    ds_read_b128 v[160:163], v5 offset:0
    ds_read_b128 v[164:167], v5 offset:1024
    ds_read_b128 v[168:171], v5 offset:2048
    ds_read_b128 v[172:175], v5 offset:3072
    ds_read_b128 v[176:179], v5 offset:4096
    ds_read_b128 v[180:183], v5 offset:5120
    s_waitcnt lgkmcnt(8)
    ds_read_b128 v[184:187], v5 offset:6144
    ds_read_b128 v[188:191], v5 offset:7168
    ds_read_b128 v[192:195], v5 offset:8192
    ds_read_b128 v[196:199], v5 offset:9216
    ds_read_b128 v[200:203], v5 offset:10240
    ds_read_b128 v[204:207], v5 offset:11264
    ds_read_b128 v[208:211], v5 offset:12288
    s_waitcnt lgkmcnt(8)
    ds_read_b128 v[212:215], v5 offset:13312
    ds_read_b128 v[216:219], v5 offset:14336
    ds_read_b128 v[220:223], v5 offset:15360
    ds_read_b128 v[224:227], v5 offset:16384
    ds_read_b128 v[228:231], v5 offset:17408
    ds_read_b128 v[232:235], v5 offset:18432
    ds_read_b128 v[236:239], v5 offset:19456
    s_add_u32 s51, s50, 3
    v_mov_b32 v3, s51
    s_waitcnt lgkmcnt(8)
    ds_write_b32 v14, v3 offset:64
    s_mov_b64 exec, 0xffff
    s_waitcnt vmcnt(0)
    v_cmp_le_u32 vcc, 1, v0
    s_nop 0
    s_cmp_eq_u64 vcc, exec
    s_cbranch_scc1 .Lpolld_197
.Lpoll_194:
    s_cmp_eq_u32 s45, 0
    s_cbranch_scc1 .Lpolls_195
    buffer_load_dword v3, v7, s[4:7], s29 offen offset:640 sc1
    s_branch .Lpollc_196
.Lpolls_195:
    v_mov_b32 v3, 0
    buffer_atomic_add v3, v7, s[4:7], s29 offen offset:640 sc0
.Lpollc_196:
    s_waitcnt vmcnt(0)
    v_cmp_le_u32 vcc, 1, v3
    s_nop 0
    s_cmp_eq_u64 vcc, exec
    s_cbranch_scc1 .Lpolld_197
    s_sub_u32 s23, s23, 1
    s_cbranch_scc1 .Lexit_1
    s_branch .Lpoll_194
.Lpolld_197:
    s_mov_b64 exec, -1
    buffer_load_dwordx4 v[32:35], v1, s[4:7], s26 offen sc1
    buffer_load_dwordx4 v[36:39], v1, s[4:7], s26 offen offset:1024 sc1
    buffer_load_dwordx4 v[40:43], v1, s[4:7], s26 offen offset:2048 sc1
    buffer_load_dwordx4 v[44:47], v1, s[4:7], s26 offen offset:3072 sc1
    s_add_u32 s26, s26, 4096
    buffer_load_dwordx4 v[48:51], v1, s[4:7], s26 offen sc1
    buffer_load_dwordx4 v[52:55], v1, s[4:7], s26 offen offset:1024 sc1
    buffer_load_dwordx4 v[56:59], v1, s[4:7], s26 offen offset:2048 sc1
    buffer_load_dwordx4 v[60:63], v1, s[4:7], s26 offen offset:3072 sc1
    s_add_u32 s26, s26, 4096
    buffer_load_dwordx4 v[64:67], v1, s[4:7], s26 offen sc1
    buffer_load_dwordx4 v[68:71], v1, s[4:7], s26 offen offset:1024 sc1
    s_waitcnt lgkmcnt(0)
    s_waitcnt vmcnt(9)
    v_mfma_f32_16x16x32_bf16 v[16:19], v[96:99], v[32:35], v[16:19]
    v_mfma_f32_16x16x32_bf16 v[20:23], v[100:103], v[32:35], v[20:23]
    buffer_load_dwordx4 v[72:75], v1, s[4:7], s26 offen offset:2048 sc1
    v_mfma_f32_16x16x32_bf16 v[24:27], v[104:107], v[32:35], v[24:27]
    v_mfma_f32_16x16x32_bf16 v[28:31], v[108:111], v[32:35], v[28:31]
    s_waitcnt vmcnt(9)
    v_mfma_f32_16x16x32_bf16 v[16:19], v[112:115], v[36:39], v[16:19]
    ds_read_b128 v[96:99], v5 offset:20480
    ds_read_b128 v[100:103], v5 offset:21504
    v_mfma_f32_16x16x32_bf16 v[20:23], v[116:119], v[36:39], v[20:23]
    buffer_load_dwordx4 v[76:79], v1, s[4:7], s26 offen offset:3072 sc1
    s_add_u32 s26, s26, 4096
    v_mfma_f32_16x16x32_bf16 v[24:27], v[120:123], v[36:39], v[24:27]
    ds_read_b128 v[104:107], v5 offset:22528
    ds_read_b128 v[108:111], v5 offset:23552
    v_mfma_f32_16x16x32_bf16 v[28:31], v[124:127], v[36:39], v[28:31]
    s_waitcnt vmcnt(9)
    v_mfma_f32_16x16x32_bf16 v[16:19], v[128:131], v[40:43], v[16:19]
    ds_read_b128 v[252:255], v15 offset:16
    ds_read_b128 v[112:115], v5 offset:24576
    ds_read_b128 v[116:119], v5 offset:25600
    v_mfma_f32_16x16x32_bf16 v[20:23], v[132:135], v[40:43], v[20:23]
    buffer_load_dwordx4 v[80:83], v1, s[4:7], s26 offen sc1
    v_mfma_f32_16x16x32_bf16 v[24:27], v[136:139], v[40:43], v[24:27]
    ds_read_b128 v[120:123], v5 offset:26624
    ds_read_b128 v[124:127], v5 offset:27648
    v_mfma_f32_16x16x32_bf16 v[28:31], v[140:143], v[40:43], v[28:31]
    s_waitcnt vmcnt(9)
    v_mfma_f32_16x16x32_bf16 v[16:19], v[144:147], v[44:47], v[16:19]
    s_add_u32 s51, s50, 9
    s_waitcnt lgkmcnt(4)
    v_min_u32 v252, v252, v253
    v_min3_u32 v252, v252, v254, v255
    v_cmp_le_u32 vcc, s51, v252
    s_cbranch_vccnz .Llt_198
    s_add_u32 s51, s50, 9
.Llw_199:
    ds_read_b128 v[252:255], v15 offset:16
    s_waitcnt lgkmcnt(0)
    v_min_u32 v252, v252, v253
    v_min3_u32 v252, v252, v254, v255
    v_cmp_le_u32 vcc, s51, v252
    s_cbranch_vccnz .Llwd_200
    s_sub_u32 s23, s23, 1
    s_cbranch_scc1 .Lexit_1
    s_branch .Llw_199
.Llwd_200:
.Llt_198:
    ds_read_b128 v[128:131], v4 offset:24576
    ds_read_b128 v[132:135], v4 offset:25600
    v_mfma_f32_16x16x32_bf16 v[20:23], v[148:151], v[44:47], v[20:23]
    buffer_load_dwordx4 v[84:87], v1, s[4:7], s26 offen offset:1024 sc1
    v_mfma_f32_16x16x32_bf16 v[24:27], v[152:155], v[44:47], v[24:27]
    ds_read_b128 v[136:139], v4 offset:26624
    ds_read_b128 v[140:143], v4 offset:27648
    v_mfma_f32_16x16x32_bf16 v[28:31], v[156:159], v[44:47], v[28:31]
    s_waitcnt vmcnt(9)
    v_mfma_f32_16x16x32_bf16 v[16:19], v[160:163], v[48:51], v[16:19]
    ds_read_b128 v[144:147], v4 offset:28672
    ds_read_b128 v[148:151], v4 offset:29696
    v_mfma_f32_16x16x32_bf16 v[20:23], v[164:167], v[48:51], v[20:23]
    buffer_load_dwordx4 v[88:91], v1, s[4:7], s26 offen offset:2048 sc1
    v_mfma_f32_16x16x32_bf16 v[24:27], v[168:171], v[48:51], v[24:27]
    ds_read_b128 v[152:155], v4 offset:30720
    ds_read_b128 v[156:159], v4 offset:31744
    v_mfma_f32_16x16x32_bf16 v[28:31], v[172:175], v[48:51], v[28:31]
    s_waitcnt vmcnt(9)
    v_mfma_f32_16x16x32_bf16 v[16:19], v[176:179], v[52:55], v[16:19]
    ds_read_b128 v[160:163], v4 offset:32768
    ds_read_b128 v[164:167], v4 offset:33792
    v_mfma_f32_16x16x32_bf16 v[20:23], v[180:183], v[52:55], v[20:23]
    buffer_load_dwordx4 v[92:95], v1, s[4:7], s26 offen offset:3072 sc1
    s_add_u32 s26, s26, 4096
    v_mfma_f32_16x16x32_bf16 v[24:27], v[184:187], v[52:55], v[24:27]
    ds_read_b128 v[168:171], v4 offset:34816
    s_waitcnt lgkmcnt(8)
    ds_read_b128 v[172:175], v4 offset:35840
    v_mfma_f32_16x16x32_bf16 v[28:31], v[188:191], v[52:55], v[28:31]
    s_waitcnt vmcnt(9)
    v_mfma_f32_16x16x32_bf16 v[16:19], v[192:195], v[56:59], v[16:19]
    ds_read_b128 v[176:179], v4 offset:36864
    ds_read_b128 v[180:183], v4 offset:37888
    v_mfma_f32_16x16x32_bf16 v[20:23], v[196:199], v[56:59], v[20:23]
    buffer_load_dwordx4 v[32:35], v1, s[4:7], s26 offen sc1
    v_mfma_f32_16x16x32_bf16 v[24:27], v[200:203], v[56:59], v[24:27]
    ds_read_b128 v[184:187], v4 offset:38912
    ds_read_b128 v[188:191], v4 offset:39936
    v_mfma_f32_16x16x32_bf16 v[28:31], v[204:207], v[56:59], v[28:31]
    s_waitcnt vmcnt(9)
    v_mfma_f32_16x16x32_bf16 v[16:19], v[208:211], v[60:63], v[16:19]
    ds_read_b128 v[192:195], v4 offset:40960
    ds_read_b128 v[196:199], v4 offset:41984
    v_mfma_f32_16x16x32_bf16 v[20:23], v[212:215], v[60:63], v[20:23]
    buffer_load_dwordx4 v[36:39], v1, s[4:7], s26 offen offset:1024 sc1
    v_mfma_f32_16x16x32_bf16 v[24:27], v[216:219], v[60:63], v[24:27]
    s_waitcnt lgkmcnt(8)
    ds_read_b128 v[200:203], v4 offset:43008
    ds_read_b128 v[204:207], v4 offset:44032
    v_mfma_f32_16x16x32_bf16 v[28:31], v[220:223], v[60:63], v[28:31]
    s_waitcnt vmcnt(9)
    v_mfma_f32_16x16x32_bf16 v[16:19], v[224:227], v[64:67], v[16:19]
    ds_read_b128 v[208:211], v4 offset:45056
    ds_read_b128 v[212:215], v4 offset:46080
    v_mfma_f32_16x16x32_bf16 v[20:23], v[228:231], v[64:67], v[20:23]
    buffer_load_dwordx4 v[40:43], v1, s[4:7], s26 offen offset:2048 sc1
    v_mfma_f32_16x16x32_bf16 v[24:27], v[232:235], v[64:67], v[24:27]
    ds_read_b128 v[216:219], v4 offset:47104
    ds_read_b128 v[220:223], v4 offset:48128
    v_mfma_f32_16x16x32_bf16 v[28:31], v[236:239], v[64:67], v[28:31]
    s_add_u32 s51, s50, 10
    v_mov_b32 v3, s51
    ds_write_b32 v14, v3 offset:0
    s_waitcnt vmcnt(9)
    v_mfma_f32_16x16x32_bf16 v[16:19], v[96:99], v[68:71], v[16:19]
    s_waitcnt lgkmcnt(8)
    ds_read_b128 v[224:227], v1 offset:0
    ds_read_b128 v[228:231], v1 offset:1024
    v_mfma_f32_16x16x32_bf16 v[20:23], v[100:103], v[68:71], v[20:23]
    buffer_load_dwordx4 v[44:47], v1, s[4:7], s26 offen offset:3072 sc1
    s_add_u32 s26, s26, 4096
    v_mfma_f32_16x16x32_bf16 v[24:27], v[104:107], v[68:71], v[24:27]
    ds_read_b128 v[232:235], v1 offset:2048
    ds_read_b128 v[236:239], v1 offset:3072
    v_mfma_f32_16x16x32_bf16 v[28:31], v[108:111], v[68:71], v[28:31]
    s_waitcnt vmcnt(9)
    v_mfma_f32_16x16x32_bf16 v[16:19], v[112:115], v[72:75], v[16:19]
    ds_read_b128 v[96:99], v1 offset:4096
    ds_read_b128 v[100:103], v1 offset:5120
    v_mfma_f32_16x16x32_bf16 v[20:23], v[116:119], v[72:75], v[20:23]
    buffer_load_dwordx4 v[48:51], v1, s[4:7], s26 offen sc1
    v_mfma_f32_16x16x32_bf16 v[24:27], v[120:123], v[72:75], v[24:27]
    ds_read_b128 v[104:107], v1 offset:6144
    s_waitcnt lgkmcnt(8)
    ds_read_b128 v[108:111], v1 offset:7168
    v_mfma_f32_16x16x32_bf16 v[28:31], v[124:127], v[72:75], v[28:31]
    s_waitcnt vmcnt(9)
    v_mfma_f32_16x16x32_bf16 v[16:19], v[128:131], v[76:79], v[16:19]
    ds_read_b128 v[112:115], v1 offset:8192
    ds_read_b128 v[116:119], v1 offset:9216
    v_mfma_f32_16x16x32_bf16 v[20:23], v[132:135], v[76:79], v[20:23]
    buffer_load_dwordx4 v[52:55], v1, s[4:7], s26 offen offset:1024 sc1
    v_mfma_f32_16x16x32_bf16 v[24:27], v[136:139], v[76:79], v[24:27]
    ds_read_b128 v[120:123], v1 offset:10240
    ds_read_b128 v[124:127], v1 offset:11264
    v_mfma_f32_16x16x32_bf16 v[28:31], v[140:143], v[76:79], v[28:31]
    s_waitcnt vmcnt(9)
    v_mfma_f32_16x16x32_bf16 v[16:19], v[144:147], v[80:83], v[16:19]
    ds_read_b128 v[128:131], v1 offset:12288
    ds_read_b128 v[132:135], v1 offset:13312
    v_mfma_f32_16x16x32_bf16 v[20:23], v[148:151], v[80:83], v[20:23]
    buffer_load_dwordx4 v[56:59], v1, s[4:7], s26 offen offset:2048 sc1
    v_mfma_f32_16x16x32_bf16 v[24:27], v[152:155], v[80:83], v[24:27]
    s_waitcnt lgkmcnt(8)
    ds_read_b128 v[136:139], v1 offset:14336
    ds_read_b128 v[140:143], v1 offset:15360
    v_mfma_f32_16x16x32_bf16 v[28:31], v[156:159], v[80:83], v[28:31]
    s_waitcnt vmcnt(9)
    v_mfma_f32_16x16x32_bf16 v[16:19], v[160:163], v[84:87], v[16:19]
    ds_read_b128 v[144:147], v1 offset:16384
    ds_read_b128 v[148:151], v1 offset:17408
    v_mfma_f32_16x16x32_bf16 v[20:23], v[164:167], v[84:87], v[20:23]
    buffer_load_dwordx4 v[60:63], v1, s[4:7], s26 offen offset:3072 sc1
    s_add_u32 s26, s26, 4096
    v_mfma_f32_16x16x32_bf16 v[24:27], v[168:171], v[84:87], v[24:27]
    ds_read_b128 v[152:155], v1 offset:18432
    ds_read_b128 v[156:159], v1 offset:19456
    v_mfma_f32_16x16x32_bf16 v[28:31], v[172:175], v[84:87], v[28:31]
    s_waitcnt vmcnt(9)
    v_mfma_f32_16x16x32_bf16 v[16:19], v[176:179], v[88:91], v[16:19]
    ds_read_b128 v[160:163], v1 offset:20480
    s_waitcnt lgkmcnt(8)
    ds_read_b128 v[164:167], v1 offset:21504
    v_mfma_f32_16x16x32_bf16 v[20:23], v[180:183], v[88:91], v[20:23]
    buffer_load_dwordx4 v[64:67], v1, s[4:7], s26 offen sc1
    v_mfma_f32_16x16x32_bf16 v[24:27], v[184:187], v[88:91], v[24:27]
    ds_read_b128 v[168:171], v1 offset:22528
    ds_read_b128 v[172:175], v1 offset:23552
    v_mfma_f32_16x16x32_bf16 v[28:31], v[188:191], v[88:91], v[28:31]
    s_waitcnt vmcnt(9)
    v_mfma_f32_16x16x32_bf16 v[16:19], v[192:195], v[92:95], v[16:19]
    ds_read_b128 v[176:179], v1 offset:24576
    ds_read_b128 v[180:183], v1 offset:25600
    v_mfma_f32_16x16x32_bf16 v[20:23], v[196:199], v[92:95], v[20:23]
    buffer_load_dwordx4 v[68:71], v1, s[4:7], s26 offen offset:1024 sc1
    v_mfma_f32_16x16x32_bf16 v[24:27], v[200:203], v[92:95], v[24:27]
    ds_read_b128 v[184:187], v1 offset:26624
    ds_read_b128 v[188:191], v1 offset:27648
    v_mfma_f32_16x16x32_bf16 v[28:31], v[204:207], v[92:95], v[28:31]
    s_waitcnt vmcnt(9)
    v_mfma_f32_16x16x32_bf16 v[16:19], v[208:211], v[32:35], v[16:19]
    s_waitcnt lgkmcnt(8)
    ds_read_b128 v[192:195], v1 offset:28672
    ds_read_b128 v[196:199], v1 offset:29696
    v_mfma_f32_16x16x32_bf16 v[20:23], v[212:215], v[32:35], v[20:23]
    buffer_load_dwordx4 v[72:75], v1, s[4:7], s26 offen offset:2048 sc1
    v_mfma_f32_16x16x32_bf16 v[24:27], v[216:219], v[32:35], v[24:27]
    ds_read_b128 v[200:203], v1 offset:30720
    ds_read_b128 v[204:207], v1 offset:31744
    v_mfma_f32_16x16x32_bf16 v[28:31], v[220:223], v[32:35], v[28:31]
    s_waitcnt vmcnt(9)
    v_mfma_f32_16x16x32_bf16 v[16:19], v[224:227], v[36:39], v[16:19]
    ds_read_b128 v[208:211], v1 offset:32768
    ds_read_b128 v[212:215], v1 offset:33792
    v_mfma_f32_16x16x32_bf16 v[20:23], v[228:231], v[36:39], v[20:23]
    buffer_load_dwordx4 v[76:79], v1, s[4:7], s26 offen offset:3072 sc1
    s_add_u32 s26, s26, 4096
    v_mfma_f32_16x16x32_bf16 v[24:27], v[232:235], v[36:39], v[24:27]
    ds_read_b128 v[216:219], v1 offset:34816
    s_waitcnt lgkmcnt(8)
    ds_read_b128 v[220:223], v1 offset:35840
    v_mfma_f32_16x16x32_bf16 v[28:31], v[236:239], v[36:39], v[28:31]
    s_waitcnt vmcnt(9)
    v_mfma_f32_16x16x32_bf16 v[16:19], v[96:99], v[40:43], v[16:19]
    ds_read_b128 v[224:227], v1 offset:36864
    ds_read_b128 v[228:231], v1 offset:37888
    v_mfma_f32_16x16x32_bf16 v[20:23], v[100:103], v[40:43], v[20:23]
    buffer_load_dwordx4 v[80:83], v1, s[4:7], s26 offen sc1
    v_mfma_f32_16x16x32_bf16 v[24:27], v[104:107], v[40:43], v[24:27]
    ds_read_b128 v[232:235], v1 offset:38912
    ds_read_b128 v[236:239], v1 offset:39936
    v_mfma_f32_16x16x32_bf16 v[28:31], v[108:111], v[40:43], v[28:31]
    s_waitcnt vmcnt(9)
    v_mfma_f32_16x16x32_bf16 v[16:19], v[112:115], v[44:47], v[16:19]
    ds_read_b128 v[96:99], v1 offset:40960
    ds_read_b128 v[100:103], v1 offset:41984
    v_mfma_f32_16x16x32_bf16 v[20:23], v[116:119], v[44:47], v[20:23]
    buffer_load_dwordx4 v[84:87], v1, s[4:7], s26 offen offset:1024 sc1
    v_mfma_f32_16x16x32_bf16 v[24:27], v[120:123], v[44:47], v[24:27]
    s_waitcnt lgkmcnt(8)
    ds_read_b128 v[104:107], v1 offset:43008
    ds_read_b128 v[108:111], v1 offset:44032
    v_mfma_f32_16x16x32_bf16 v[28:31], v[124:127], v[44:47], v[28:31]
    s_waitcnt vmcnt(9)
    v_mfma_f32_16x16x32_bf16 v[16:19], v[128:131], v[48:51], v[16:19]
    ds_read_b128 v[112:115], v1 offset:45056
    ds_read_b128 v[116:119], v1 offset:46080
    v_mfma_f32_16x16x32_bf16 v[20:23], v[132:135], v[48:51], v[20:23]
    buffer_load_dwordx4 v[88:91], v1, s[4:7], s26 offen offset:2048 sc1
    v_mfma_f32_16x16x32_bf16 v[24:27], v[136:139], v[48:51], v[24:27]
    ds_read_b128 v[120:123], v1 offset:47104
    ds_read_b128 v[124:127], v1 offset:48128
    v_mfma_f32_16x16x32_bf16 v[28:31], v[140:143], v[48:51], v[28:31]
    s_waitcnt vmcnt(9)
    v_mfma_f32_16x16x32_bf16 v[16:19], v[144:147], v[52:55], v[16:19]
    ds_read_b128 v[128:131], v1 offset:49152
    s_waitcnt lgkmcnt(8)
    ds_read_b128 v[132:135], v1 offset:50176
    v_mfma_f32_16x16x32_bf16 v[20:23], v[148:151], v[52:55], v[20:23]
    buffer_load_dwordx4 v[92:95], v1, s[4:7], s26 offen offset:3072 sc1
    s_add_u32 s26, s26, 4096
    v_mfma_f32_16x16x32_bf16 v[24:27], v[152:155], v[52:55], v[24:27]
    ds_read_b128 v[136:139], v1 offset:51200
    ds_read_b128 v[140:143], v1 offset:52224
    v_mfma_f32_16x16x32_bf16 v[28:31], v[156:159], v[52:55], v[28:31]
    s_waitcnt vmcnt(9)
    v_mfma_f32_16x16x32_bf16 v[16:19], v[160:163], v[56:59], v[16:19]
    ds_read_b128 v[144:147], v1 offset:53248
    ds_read_b128 v[148:151], v1 offset:54272
    v_mfma_f32_16x16x32_bf16 v[20:23], v[164:167], v[56:59], v[20:23]
    buffer_load_dwordx4 v[32:35], v1, s[4:7], s26 offen sc1
    v_mfma_f32_16x16x32_bf16 v[24:27], v[168:171], v[56:59], v[24:27]
    ds_read_b128 v[152:155], v1 offset:55296
    ds_read_b128 v[156:159], v1 offset:56320
    v_mfma_f32_16x16x32_bf16 v[28:31], v[172:175], v[56:59], v[28:31]
    s_waitcnt vmcnt(9)
    v_mfma_f32_16x16x32_bf16 v[16:19], v[176:179], v[60:63], v[16:19]
    s_waitcnt lgkmcnt(8)
    ds_read_b128 v[160:163], v1 offset:57344
    ds_read_b128 v[164:167], v1 offset:58368
    v_mfma_f32_16x16x32_bf16 v[20:23], v[180:183], v[60:63], v[20:23]
    buffer_load_dwordx4 v[36:39], v1, s[4:7], s26 offen offset:1024 sc1
    v_mfma_f32_16x16x32_bf16 v[24:27], v[184:187], v[60:63], v[24:27]
    ds_read_b128 v[168:171], v1 offset:59392
    ds_read_b128 v[172:175], v1 offset:60416
    v_mfma_f32_16x16x32_bf16 v[28:31], v[188:191], v[60:63], v[28:31]
    s_waitcnt vmcnt(9)
    v_mfma_f32_16x16x32_bf16 v[16:19], v[192:195], v[64:67], v[16:19]
    ds_read_b128 v[176:179], v1 offset:61440
    ds_read_b128 v[180:183], v1 offset:62464
    v_mfma_f32_16x16x32_bf16 v[20:23], v[196:199], v[64:67], v[20:23]
    buffer_load_dwordx4 v[40:43], v1, s[4:7], s26 offen offset:2048 sc1
    v_mfma_f32_16x16x32_bf16 v[24:27], v[200:203], v[64:67], v[24:27]
    ds_read_b128 v[184:187], v1 offset:63488
    s_waitcnt lgkmcnt(8)
    ds_read_b128 v[188:191], v1 offset:64512
    v_mfma_f32_16x16x32_bf16 v[28:31], v[204:207], v[64:67], v[28:31]
    s_waitcnt vmcnt(9)
    v_mfma_f32_16x16x32_bf16 v[16:19], v[208:211], v[68:71], v[16:19]
    ds_read_b128 v[192:195], v4 offset:0
    ds_read_b128 v[196:199], v4 offset:1024
    v_mfma_f32_16x16x32_bf16 v[20:23], v[212:215], v[68:71], v[20:23]
    buffer_load_dwordx4 v[44:47], v1, s[4:7], s26 offen offset:3072 sc1
    s_add_u32 s26, s26, 4096
    v_mfma_f32_16x16x32_bf16 v[24:27], v[216:219], v[68:71], v[24:27]
    ds_read_b128 v[200:203], v4 offset:2048
    ds_read_b128 v[204:207], v4 offset:3072
    v_mfma_f32_16x16x32_bf16 v[28:31], v[220:223], v[68:71], v[28:31]
    s_waitcnt vmcnt(9)
    v_mfma_f32_16x16x32_bf16 v[16:19], v[224:227], v[72:75], v[16:19]
    ds_read_b128 v[208:211], v4 offset:4096
    ds_read_b128 v[212:215], v4 offset:5120
    v_mfma_f32_16x16x32_bf16 v[20:23], v[228:231], v[72:75], v[20:23]
    buffer_load_dwordx4 v[48:51], v1, s[4:7], s26 offen sc1
    v_mfma_f32_16x16x32_bf16 v[24:27], v[232:235], v[72:75], v[24:27]
    s_waitcnt lgkmcnt(8)
    ds_read_b128 v[216:219], v4 offset:6144
    ds_read_b128 v[220:223], v4 offset:7168
    v_mfma_f32_16x16x32_bf16 v[28:31], v[236:239], v[72:75], v[28:31]
    s_waitcnt vmcnt(9)
    v_mfma_f32_16x16x32_bf16 v[16:19], v[96:99], v[76:79], v[16:19]
    ds_read_b128 v[224:227], v4 offset:8192
    ds_read_b128 v[228:231], v4 offset:9216
    v_mfma_f32_16x16x32_bf16 v[20:23], v[100:103], v[76:79], v[20:23]
    buffer_load_dwordx4 v[52:55], v1, s[4:7], s26 offen offset:1024 sc1
    v_mfma_f32_16x16x32_bf16 v[24:27], v[104:107], v[76:79], v[24:27]
    ds_read_b128 v[232:235], v4 offset:10240
    ds_read_b128 v[236:239], v4 offset:11264
    v_mfma_f32_16x16x32_bf16 v[28:31], v[108:111], v[76:79], v[28:31]
    s_waitcnt vmcnt(9)
    v_mfma_f32_16x16x32_bf16 v[16:19], v[112:115], v[80:83], v[16:19]
    ds_read_b128 v[96:99], v4 offset:12288
    s_waitcnt lgkmcnt(8)
    ds_read_b128 v[100:103], v4 offset:13312
    v_mfma_f32_16x16x32_bf16 v[20:23], v[116:119], v[80:83], v[20:23]
    buffer_load_dwordx4 v[56:59], v1, s[4:7], s26 offen offset:2048 sc1
    v_mfma_f32_16x16x32_bf16 v[24:27], v[120:123], v[80:83], v[24:27]
    ds_read_b128 v[104:107], v4 offset:14336
    ds_read_b128 v[108:111], v4 offset:15360
    v_mfma_f32_16x16x32_bf16 v[28:31], v[124:127], v[80:83], v[28:31]
    s_waitcnt vmcnt(9)
    v_mfma_f32_16x16x32_bf16 v[16:19], v[128:131], v[84:87], v[16:19]
    ds_read_b128 v[112:115], v4 offset:16384
    ds_read_b128 v[116:119], v4 offset:17408
    v_mfma_f32_16x16x32_bf16 v[20:23], v[132:135], v[84:87], v[20:23]
    buffer_load_dwordx4 v[60:63], v1, s[4:7], s26 offen offset:3072 sc1
    s_add_u32 s26, s26, 4096
    v_mfma_f32_16x16x32_bf16 v[24:27], v[136:139], v[84:87], v[24:27]
    ds_read_b128 v[120:123], v4 offset:18432
    ds_read_b128 v[124:127], v4 offset:19456
    v_mfma_f32_16x16x32_bf16 v[28:31], v[140:143], v[84:87], v[28:31]
    s_waitcnt vmcnt(9)
    v_mfma_f32_16x16x32_bf16 v[16:19], v[144:147], v[88:91], v[16:19]
    s_waitcnt lgkmcnt(8)
    ds_read_b128 v[252:255], v15 offset:16
    ds_read_b128 v[128:131], v4 offset:20480
    ds_read_b128 v[132:135], v4 offset:21504
    v_mfma_f32_16x16x32_bf16 v[20:23], v[148:151], v[88:91], v[20:23]
    buffer_load_dwordx4 v[64:67], v1, s[4:7], s26 offen sc1
    v_mfma_f32_16x16x32_bf16 v[24:27], v[152:155], v[88:91], v[24:27]
    ds_read_b128 v[136:139], v4 offset:22528
    ds_read_b128 v[140:143], v4 offset:23552
    v_mfma_f32_16x16x32_bf16 v[28:31], v[156:159], v[88:91], v[28:31]
    s_waitcnt vmcnt(9)
    v_mfma_f32_16x16x32_bf16 v[16:19], v[160:163], v[92:95], v[16:19]
    s_add_u32 s51, s50, 10
    s_waitcnt lgkmcnt(4)
    v_min_u32 v252, v252, v253
    v_min3_u32 v252, v252, v254, v255
    v_cmp_le_u32 vcc, s51, v252
    s_cbranch_vccnz .Llt_201
    s_add_u32 s51, s50, 10
.Llw_202:
    ds_read_b128 v[252:255], v15 offset:16
    s_waitcnt lgkmcnt(0)
    v_min_u32 v252, v252, v253
    v_min3_u32 v252, v252, v254, v255
    v_cmp_le_u32 vcc, s51, v252
    s_cbranch_vccnz .Llwd_203
    s_sub_u32 s23, s23, 1
    s_cbranch_scc1 .Lexit_1
    s_branch .Llw_202
.Llwd_203:
.Llt_201:
    ds_read_b128 v[144:147], v4 offset:49152
    ds_read_b128 v[148:151], v4 offset:50176
    v_mfma_f32_16x16x32_bf16 v[20:23], v[164:167], v[92:95], v[20:23]
    buffer_load_dwordx4 v[68:71], v1, s[4:7], s26 offen offset:1024 sc1
    v_mfma_f32_16x16x32_bf16 v[24:27], v[168:171], v[92:95], v[24:27]
    ds_read_b128 v[152:155], v4 offset:51200
    ds_read_b128 v[156:159], v4 offset:52224
    v_mfma_f32_16x16x32_bf16 v[28:31], v[172:175], v[92:95], v[28:31]
    s_waitcnt vmcnt(9)
    v_mfma_f32_16x16x32_bf16 v[16:19], v[176:179], v[32:35], v[16:19]
    ds_read_b128 v[160:163], v4 offset:53248
    ds_read_b128 v[164:167], v4 offset:54272
    v_mfma_f32_16x16x32_bf16 v[20:23], v[180:183], v[32:35], v[20:23]
    buffer_load_dwordx4 v[72:75], v1, s[4:7], s26 offen offset:2048 sc1
    v_mfma_f32_16x16x32_bf16 v[24:27], v[184:187], v[32:35], v[24:27]
    ds_read_b128 v[168:171], v4 offset:55296
    ds_read_b128 v[172:175], v4 offset:56320
    v_mfma_f32_16x16x32_bf16 v[28:31], v[188:191], v[32:35], v[28:31]
    s_waitcnt vmcnt(9)
    v_mfma_f32_16x16x32_bf16 v[16:19], v[192:195], v[36:39], v[16:19]
    ds_read_b128 v[176:179], v4 offset:57344
    ds_read_b128 v[180:183], v4 offset:58368
    v_mfma_f32_16x16x32_bf16 v[20:23], v[196:199], v[36:39], v[20:23]
    buffer_load_dwordx4 v[76:79], v1, s[4:7], s26 offen offset:3072 sc1
    s_add_u32 s26, s26, 4096
    v_mfma_f32_16x16x32_bf16 v[24:27], v[200:203], v[36:39], v[24:27]
    ds_read_b128 v[184:187], v4 offset:59392
    s_waitcnt lgkmcnt(8)
    ds_read_b128 v[188:191], v4 offset:60416
    v_mfma_f32_16x16x32_bf16 v[28:31], v[204:207], v[36:39], v[28:31]
    s_waitcnt vmcnt(9)
    v_mfma_f32_16x16x32_bf16 v[16:19], v[208:211], v[40:43], v[16:19]
    ds_read_b128 v[192:195], v4 offset:61440
    ds_read_b128 v[196:199], v4 offset:62464
    v_mfma_f32_16x16x32_bf16 v[20:23], v[212:215], v[40:43], v[20:23]
    buffer_load_dwordx4 v[80:83], v1, s[4:7], s26 offen sc1
    v_mfma_f32_16x16x32_bf16 v[24:27], v[216:219], v[40:43], v[24:27]
    ds_read_b128 v[200:203], v4 offset:63488
    ds_read_b128 v[204:207], v4 offset:64512
    v_mfma_f32_16x16x32_bf16 v[28:31], v[220:223], v[40:43], v[28:31]
    s_waitcnt vmcnt(9)
    v_mfma_f32_16x16x32_bf16 v[16:19], v[224:227], v[44:47], v[16:19]
    ds_read_b128 v[208:211], v5 offset:0
    ds_read_b128 v[212:215], v5 offset:1024
    v_mfma_f32_16x16x32_bf16 v[20:23], v[228:231], v[44:47], v[20:23]
    buffer_load_dwordx4 v[84:87], v1, s[4:7], s26 offen offset:1024 sc1
    v_mfma_f32_16x16x32_bf16 v[24:27], v[232:235], v[44:47], v[24:27]
    s_waitcnt lgkmcnt(8)
    ds_read_b128 v[216:219], v5 offset:2048
    ds_read_b128 v[220:223], v5 offset:3072
    v_mfma_f32_16x16x32_bf16 v[28:31], v[236:239], v[44:47], v[28:31]
    s_waitcnt vmcnt(9)
    v_mfma_f32_16x16x32_bf16 v[16:19], v[96:99], v[48:51], v[16:19]
    ds_read_b128 v[224:227], v5 offset:4096
    ds_read_b128 v[228:231], v5 offset:5120
    v_mfma_f32_16x16x32_bf16 v[20:23], v[100:103], v[48:51], v[20:23]
    buffer_load_dwordx4 v[88:91], v1, s[4:7], s26 offen offset:2048 sc1
    v_mfma_f32_16x16x32_bf16 v[24:27], v[104:107], v[48:51], v[24:27]
    ds_read_b128 v[232:235], v5 offset:6144
    ds_read_b128 v[236:239], v5 offset:7168
    v_mfma_f32_16x16x32_bf16 v[28:31], v[108:111], v[48:51], v[28:31]
    s_waitcnt vmcnt(9)
    v_mfma_f32_16x16x32_bf16 v[16:19], v[112:115], v[52:55], v[16:19]
    ds_read_b128 v[96:99], v5 offset:8192
    s_waitcnt lgkmcnt(8)
    ds_read_b128 v[100:103], v5 offset:9216
    v_mfma_f32_16x16x32_bf16 v[20:23], v[116:119], v[52:55], v[20:23]
    buffer_load_dwordx4 v[92:95], v1, s[4:7], s26 offen offset:3072 sc1
    s_add_u32 s26, s26, 4096
    v_mfma_f32_16x16x32_bf16 v[24:27], v[120:123], v[52:55], v[24:27]
    ds_read_b128 v[104:107], v5 offset:10240
    ds_read_b128 v[108:111], v5 offset:11264
    v_mfma_f32_16x16x32_bf16 v[28:31], v[124:127], v[52:55], v[28:31]
    s_waitcnt vmcnt(9)
    v_mfma_f32_16x16x32_bf16 v[16:19], v[128:131], v[56:59], v[16:19]
    ds_read_b128 v[112:115], v5 offset:12288
    ds_read_b128 v[116:119], v5 offset:13312
    v_mfma_f32_16x16x32_bf16 v[20:23], v[132:135], v[56:59], v[20:23]
    buffer_load_dwordx4 v[32:35], v1, s[4:7], s26 offen sc1
    v_mfma_f32_16x16x32_bf16 v[24:27], v[136:139], v[56:59], v[24:27]
    ds_read_b128 v[120:123], v5 offset:14336
    ds_read_b128 v[124:127], v5 offset:15360
    v_mfma_f32_16x16x32_bf16 v[28:31], v[140:143], v[56:59], v[28:31]
    s_waitcnt vmcnt(9)
    v_mfma_f32_16x16x32_bf16 v[16:19], v[144:147], v[60:63], v[16:19]
    s_waitcnt lgkmcnt(8)
    ds_read_b128 v[128:131], v5 offset:16384
    ds_read_b128 v[132:135], v5 offset:17408
    v_mfma_f32_16x16x32_bf16 v[20:23], v[148:151], v[60:63], v[20:23]
    buffer_load_dwordx4 v[36:39], v1, s[4:7], s26 offen offset:1024 sc1
    v_mfma_f32_16x16x32_bf16 v[24:27], v[152:155], v[60:63], v[24:27]
    ds_read_b128 v[136:139], v5 offset:18432
    ds_read_b128 v[140:143], v5 offset:19456
    v_mfma_f32_16x16x32_bf16 v[28:31], v[156:159], v[60:63], v[28:31]
    s_waitcnt vmcnt(9)
    v_mfma_f32_16x16x32_bf16 v[16:19], v[160:163], v[64:67], v[16:19]
    ds_read_b128 v[144:147], v5 offset:20480
    ds_read_b128 v[148:151], v5 offset:21504
    v_mfma_f32_16x16x32_bf16 v[20:23], v[164:167], v[64:67], v[20:23]
    buffer_load_dwordx4 v[40:43], v1, s[4:7], s26 offen offset:2048 sc1
    v_mfma_f32_16x16x32_bf16 v[24:27], v[168:171], v[64:67], v[24:27]
    ds_read_b128 v[152:155], v5 offset:22528
    s_waitcnt lgkmcnt(8)
    ds_read_b128 v[156:159], v5 offset:23552
    v_mfma_f32_16x16x32_bf16 v[28:31], v[172:175], v[64:67], v[28:31]
    s_waitcnt vmcnt(9)
    v_mfma_f32_16x16x32_bf16 v[16:19], v[176:179], v[68:71], v[16:19]
    ds_read_b128 v[160:163], v5 offset:24576
    ds_read_b128 v[164:167], v5 offset:25600
    v_mfma_f32_16x16x32_bf16 v[20:23], v[180:183], v[68:71], v[20:23]
    buffer_load_dwordx4 v[44:47], v1, s[4:7], s26 offen offset:3072 sc1
    s_add_u32 s26, s26, 4096
    v_mfma_f32_16x16x32_bf16 v[24:27], v[184:187], v[68:71], v[24:27]
    ds_read_b128 v[168:171], v5 offset:26624
    ds_read_b128 v[172:175], v5 offset:27648
    v_mfma_f32_16x16x32_bf16 v[28:31], v[188:191], v[68:71], v[28:31]
    s_waitcnt vmcnt(9)
    v_mfma_f32_16x16x32_bf16 v[16:19], v[192:195], v[72:75], v[16:19]
    ds_read_b128 v[176:179], v4 offset:24576
    ds_read_b128 v[180:183], v4 offset:25600
    v_mfma_f32_16x16x32_bf16 v[20:23], v[196:199], v[72:75], v[20:23]
    buffer_load_dwordx4 v[48:51], v1, s[4:7], s26 offen sc1
    v_mfma_f32_16x16x32_bf16 v[24:27], v[200:203], v[72:75], v[24:27]
    s_waitcnt lgkmcnt(8)
    ds_read_b128 v[184:187], v4 offset:26624
    ds_read_b128 v[188:191], v4 offset:27648
    v_mfma_f32_16x16x32_bf16 v[28:31], v[204:207], v[72:75], v[28:31]
    s_waitcnt vmcnt(9)
    v_mfma_f32_16x16x32_bf16 v[16:19], v[208:211], v[76:79], v[16:19]
    ds_read_b128 v[192:195], v4 offset:28672
    ds_read_b128 v[196:199], v4 offset:29696
    v_mfma_f32_16x16x32_bf16 v[20:23], v[212:215], v[76:79], v[20:23]
    buffer_load_dwordx4 v[52:55], v1, s[4:7], s26 offen offset:1024 sc1
    v_mfma_f32_16x16x32_bf16 v[24:27], v[216:219], v[76:79], v[24:27]
    ds_read_b128 v[200:203], v4 offset:30720
    ds_read_b128 v[204:207], v4 offset:31744
    v_mfma_f32_16x16x32_bf16 v[28:31], v[220:223], v[76:79], v[28:31]
    s_waitcnt vmcnt(9)
    v_mfma_f32_16x16x32_bf16 v[16:19], v[224:227], v[80:83], v[16:19]
    ds_read_b128 v[208:211], v4 offset:32768
    s_waitcnt lgkmcnt(8)
    ds_read_b128 v[212:215], v4 offset:33792
    v_mfma_f32_16x16x32_bf16 v[20:23], v[228:231], v[80:83], v[20:23]
    buffer_load_dwordx4 v[56:59], v1, s[4:7], s26 offen offset:2048 sc1
    v_mfma_f32_16x16x32_bf16 v[24:27], v[232:235], v[80:83], v[24:27]
    ds_read_b128 v[216:219], v4 offset:34816
    ds_read_b128 v[220:223], v4 offset:35840
    v_mfma_f32_16x16x32_bf16 v[28:31], v[236:239], v[80:83], v[28:31]
    s_waitcnt vmcnt(9)
    v_mfma_f32_16x16x32_bf16 v[16:19], v[96:99], v[84:87], v[16:19]
    ds_read_b128 v[224:227], v4 offset:36864
    ds_read_b128 v[228:231], v4 offset:37888
    v_mfma_f32_16x16x32_bf16 v[20:23], v[100:103], v[84:87], v[20:23]
    buffer_load_dwordx4 v[60:63], v1, s[4:7], s26 offen offset:3072 sc1
    v_mfma_f32_16x16x32_bf16 v[24:27], v[104:107], v[84:87], v[24:27]
    ds_read_b128 v[232:235], v4 offset:38912
    ds_read_b128 v[236:239], v4 offset:39936
    v_mfma_f32_16x16x32_bf16 v[28:31], v[108:111], v[84:87], v[28:31]
    s_waitcnt vmcnt(9)
    v_mfma_f32_16x16x32_bf16 v[16:19], v[112:115], v[88:91], v[16:19]
    s_waitcnt lgkmcnt(8)
    ds_read_b128 v[96:99], v4 offset:40960
    ds_read_b128 v[100:103], v4 offset:41984
    v_mfma_f32_16x16x32_bf16 v[20:23], v[116:119], v[88:91], v[20:23]
    v_mfma_f32_16x16x32_bf16 v[24:27], v[120:123], v[88:91], v[24:27]
    ds_read_b128 v[104:107], v4 offset:43008
    ds_read_b128 v[108:111], v4 offset:44032
    v_mfma_f32_16x16x32_bf16 v[28:31], v[124:127], v[88:91], v[28:31]
    s_waitcnt vmcnt(8)
    v_mfma_f32_16x16x32_bf16 v[16:19], v[128:131], v[92:95], v[16:19]
    ds_read_b128 v[112:115], v4 offset:45056
    ds_read_b128 v[116:119], v4 offset:46080
    v_mfma_f32_16x16x32_bf16 v[20:23], v[132:135], v[92:95], v[20:23]
    v_mfma_f32_16x16x32_bf16 v[24:27], v[136:139], v[92:95], v[24:27]
    ds_read_b128 v[120:123], v4 offset:47104
    s_waitcnt lgkmcnt(8)
    ds_read_b128 v[124:127], v4 offset:48128
    v_mfma_f32_16x16x32_bf16 v[28:31], v[140:143], v[92:95], v[28:31]
    s_waitcnt vmcnt(7)
    v_mfma_f32_16x16x32_bf16 v[16:19], v[144:147], v[32:35], v[16:19]
    v_mfma_f32_16x16x32_bf16 v[20:23], v[148:151], v[32:35], v[20:23]
    v_mfma_f32_16x16x32_bf16 v[24:27], v[152:155], v[32:35], v[24:27]
    v_mfma_f32_16x16x32_bf16 v[28:31], v[156:159], v[32:35], v[28:31]
    s_add_u32 s51, s50, 11
    v_mov_b32 v3, s51
    ds_write_b32 v14, v3 offset:0
    s_waitcnt vmcnt(6)
    v_mfma_f32_16x16x32_bf16 v[16:19], v[160:163], v[36:39], v[16:19]
    v_mfma_f32_16x16x32_bf16 v[20:23], v[164:167], v[36:39], v[20:23]
    v_mfma_f32_16x16x32_bf16 v[24:27], v[168:171], v[36:39], v[24:27]
    v_mfma_f32_16x16x32_bf16 v[28:31], v[172:175], v[36:39], v[28:31]
    s_waitcnt vmcnt(5)
    v_mfma_f32_16x16x32_bf16 v[16:19], v[176:179], v[40:43], v[16:19]
    v_mfma_f32_16x16x32_bf16 v[20:23], v[180:183], v[40:43], v[20:23]
    v_mfma_f32_16x16x32_bf16 v[24:27], v[184:187], v[40:43], v[24:27]
    v_mfma_f32_16x16x32_bf16 v[28:31], v[188:191], v[40:43], v[28:31]
    s_waitcnt vmcnt(4)
    v_mfma_f32_16x16x32_bf16 v[16:19], v[192:195], v[44:47], v[16:19]
    v_mfma_f32_16x16x32_bf16 v[20:23], v[196:199], v[44:47], v[20:23]
    v_mfma_f32_16x16x32_bf16 v[24:27], v[200:203], v[44:47], v[24:27]
    v_mfma_f32_16x16x32_bf16 v[28:31], v[204:207], v[44:47], v[28:31]
    s_waitcnt vmcnt(3)
    v_mfma_f32_16x16x32_bf16 v[16:19], v[208:211], v[48:51], v[16:19]
    v_mfma_f32_16x16x32_bf16 v[20:23], v[212:215], v[48:51], v[20:23]
    v_mfma_f32_16x16x32_bf16 v[24:27], v[216:219], v[48:51], v[24:27]
    v_mfma_f32_16x16x32_bf16 v[28:31], v[220:223], v[48:51], v[28:31]
    s_waitcnt vmcnt(2) lgkmcnt(9)
    v_mfma_f32_16x16x32_bf16 v[16:19], v[224:227], v[52:55], v[16:19]
    v_mfma_f32_16x16x32_bf16 v[20:23], v[228:231], v[52:55], v[20:23]
    v_mfma_f32_16x16x32_bf16 v[24:27], v[232:235], v[52:55], v[24:27]
    v_mfma_f32_16x16x32_bf16 v[28:31], v[236:239], v[52:55], v[28:31]
    s_waitcnt vmcnt(1) lgkmcnt(5)
    v_mfma_f32_16x16x32_bf16 v[16:19], v[96:99], v[56:59], v[16:19]
    v_mfma_f32_16x16x32_bf16 v[20:23], v[100:103], v[56:59], v[20:23]
    v_mfma_f32_16x16x32_bf16 v[24:27], v[104:107], v[56:59], v[24:27]
    v_mfma_f32_16x16x32_bf16 v[28:31], v[108:111], v[56:59], v[28:31]
    s_waitcnt vmcnt(0) lgkmcnt(1)
    v_mfma_f32_16x16x32_bf16 v[16:19], v[112:115], v[60:63], v[16:19]
    v_mfma_f32_16x16x32_bf16 v[20:23], v[116:119], v[60:63], v[20:23]
    v_mfma_f32_16x16x32_bf16 v[24:27], v[120:123], v[60:63], v[24:27]
    v_mfma_f32_16x16x32_bf16 v[28:31], v[124:127], v[60:63], v[28:31]
    s_add_u32 s51, s50, 12
    v_mov_b32 v3, s51
    ds_write_b32 v14, v3 offset:0
    s_cmp_eq_u32 s21, 1
    s_cbranch_scc1 .Lfinal_85
    v_cvt_pk_bf16_f32 v32, v16, v17
    v_cvt_pk_bf16_f32 v33, v18, v19
    v_cvt_pk_bf16_f32 v34, v20, v21
    v_cvt_pk_bf16_f32 v35, v22, v23
    v_cvt_pk_bf16_f32 v36, v24, v25
    v_cvt_pk_bf16_f32 v37, v26, v27
    v_cvt_pk_bf16_f32 v38, v28, v29
    v_cvt_pk_bf16_f32 v39, v30, v31
    s_add_u32 s26, s24, 7155712
    s_add_u32 s27, s25, 9252864
    s_cmp_eq_u32 s45, 0
    s_cbranch_scc1 .Lsts_204
    buffer_store_dwordx4 v[32:35], v1, s[4:7], s26 offen
    buffer_store_dwordx4 v[36:39], v1, s[4:7], s26 offen offset:1024
    s_branch .Lstd_205
.Lsts_204:
    buffer_store_dwordx4 v[32:35], v1, s[4:7], s26 offen sc1
    buffer_store_dwordx4 v[36:39], v1, s[4:7], s26 offen offset:1024 sc1
.Lstd_205:
    v_pk_add_f32 v[40:41], v[16:17], v[18:19]
    v_pk_mul_f32 v[42:43], v[16:17], v[16:17]
    v_pk_fma_f32 v[42:43], v[18:19], v[18:19], v[42:43]
    v_pk_add_f32 v[40:41], v[40:41], v[20:21]
    v_pk_fma_f32 v[42:43], v[20:21], v[20:21], v[42:43]
    v_pk_add_f32 v[40:41], v[40:41], v[22:23]
    v_pk_fma_f32 v[42:43], v[22:23], v[22:23], v[42:43]
    v_pk_add_f32 v[40:41], v[40:41], v[24:25]
    v_pk_fma_f32 v[42:43], v[24:25], v[24:25], v[42:43]
    v_pk_add_f32 v[40:41], v[40:41], v[26:27]
    v_pk_fma_f32 v[42:43], v[26:27], v[26:27], v[42:43]
    v_pk_add_f32 v[40:41], v[40:41], v[28:29]
    v_pk_fma_f32 v[42:43], v[28:29], v[28:29], v[42:43]
    v_pk_add_f32 v[40:41], v[40:41], v[30:31]
    v_pk_fma_f32 v[42:43], v[30:31], v[30:31], v[42:43]
    v_add_f32 v40, v40, v41
    v_add_f32 v41, v42, v43
    s_nop 1
    v_permlane32_swap_b32 v40, v41
    v_add_f32 v40, v40, v41
    v_mov_b32 v41, v40
    s_nop 1
    v_permlane16_swap_b32 v40, v41
    v_add_f32 v40, v40, v41
    v_mov_b32 v41, v40
    s_nop 1
    v_permlane32_swap_b32 v40, v41
    s_cmp_eq_u32 s45, 0
    s_cbranch_scc1 .Lsts_206
    s_mov_b64 exec, 0xffff
    buffer_store_dwordx2 v[40:41], v6, s[4:7], s27 offen
    s_mov_b64 exec, -1
    s_branch .Lstd_207
.Lsts_206:
    s_mov_b64 exec, 0xffff
    buffer_store_dwordx2 v[40:41], v6, s[4:7], s27 offen sc1
    s_mov_b64 exec, -1
.Lstd_207:
    s_waitcnt vmcnt(0)
    s_cmp_eq_u32 s45, 0
    s_cbranch_scc1 .Lsts_208
    s_mov_b64 exec, 1
    buffer_store_dword v8, v9, s[4:7], s47 offen offset:64
    s_mov_b64 exec, -1
    s_branch .Lstd_209
.Lsts_208:
    s_mov_b64 exec, 1
    buffer_store_dword v8, v9, s[4:7], s47 offen offset:64 sc1
    s_mov_b64 exec, -1
.Lstd_209:
    s_mov_b32 s21, 1
    s_mov_b32 s50, 10
    s_mov_b32 s52, 11534336
    s_mov_b32 s49, s45
    s_mov_b32 s22, 69632
    s_mov_b32 s44, 64
    s_add_u32 s47, s47, 64
    s_add_u32 s48, s48, 64
    s_branch .Lpair_84
.Lfinal_85:
    s_mov_b64 s[12:13], s[82:83]
    v_and_b32 v13, 15, v2
    v_lshlrev_b32 v13, 10, v13
    v_bfe_u32 v3, v2, 4, 1
    v_lshl_add_u32 v13, v3, 5, v13
    v_lshrrev_b32 v3, 5, v2
    v_lshl_add_u32 v13, v3, 4, v13
    s_lshl_b32 s28, s16, 14
    s_lshl_b32 s29, s17, 7
    s_add_u32 s28, s28, s29
    v_cvt_pk_bf16_f32 v64, v16, v17
    v_cvt_pk_bf16_f32 v65, v18, v19
    v_cvt_pk_bf16_f32 v66, v20, v21
    v_cvt_pk_bf16_f32 v67, v22, v23
    v_cvt_pk_bf16_f32 v68, v24, v25
    v_cvt_pk_bf16_f32 v69, v26, v27
    v_cvt_pk_bf16_f32 v70, v28, v29
    v_cvt_pk_bf16_f32 v71, v30, v31
    v_permlane16_swap_b32 v64, v66
    v_permlane16_swap_b32 v65, v67
    v_permlane16_swap_b32 v68, v70
    v_permlane16_swap_b32 v69, v71
    buffer_store_dwordx4 v[64:67], v13, s[12:15], s28 offen
    buffer_store_dwordx4 v[68:71], v13, s[12:15], s28 offen offset:64
.Lexit_1:
    s_endpgm
code_end:

.section .rodata,"a"
.p2align 6
.amdhsa_kernel interleave_layers__linear_kernel_hedgehog__mixer_s_mlp__prompt_kernel
  .amdhsa_next_free_vgpr 256
  .amdhsa_next_free_sgpr 102
  .amdhsa_accum_offset 256
  .amdhsa_group_segment_fixed_size 0
  .amdhsa_kernarg_size 96
  .amdhsa_user_sgpr_count 2
  .amdhsa_user_sgpr_kernarg_segment_ptr 1
  .amdhsa_system_sgpr_workgroup_id_x 1
  .amdhsa_float_denorm_mode_32 3
.end_amdhsa_kernel
```
